```python
import torch

def _softmax(x, axis=-1):
    return torch.softmax(x, dim=axis)
def _gelu(x):
    return torch.nn.functional.gelu(x, approximate="tanh")
def _silu(x):
    return torch.nn.functional.silu(x)
def _sigmoid(x):
    return torch.sigmoid(x)
def _layernorm(x, axis=-1, eps=1e-5):
    m = x.mean(dim=axis, keepdim=True)
    v = x.var(dim=axis, keepdim=True, unbiased=False)
    return (x - m) / torch.sqrt(v + eps)
def _scatter_add(tgt, idx, src, axis=0):
    return tgt.clone().index_add_(axis, idx, src)
def _segment_sum(src, seg, n):
    out = torch.zeros((n,) + src.shape[1:], dtype=src.dtype)
    return out.index_add_(0, seg, src)
def _pad(x, pw):
    flat = tuple(v for pair in reversed(pw) for v in pair)
    return torch.nn.functional.pad(x, flat)

kernel_name = 'parallel_sum__linear_attn_block__dense_activation_silu__prompt'

def setup_inputs():

    _w = (lambda a: (lambda t: t.to(torch.bfloat16) if t.is_floating_point() else t)(torch.as_tensor(a)))
    def _A_setup():
        B, S, D = 1, 2048, 640
        return {
            "x": _w((lambda *s: torch.randn(*s, dtype=torch.bfloat16) * 0.05)(B, S, D)),
            "wqkv": _w((lambda *s: torch.randn(*s, dtype=torch.bfloat16) * 0.1)(D, 3 * D)),
            "wo": _w((lambda *s: torch.randn(*s, dtype=torch.bfloat16) * 0.05)(D, D)),
        }
    _A_in = _A_setup()

    def _B_setup():
        B, S, D, F = 1, 2048, 640, 1536
        return {
            "x": _w((lambda *s: torch.randn(*s, dtype=torch.bfloat16) * 0.05)(B, S, D)),
            "w1": _w((lambda *s: torch.randn(*s, dtype=torch.bfloat16) * 0.8)(D, F) * (D ** -0.5)),
            "w2": _w((lambda *s: torch.randn(*s, dtype=torch.bfloat16) * 0.1)(F, D) * (F ** -0.5)),
        }
    _B_in = _B_setup()

    return {
        "A_x": _A_in["x"],
        "A_wqkv": _A_in["wqkv"],
        "A_wo": _A_in["wo"],
        "B_x": _B_in["x"],
        "B_w1": _B_in["w1"],
        "B_w2": _B_in["w2"],
    }

def reference(A_x, A_wqkv, A_wo, B_x, B_w1, B_w2):
    def _A_ref(x, wqkv, wo):
        B, S, D = x.shape
        H = 32; Dh = D // H
        qkv = (lambda x, *d: x.permute(*d))((x @ wqkv).reshape(B, S, 3, H, Dh), 2, 0, 3, 1, 4)
        q, k, v = qkv[0], qkv[1], qkv[2]
        phi = lambda t: torch.where(t > 0, t + 1, torch.exp(t)) + 1e-6
        pq, pk = phi(q), phi(k)
        kv = torch.einsum("bhsd,bhse->bhde", pk, v)
        z = torch.einsum("bhsd->bhd", pk)
        num = torch.einsum("bhqd,bhde->bhqe", pq, kv)
        den = torch.einsum("bhqd,bhd->bhq", pq, z)[..., None] + 1e-6
        o = num / den
        return (lambda x, *d: x.permute(*d))(o, 0, 2, 1, 3).reshape(B, S, D) @ wo

    def _B_ref(x, w1, w2):
        h = torch.einsum("bsd,df->bsf", x, w1)
        h = _silu(h)
        out = torch.einsum("bsf,fd->bsd", h, w2)
        return out

    x = A_x
    xn = _layernorm(x, axis=-1)
    return x + _A_ref(xn, A_wqkv, A_wo) + _B_ref(xn, B_w1, B_w2)
```

```asm
; @launch grid=(256,1,1) block=(512,1,1) lds=163840
.amdgcn_target "amdgcn-amd-amdhsa--gfx950"
.text
.globl parallel_sum__linear_attn_block__dense_activation_silu__prompt_kernel
.p2align 8
.type parallel_sum__linear_attn_block__dense_activation_silu__prompt_kernel,@function
parallel_sum__linear_attn_block__dense_activation_silu__prompt_kernel:
    s_cmp_ge_u32 s2, 256
    s_cbranch_scc1 L_end
    s_load_dwordx16 s[36:51], s[0:1], 0
    s_load_dwordx2 s[52:53], s[0:1], 64
    s_getpc_b64 s[4:5]
L_pc:
    s_mov_b32 s6, L_end-L_pc
    s_mov_b32 s7, 0x20000
    s_lshr_b32 s3, s2, 3
    s_mul_i32 s3, s3, 1408
    v_lshlrev_b32 v1, 7, v0
    v_cmp_gt_u32 vcc, 22, v0
    s_nop 0
    s_and_saveexec_b64 s[64:65], vcc
    s_cbranch_execz L_nopf
    buffer_load_dword v90, v1, s[4:7], s3 offen
L_nopf:
    s_mov_b64 exec, s[64:65]
    v_lshrrev_b32 v1, 6, v0
    v_and_b32 v0, 63, v0
    v_readfirstlane_b32 s54, v1
    s_lshr_b32 s3, s2, 3
    s_bfe_u32 s58, s2, 0x20001
    s_and_b32 s59, s2, 1
    s_and_b32 s64, s3, 7
    s_bfe_u32 s65, s2, 0x10002
    s_lshl_b32 s55, s65, 3
    s_add_u32 s55, s55, s64
    s_lshr_b32 s66, s3, 4
    s_and_b32 s65, s2, 3
    s_lshl_b32 s56, s65, 1
    s_add_u32 s56, s56, s66
    s_lshr_b32 s67, s3, 3
    s_mul_i32 s67, s67, 3
    s_add_u32 s62, s55, s67
    s_add_u32 s62, s62, s65
    s_sub_u32 s67, s62, 10
    s_cmp_ge_u32 s62, 10
    s_cselect_b32 s62, s67, s62
    s_sub_u32 s67, s62, 10
    s_cmp_ge_u32 s62, 10
    s_cselect_b32 s62, s67, s62
    s_and_b32 s63, s54, 3
    s_lshl_b32 s66, s66, 3
    s_add_u32 s70, s66, s64
    s_cmp_lt_u32 s54, 4
    s_cbranch_scc1 L_matrix
    s_setprio 3
    s_and_b32 s64, s63, 1
    s_lshl_b32 s64, s64, 2
    v_lshrrev_b32 v1, 4, v0
    v_add_u32 v1, s64, v1
    v_xor_b32 v1, v1, v0
    v_and_b32 v1, 7, v1
    v_lshlrev_b32 v1, 4, v1
    s_lshl_b32 s65, s63, 3
    v_lshrrev_b32 v7, 3, v0
    v_add_u32 v7, s65, v7
    v_mul_u32_u24 v2, 1280, v7
    v_add_u32 v2, v2, v1
    s_lshl_b32 s75, s63, 10
    s_mul_i32 s73, s55, 163840
    s_lshl_b32 s65, s62, 7
    s_add_u32 s73, s73, s65
    s_waitcnt lgkmcnt(0)
    s_mov_b32 s8, s36
    s_mov_b32 s9, s37
    s_mov_b32 s10, 0x280000
    s_mov_b32 s11, 0x20000
    s_add_u32 m0, s75, 0
    s_add_u32 s65, s73, 0
    buffer_load_dwordx4 v2, s[8:11], s65 offen lds
    s_add_u32 m0, s75, 4096
    s_add_u32 s65, s73, 40960
    buffer_load_dwordx4 v2, s[8:11], s65 offen lds
    s_add_u32 m0, s75, 8192
    s_add_u32 s65, s73, 81920
    buffer_load_dwordx4 v2, s[8:11], s65 offen lds
    s_add_u32 m0, s75, 12288
    s_add_u32 s65, s73, 122880
    buffer_load_dwordx4 v2, s[8:11], s65 offen lds
    s_bitcmp1_b32 s3, 3
    s_cbranch_scc1 L_loader_Q
L_loader_F:
    v_bfe_u32 v1, v0, 4, 1
    v_lshlrev_b32 v1, 1, v1
    v_add_u32 v1, s64, v1
    v_xor_b32 v1, v1, v0
    v_and_b32 v1, 7, v1
    v_lshlrev_b32 v1, 4, v1
    v_mul_u32_u24 v3, 3072, v7
    v_add_u32 v3, v3, v1
    s_mul_i32 s76, s63, 3072
    s_mov_b32 s12, s44
    s_mov_b32 s13, s45
    s_mov_b32 s14, 0x1e0000
    s_mov_b32 s15, 0x20000
    s_mov_b32 s81, s62
    s_mul_i32 s74, s56, 384
    s_mul_i32 s64, s62, 196608
    s_add_u32 s74, s74, s64
    s_add_u32 m0, s76, 16384
    s_add_u32 s64, s74, 0
    buffer_load_dwordx4 v3, s[12:15], s64 offen lds
    s_add_u32 m0, s76, 17408
    s_add_u32 s64, s74, 128
    buffer_load_dwordx4 v3, s[12:15], s64 offen lds
    s_add_u32 m0, s76, 18432
    s_add_u32 s64, s74, 256
    buffer_load_dwordx4 v3, s[12:15], s64 offen lds
    s_add_u32 m0, s76, 28672
    s_add_u32 s64, s74, 98304
    buffer_load_dwordx4 v3, s[12:15], s64 offen lds
    s_add_u32 m0, s76, 29696
    s_add_u32 s64, s74, 98432
    buffer_load_dwordx4 v3, s[12:15], s64 offen lds
    s_add_u32 m0, s76, 30720
    s_add_u32 s64, s74, 98560
    buffer_load_dwordx4 v3, s[12:15], s64 offen lds
    s_add_u32 s62, s62, 1
    s_cmp_eq_u32 s62, 10
    s_cselect_b32 s62, 0, s62
    s_mul_i32 s73, s55, 163840
    s_lshl_b32 s64, s62, 7
    s_add_u32 s73, s73, s64
    s_add_u32 m0, s75, 40960
    s_add_u32 s64, s73, 0
    buffer_load_dwordx4 v2, s[8:11], s64 offen lds
    s_add_u32 m0, s75, 45056
    s_add_u32 s64, s73, 40960
    buffer_load_dwordx4 v2, s[8:11], s64 offen lds
    s_add_u32 m0, s75, 49152
    s_add_u32 s64, s73, 81920
    buffer_load_dwordx4 v2, s[8:11], s64 offen lds
    s_add_u32 m0, s75, 53248
    s_add_u32 s64, s73, 122880
    buffer_load_dwordx4 v2, s[8:11], s64 offen lds
    s_setprio 0
    s_mov_b32 s16, s46
    s_mov_b32 s17, s47
    s_mov_b32 s18, 0x1e0000
    s_mov_b32 s19, 0x20000
    s_mov_b32 s20, s40
    s_mov_b32 s21, s41
    s_mov_b32 s22, 0xc8000
    s_mov_b32 s23, 0x20000
    s_mov_b32 s24, s52
    s_mov_b32 s25, s53
    s_mov_b32 s26, 0xb00000
    s_mov_b32 s27, 0x20000
    s_mov_b32 s28, s48
    s_mov_b32 s29, s49
    s_mov_b32 s30, 0x280000
    s_mov_b32 s31, 0x20000
    s_mov_b32 s32, s50
    s_mov_b32 s33, s51
    s_mov_b32 s34, 0x100
    s_mov_b32 s35, 0x20000
    s_lshr_b32 s64, s70, 2
    s_and_b32 s65, s70, 3
    s_sub_u32 s66, s70, 12
    s_lshr_b32 s67, s66, 1
    s_add_u32 s67, s67, 3
    s_and_b32 s66, s66, 1
    s_cmp_ge_u32 s70, 12
    s_cselect_b32 s64, s67, s64
    s_cselect_b32 s65, s66, s65
    s_mul_i32 s65, s65, 6
    s_mul_i32 s60, s59, 5
    s_add_u32 s60, s60, s64
    s_lshl_b32 s61, s58, 5
    s_add_u32 s61, s61, s65
    s_lshl_b32 s66, s64, 2
    s_lshr_b32 s67, 0xA2840, s66
    s_and_b32 s67, s67, 15
    s_add_u32 s71, s67, s59
    s_and_b32 s72, s60, 3
    v_lshrrev_b32 v1, 4, v0
    v_lshlrev_b32 v1, 1, v1
    v_xor_b32 v1, v1, v0
    v_and_b32 v1, 7, v1
    v_lshlrev_b32 v1, 4, v1
    v_lshrrev_b32 v4, 3, v0
    v_mul_u32_u24 v4, 1280, v4
    v_add_u32 v4, v4, v1
    v_lshrrev_b32 v1, 5, v0
    v_mul_u32_u24 v1, 46080, v1
    v_add_u32 v5, v4, v1
    v_lshlrev_b32 v6, 4, v0
    s_add_u32 s42, s52, 0x918000
    s_addc_u32 s43, s53, 0
    s_lshl_b32 s36, s55, 7
    s_lshl_b32 s37, s56, 7
    s_lshr_b32 s64, s61, 3
    s_lshl_b32 s38, s64, 7
    s_add_u32 s64, s61, 5
    s_lshr_b32 s64, s64, 3
    s_lshl_b32 s39, s64, 7
    s_mov_b32 s67, 0x40000000
    s_cmp_eq_u32 s63, 0
    s_cselect_b32 s67, 0x918000, s67
    v_mov_b32 v7, 0x40000000
    s_add_u32 s64, s67, s37
    s_add_u32 s64, s64, 6144
    v_mov_b32 v1, s64
    v_cmp_eq_u32 vcc, 0, v0
    s_nop 1
    v_cndmask_b32 v10, v7, v1, vcc
    s_add_u32 s64, s67, s36
    s_add_u32 s64, s64, 4096
    v_mov_b32 v1, s64
    v_cmp_eq_u32 vcc, 1, v0
    s_nop 1
    v_cndmask_b32 v10, v10, v1, vcc
    s_lshl_b32 s64, s55, 3
    s_add_u32 s64, s64, s56
    s_lshl_b32 s64, s64, 2
    s_add_u32 s64, s64, s63
    s_lshl_b32 s65, s64, 2
    v_lshrrev_b32 v16, 4, v0
    v_and_b32 v17, 15, v0
    v_add_u32_e64 v1, s65, v16
    v_mul_u32_u24 v1, 1280, v1
    v_lshl_add_u32 v9, v17, 4, v1
    s_lshl_b32 s64, s64, 6
    s_add_u32 s64, s64, 0x920000
    v_lshl_add_u32 v1, v16, 2, s64
    v_lshl_add_u32 v1, v17, 4, v1
    v_cmp_gt_u32 vcc, 3, v17
    s_nop 1
    v_cndmask_b32 v15, v7, v1, vcc
    s_lshl_b32 s64, s58, 4
    s_add_u32 s64, s64, s70
    s_mul_i32 s64, s64, 170
    s_mul_i32 s65, s63, 43
    v_add_u32 v1, s65, v0
    v_add_u32 v17, s64, v1
    v_mul_u32_u24 v16, 52429, v17
    v_lshrrev_b32 v16, 18, v16
    v_mul_u32_u24 v16, 640, v16
    v_lshl_add_u32 v16, v17, 7, v16
    s_mul_i32 s65, s59, 640
    v_add_u32 v16, s65, v16
    v_cmp_gt_u32 vcc, 170, v1
    s_nop 1
    v_cndmask_b32 v16, v7, v16, vcc
    v_cmp_gt_u32 vcc, 43, v0
    s_nop 1
    v_cndmask_b32 v24, v7, v16, vcc
    v_subrev_u32 v25, 1966080, v24
    s_lshl_b32 s64, s63, 6
    v_add_u32 v1, s64, v0
    s_mul_i32 s100, s56, 10240
    s_add_u32 s100, s100, 0x880000
    v_and_b32 v16, 0xe0, v1
    v_and_b32_e64 v17, 7, v1
    v_lshl_add_u32 v16, v17, 2, v16
    v_bfe_u32 v17, v1, 3, 2
    v_add_u32_e64 v16, v16, v17
    v_lshl_add_u32 v16, v16, 2, s100
    v_cmp_gt_u32 vcc, 192, v1
    s_nop 1
    v_cndmask_b32 v13, v7, v16, vcc
    v_lshlrev_b32_e64 v1, 2, v1
    v_add_u32 v14, 157696, v1
    v_mov_b32 v1, 158720
    v_mov_b32 v16, 0
    v_mov_b32 v17, 0
    v_mov_b32 v18, 0
    v_mov_b32 v19, 0
    ds_write_b128 v1, v[16:19]
    ds_write_b128 v1, v[16:19] offset:16
    ds_write_b128 v1, v[16:19] offset:32
    s_mov_b32 s77, s71
    s_mov_b32 s78, s71
    s_waitcnt vmcnt(4)
    s_waitcnt lgkmcnt(0)
    s_barrier
    s_mul_i32 s74, s56, 384
    s_mul_i32 s64, s62, 196608
    s_add_u32 s74, s74, s64
    s_add_u32 m0, s76, 57344
    s_add_u32 s64, s74, 0
    buffer_load_dwordx4 v3, s[12:15], s64 offen lds
    s_add_u32 m0, s76, 58368
    s_add_u32 s64, s74, 128
    buffer_load_dwordx4 v3, s[12:15], s64 offen lds
    s_add_u32 m0, s76, 59392
    s_add_u32 s64, s74, 256
    buffer_load_dwordx4 v3, s[12:15], s64 offen lds
    s_add_u32 m0, s76, 69632
    s_add_u32 s64, s74, 98304
    buffer_load_dwordx4 v3, s[12:15], s64 offen lds
    s_add_u32 m0, s76, 70656
    s_add_u32 s64, s74, 98432
    buffer_load_dwordx4 v3, s[12:15], s64 offen lds
    s_add_u32 m0, s76, 71680
    s_add_u32 s64, s74, 98560
    buffer_load_dwordx4 v3, s[12:15], s64 offen lds
    s_add_u32 s62, s62, 1
    s_cmp_eq_u32 s62, 10
    s_cselect_b32 s62, 0, s62
    s_mul_i32 s73, s55, 163840
    s_lshl_b32 s64, s62, 7
    s_add_u32 s73, s73, s64
    s_add_u32 m0, s75, 81920
    s_add_u32 s64, s73, 0
    buffer_load_dwordx4 v2, s[8:11], s64 offen lds
    s_add_u32 m0, s75, 86016
    s_add_u32 s64, s73, 40960
    buffer_load_dwordx4 v2, s[8:11], s64 offen lds
    s_add_u32 m0, s75, 90112
    s_add_u32 s64, s73, 81920
    buffer_load_dwordx4 v2, s[8:11], s64 offen lds
    s_add_u32 m0, s75, 94208
    s_add_u32 s64, s73, 122880
    buffer_load_dwordx4 v2, s[8:11], s64 offen lds
    v_mov_b32 v20, 0x40000000
    s_bitcmp0_b32 0x3ff, s55
    s_cbranch_scc1 L_cs_1
    s_cmp_ge_u32 s63, 2
    s_cbranch_scc1 L_cs_1
    v_and_b32 v1, 15, v0
    v_lshrrev_b32 v16, 4, v0
    s_lshl_b32 s64, s81, 10
    s_add_u32 s64, s64, s100
    s_cmp_lg_u32 s63, 0
    s_cbranch_scc1 L_cs_3
    v_min_u32 v17, 15, v1
    s_add_u32 s64, s64, 0
    s_mov_b32 s65, 4
    v_lshrrev_b32 v18, 3, v17
    v_lshlrev_b32 v18, 10, v18
    v_lshl_add_u32 v18, v16, 7, v18
    v_and_b32 v19, 2, v16
    v_xor_b32 v19, v19, v17
    v_and_b32_e64 v19, 7, v19
    v_lshl_add_u32 v18, v19, 4, v18
    v_add_u32 v22, 16384, v18
    v_xor_b32 v23, 64, v22
    ds_read_b128 v[64:67], v22 offset:0
    ds_read_b128 v[68:71], v22 offset:512
    ds_read_b128 v[72:75], v23 offset:3072
    ds_read_b128 v[76:79], v23 offset:3584
    ds_read_b128 v[80:83], v22 offset:6144
    ds_read_b128 v[84:87], v22 offset:6656
    ds_read_b128 v[88:91], v23 offset:9216
    ds_read_b128 v[92:95], v23 offset:9728
    ds_read_b128 v[96:99], v22 offset:12288
    ds_read_b128 v[100:103], v22 offset:12800
    ds_read_b128 v[104:107], v23 offset:15360
    ds_read_b128 v[108:111], v23 offset:15872
    ds_read_b128 v[112:115], v22 offset:18432
    ds_read_b128 v[116:119], v22 offset:18944
    ds_read_b128 v[120:123], v23 offset:21504
    ds_read_b128 v[124:127], v23 offset:22016
    s_branch L_cs_2
L_cs_3:
    v_min_u32 v17, 7, v1
    s_add_u32 s64, s64, 512
    s_mov_b32 s65, 2
    v_lshrrev_b32 v18, 3, v17
    v_lshlrev_b32 v18, 10, v18
    v_lshl_add_u32 v18, v16, 7, v18
    v_and_b32 v19, 2, v16
    v_xor_b32 v19, v19, v17
    v_and_b32_e64 v19, 7, v19
    v_lshl_add_u32 v18, v19, 4, v18
    v_add_u32 v22, 18432, v18
    v_xor_b32 v23, 64, v22
    ds_read_b128 v[64:67], v22 offset:0
    ds_read_b128 v[68:71], v22 offset:512
    ds_read_b128 v[72:75], v23 offset:3072
    ds_read_b128 v[76:79], v23 offset:3584
    ds_read_b128 v[80:83], v22 offset:6144
    ds_read_b128 v[84:87], v22 offset:6656
    ds_read_b128 v[88:91], v23 offset:9216
    ds_read_b128 v[92:95], v23 offset:9728
    ds_read_b128 v[96:99], v22 offset:12288
    ds_read_b128 v[100:103], v22 offset:12800
    ds_read_b128 v[104:107], v23 offset:15360
    ds_read_b128 v[108:111], v23 offset:15872
    ds_read_b128 v[112:115], v22 offset:18432
    ds_read_b128 v[116:119], v22 offset:18944
    ds_read_b128 v[120:123], v23 offset:21504
    ds_read_b128 v[124:127], v23 offset:22016
L_cs_4:
L_cs_2:
    v_lshlrev_b32 v17, 3, v16
    v_and_b32 v18, 7, v0
    v_add_u32 v17, v17, v18
    v_lshl_add_u32 v17, v17, 4, s64
    v_cmp_gt_u32 vcc, 8, v1
    s_nop 1
    v_cndmask_b32 v17, v20, v17, vcc
    v_cmp_gt_u32 vcc, s65, v16
    s_nop 1
    v_cndmask_b32 v20, v20, v17, vcc
    v_lshrrev_b32 v60, 1, v1
    v_and_b32 v1, 1, v1
    v_lshlrev_b32 v1, 4, v1
    v_mov_b32 v61, 0x3f80
    v_lshlrev_b32 v61, v1, v61
    v_mov_b32 v62, 0
    v_cmp_eq_u32 vcc, 0, v60
    s_nop 1
    v_cndmask_b32 v16, v62, v61, vcc
    v_cmp_eq_u32 vcc, 1, v60
    s_nop 1
    v_cndmask_b32 v17, v62, v61, vcc
    v_cmp_eq_u32 vcc, 2, v60
    s_nop 1
    v_cndmask_b32 v18, v62, v61, vcc
    v_cmp_eq_u32 vcc, 3, v60
    s_nop 1
    v_cndmask_b32 v19, v62, v61, vcc
    s_waitcnt lgkmcnt(0)
    s_nop 0
    v_mfma_f32_16x16x32_bf16 v[60:63], v[64:67], v[16:19], 0
    v_mfma_f32_16x16x32_bf16 v[60:63], v[68:71], v[16:19], v[60:63]
    v_mfma_f32_16x16x32_bf16 v[60:63], v[72:75], v[16:19], v[60:63]
    v_mfma_f32_16x16x32_bf16 v[60:63], v[76:79], v[16:19], v[60:63]
    v_mfma_f32_16x16x32_bf16 v[60:63], v[80:83], v[16:19], v[60:63]
    v_mfma_f32_16x16x32_bf16 v[60:63], v[84:87], v[16:19], v[60:63]
    v_mfma_f32_16x16x32_bf16 v[60:63], v[88:91], v[16:19], v[60:63]
    v_mfma_f32_16x16x32_bf16 v[60:63], v[92:95], v[16:19], v[60:63]
    v_mfma_f32_16x16x32_bf16 v[60:63], v[96:99], v[16:19], v[60:63]
    v_mfma_f32_16x16x32_bf16 v[60:63], v[100:103], v[16:19], v[60:63]
    v_mfma_f32_16x16x32_bf16 v[60:63], v[104:107], v[16:19], v[60:63]
    v_mfma_f32_16x16x32_bf16 v[60:63], v[108:111], v[16:19], v[60:63]
    v_mfma_f32_16x16x32_bf16 v[60:63], v[112:115], v[16:19], v[60:63]
    v_mfma_f32_16x16x32_bf16 v[60:63], v[116:119], v[16:19], v[60:63]
    v_mfma_f32_16x16x32_bf16 v[60:63], v[120:123], v[16:19], v[60:63]
    v_mfma_f32_16x16x32_bf16 v[60:63], v[124:127], v[16:19], v[60:63]
L_cs_1:
    s_nop 7
    buffer_store_dwordx4 v[60:63], v20, s[24:27], 0 offen sc1
    s_waitcnt vmcnt(5)
    s_barrier
    s_mul_i32 s74, s56, 384
    s_mul_i32 s64, s62, 196608
    s_add_u32 s74, s74, s64
    s_add_u32 m0, s76, 98304
    s_add_u32 s64, s74, 0
    buffer_load_dwordx4 v3, s[12:15], s64 offen lds
    s_add_u32 m0, s76, 99328
    s_add_u32 s64, s74, 128
    buffer_load_dwordx4 v3, s[12:15], s64 offen lds
    s_add_u32 m0, s76, 100352
    s_add_u32 s64, s74, 256
    buffer_load_dwordx4 v3, s[12:15], s64 offen lds
    s_add_u32 m0, s76, 110592
    s_add_u32 s64, s74, 98304
    buffer_load_dwordx4 v3, s[12:15], s64 offen lds
    s_add_u32 m0, s76, 111616
    s_add_u32 s64, s74, 98432
    buffer_load_dwordx4 v3, s[12:15], s64 offen lds
    s_add_u32 m0, s76, 112640
    s_add_u32 s64, s74, 98560
    buffer_load_dwordx4 v3, s[12:15], s64 offen lds
    s_add_u32 s62, s62, 1
    s_cmp_eq_u32 s62, 10
    s_cselect_b32 s62, 0, s62
    buffer_load_dwordx4 v[128:131], v9, s[8:11], 0 offen offset:0
    buffer_load_dwordx4 v[132:135], v9, s[8:11], 0 offen offset:256
    buffer_load_dwordx4 v[136:139], v9, s[8:11], 0 offen offset:512
    buffer_load_dwordx4 v[140:143], v9, s[8:11], 0 offen offset:768
    buffer_load_dwordx4 v[144:147], v9, s[8:11], 0 offen offset:1024
    s_mul_i32 s73, s55, 163840
    s_lshl_b32 s64, s62, 7
    s_add_u32 s73, s73, s64
    s_add_u32 m0, s75, 0
    s_add_u32 s64, s73, 0
    buffer_load_dwordx4 v2, s[8:11], s64 offen lds
    s_add_u32 m0, s75, 4096
    s_add_u32 s64, s73, 40960
    buffer_load_dwordx4 v2, s[8:11], s64 offen lds
    s_add_u32 m0, s75, 8192
    s_add_u32 s64, s73, 81920
    buffer_load_dwordx4 v2, s[8:11], s64 offen lds
    s_add_u32 m0, s75, 12288
    s_add_u32 s64, s73, 122880
    buffer_load_dwordx4 v2, s[8:11], s64 offen lds
    s_mul_i32 s74, s56, 384
    s_mul_i32 s64, s62, 196608
    s_add_u32 s74, s74, s64
    s_add_u32 m0, s76, 16384
    s_add_u32 s64, s74, 0
    buffer_load_dwordx4 v3, s[12:15], s64 offen lds
    s_add_u32 m0, s76, 17408
    s_add_u32 s64, s74, 128
    buffer_load_dwordx4 v3, s[12:15], s64 offen lds
    s_add_u32 m0, s76, 18432
    s_add_u32 s64, s74, 256
    buffer_load_dwordx4 v3, s[12:15], s64 offen lds
    s_add_u32 m0, s76, 28672
    s_add_u32 s64, s74, 98304
    buffer_load_dwordx4 v3, s[12:15], s64 offen lds
    s_add_u32 m0, s76, 29696
    s_add_u32 s64, s74, 98432
    buffer_load_dwordx4 v3, s[12:15], s64 offen lds
    s_add_u32 m0, s76, 30720
    s_add_u32 s64, s74, 98560
    buffer_load_dwordx4 v3, s[12:15], s64 offen lds
    s_add_u32 s62, s62, 1
    s_cmp_eq_u32 s62, 10
    s_cselect_b32 s62, 0, s62
    s_waitcnt vmcnt(15)
    s_barrier
    s_mul_i32 s73, s55, 163840
    s_lshl_b32 s64, s62, 7
    s_add_u32 s73, s73, s64
    s_add_u32 m0, s75, 40960
    s_add_u32 s64, s73, 0
    buffer_load_dwordx4 v2, s[8:11], s64 offen lds
    s_add_u32 m0, s75, 45056
    s_add_u32 s64, s73, 40960
    buffer_load_dwordx4 v2, s[8:11], s64 offen lds
    s_add_u32 m0, s75, 49152
    s_add_u32 s64, s73, 81920
    buffer_load_dwordx4 v2, s[8:11], s64 offen lds
    s_add_u32 m0, s75, 53248
    s_add_u32 s64, s73, 122880
    buffer_load_dwordx4 v2, s[8:11], s64 offen lds
    s_mul_i32 s74, s56, 384
    s_mul_i32 s64, s62, 196608
    s_add_u32 s74, s74, s64
    s_add_u32 m0, s76, 57344
    s_add_u32 s64, s74, 0
    buffer_load_dwordx4 v3, s[12:15], s64 offen lds
    s_add_u32 m0, s76, 58368
    s_add_u32 s64, s74, 128
    buffer_load_dwordx4 v3, s[12:15], s64 offen lds
    s_add_u32 m0, s76, 59392
    s_add_u32 s64, s74, 256
    buffer_load_dwordx4 v3, s[12:15], s64 offen lds
    s_add_u32 m0, s76, 69632
    s_add_u32 s64, s74, 98304
    buffer_load_dwordx4 v3, s[12:15], s64 offen lds
    s_add_u32 m0, s76, 70656
    s_add_u32 s64, s74, 98432
    buffer_load_dwordx4 v3, s[12:15], s64 offen lds
    s_add_u32 m0, s76, 71680
    s_add_u32 s64, s74, 98560
    buffer_load_dwordx4 v3, s[12:15], s64 offen lds
    s_add_u32 s62, s62, 1
    s_cmp_eq_u32 s62, 10
    s_cselect_b32 s62, 0, s62
    s_waitcnt vmcnt(20)
    v_lshlrev_b32 v150, 16, v128
    v_and_b32 v151, 0xffff0000, v128
    v_mov_b32 v154, v150
    v_mov_b32 v155, v151
    v_mul_f32 v156, v150, v150
    v_mul_f32 v157, v151, v151
    v_lshlrev_b32 v152, 16, v129
    v_and_b32 v153, 0xffff0000, v129
    v_add_f32 v154, v154, v152
    v_add_f32 v155, v155, v153
    v_fmac_f32 v156, v152, v152
    v_fmac_f32 v157, v153, v153
    v_lshlrev_b32 v150, 16, v130
    v_and_b32 v151, 0xffff0000, v130
    v_add_f32 v154, v154, v150
    v_add_f32 v155, v155, v151
    v_fmac_f32 v156, v150, v150
    v_fmac_f32 v157, v151, v151
    v_lshlrev_b32 v152, 16, v131
    v_and_b32 v153, 0xffff0000, v131
    v_add_f32 v154, v154, v152
    v_add_f32 v155, v155, v153
    v_fmac_f32 v156, v152, v152
    v_fmac_f32 v157, v153, v153
    v_lshlrev_b32 v150, 16, v132
    v_and_b32 v151, 0xffff0000, v132
    v_add_f32 v154, v154, v150
    v_add_f32 v155, v155, v151
    v_fmac_f32 v156, v150, v150
    v_fmac_f32 v157, v151, v151
    v_lshlrev_b32 v152, 16, v133
    v_and_b32 v153, 0xffff0000, v133
    v_add_f32 v154, v154, v152
    v_add_f32 v155, v155, v153
    v_fmac_f32 v156, v152, v152
    v_fmac_f32 v157, v153, v153
    v_lshlrev_b32 v150, 16, v134
    v_and_b32 v151, 0xffff0000, v134
    v_add_f32 v154, v154, v150
    v_add_f32 v155, v155, v151
    v_fmac_f32 v156, v150, v150
    v_fmac_f32 v157, v151, v151
    v_lshlrev_b32 v152, 16, v135
    v_and_b32 v153, 0xffff0000, v135
    v_add_f32 v154, v154, v152
    v_add_f32 v155, v155, v153
    v_fmac_f32 v156, v152, v152
    v_fmac_f32 v157, v153, v153
    v_lshlrev_b32 v150, 16, v136
    v_and_b32 v151, 0xffff0000, v136
    v_add_f32 v154, v154, v150
    v_add_f32 v155, v155, v151
    v_fmac_f32 v156, v150, v150
    v_fmac_f32 v157, v151, v151
    v_lshlrev_b32 v152, 16, v137
    v_and_b32 v153, 0xffff0000, v137
    v_add_f32 v154, v154, v152
    v_add_f32 v155, v155, v153
    v_fmac_f32 v156, v152, v152
    v_fmac_f32 v157, v153, v153
    v_lshlrev_b32 v150, 16, v138
    v_and_b32 v151, 0xffff0000, v138
    v_add_f32 v154, v154, v150
    v_add_f32 v155, v155, v151
    v_fmac_f32 v156, v150, v150
    v_fmac_f32 v157, v151, v151
    v_lshlrev_b32 v152, 16, v139
    v_and_b32 v153, 0xffff0000, v139
    v_add_f32 v154, v154, v152
    v_add_f32 v155, v155, v153
    v_fmac_f32 v156, v152, v152
    v_fmac_f32 v157, v153, v153
    v_lshlrev_b32 v150, 16, v140
    v_and_b32 v151, 0xffff0000, v140
    v_add_f32 v154, v154, v150
    v_add_f32 v155, v155, v151
    v_fmac_f32 v156, v150, v150
    v_fmac_f32 v157, v151, v151
    v_lshlrev_b32 v152, 16, v141
    v_and_b32 v153, 0xffff0000, v141
    v_add_f32 v154, v154, v152
    v_add_f32 v155, v155, v153
    v_fmac_f32 v156, v152, v152
    v_fmac_f32 v157, v153, v153
    v_lshlrev_b32 v150, 16, v142
    v_and_b32 v151, 0xffff0000, v142
    v_add_f32 v154, v154, v150
    v_add_f32 v155, v155, v151
    v_fmac_f32 v156, v150, v150
    v_fmac_f32 v157, v151, v151
    v_lshlrev_b32 v152, 16, v143
    v_and_b32 v153, 0xffff0000, v143
    v_add_f32 v154, v154, v152
    v_add_f32 v155, v155, v153
    v_fmac_f32 v156, v152, v152
    v_fmac_f32 v157, v153, v153
    v_lshlrev_b32 v150, 16, v144
    v_and_b32 v151, 0xffff0000, v144
    v_add_f32 v154, v154, v150
    v_add_f32 v155, v155, v151
    v_fmac_f32 v156, v150, v150
    v_fmac_f32 v157, v151, v151
    v_lshlrev_b32 v152, 16, v145
    v_and_b32 v153, 0xffff0000, v145
    v_add_f32 v154, v154, v152
    v_add_f32 v155, v155, v153
    v_fmac_f32 v156, v152, v152
    v_fmac_f32 v157, v153, v153
    v_lshlrev_b32 v150, 16, v146
    v_and_b32 v151, 0xffff0000, v146
    v_add_f32 v154, v154, v150
    v_add_f32 v155, v155, v151
    v_fmac_f32 v156, v150, v150
    v_fmac_f32 v157, v151, v151
    v_lshlrev_b32 v152, 16, v147
    v_and_b32 v153, 0xffff0000, v147
    v_add_f32 v154, v154, v152
    v_add_f32 v155, v155, v153
    v_fmac_f32 v156, v152, v152
    v_fmac_f32 v157, v153, v153
    v_add_f32 v154, v154, v155
    v_add_f32 v156, v156, v157
    s_nop 0
    v_add_f32_dpp v154, v154, v154 row_ror:8 row_mask:0xf bank_mask:0xf
    s_nop 0
    v_add_f32_dpp v156, v156, v156 row_ror:8 row_mask:0xf bank_mask:0xf
    s_nop 0
    v_add_f32_dpp v154, v154, v154 row_ror:4 row_mask:0xf bank_mask:0xf
    s_nop 0
    v_add_f32_dpp v156, v156, v156 row_ror:4 row_mask:0xf bank_mask:0xf
    s_nop 0
    v_add_f32_dpp v154, v154, v154 row_ror:2 row_mask:0xf bank_mask:0xf
    s_nop 0
    v_add_f32_dpp v156, v156, v156 row_ror:2 row_mask:0xf bank_mask:0xf
    s_nop 0
    v_add_f32_dpp v154, v154, v154 row_ror:1 row_mask:0xf bank_mask:0xf
    s_nop 0
    v_add_f32_dpp v156, v156, v156 row_ror:1 row_mask:0xf bank_mask:0xf
    v_mul_f32 v154, 0x3acccccd, v154
    v_mul_f32 v156, 0x3acccccd, v156
    v_fma_f32 v156, -v154, v154, v156
    v_max_f32 v156, 0, v156
    v_add_f32 v156, 0x3727c5ac, v156
    v_rsq_f32 v155, v156
    v_sqrt_f32 v157, v156
    v_and_b32 v1, 15, v0
    v_cmp_eq_u32 vcc, 1, v1
    s_nop 1
    v_cndmask_b32 v154, v154, v155, vcc
    v_cmp_eq_u32 vcc, 2, v1
    s_nop 1
    v_cndmask_b32 v154, v154, v157, vcc
    buffer_store_dword v154, v15, s[24:27], 0 offen sc1
    s_waitcnt vmcnt(11)
    s_barrier
    s_load_dword s57, s[50:51], 0x0
    s_mul_i32 s73, s55, 163840
    s_lshl_b32 s64, s62, 7
    s_add_u32 s73, s73, s64
    s_add_u32 m0, s75, 81920
    s_add_u32 s64, s73, 0
    buffer_load_dwordx4 v2, s[8:11], s64 offen lds
    s_add_u32 m0, s75, 86016
    s_add_u32 s64, s73, 40960
    buffer_load_dwordx4 v2, s[8:11], s64 offen lds
    s_add_u32 m0, s75, 90112
    s_add_u32 s64, s73, 81920
    buffer_load_dwordx4 v2, s[8:11], s64 offen lds
    s_add_u32 m0, s75, 94208
    s_add_u32 s64, s73, 122880
    buffer_load_dwordx4 v2, s[8:11], s64 offen lds
    s_mul_i32 s74, s56, 384
    s_mul_i32 s64, s62, 196608
    s_add_u32 s74, s74, s64
    s_add_u32 m0, s76, 98304
    s_add_u32 s64, s74, 0
    buffer_load_dwordx4 v3, s[12:15], s64 offen lds
    s_add_u32 m0, s76, 99328
    s_add_u32 s64, s74, 128
    buffer_load_dwordx4 v3, s[12:15], s64 offen lds
    s_add_u32 m0, s76, 100352
    s_add_u32 s64, s74, 256
    buffer_load_dwordx4 v3, s[12:15], s64 offen lds
    s_add_u32 m0, s76, 110592
    s_add_u32 s64, s74, 98304
    buffer_load_dwordx4 v3, s[12:15], s64 offen lds
    s_add_u32 m0, s76, 111616
    s_add_u32 s64, s74, 98432
    buffer_load_dwordx4 v3, s[12:15], s64 offen lds
    s_add_u32 m0, s76, 112640
    s_add_u32 s64, s74, 98560
    buffer_load_dwordx4 v3, s[12:15], s64 offen lds
    s_add_u32 s62, s62, 1
    s_cmp_eq_u32 s62, 10
    s_cselect_b32 s62, 0, s62
    s_waitcnt vmcnt(11)
    s_waitcnt vmcnt(10)
    s_waitcnt lgkmcnt(0)
    s_cmp_ge_u32 s57, 4
    s_cbranch_scc1 L_chk_9
L_chk_5:
    s_cmp_eq_u32 s63, 0
    s_cbranch_scc1 L_chk_8
    v_mov_b32 v16, 158752
    s_mov_b32 s67, 4194304
L_lw_11:
    ds_read_b32 v17, v16
    s_sub_u32 s67, s67, 1
    s_cbranch_scc1 L_lw_12
    s_waitcnt lgkmcnt(0)
    v_cmp_eq_u32 vcc, 1, v17
    s_sleep 1
    s_cbranch_vccz L_lw_11
L_lw_12:
    s_branch L_chk_7
L_chk_8:
    s_mov_b32 s67, 65536
    v_mov_b32 v16, 0
    s_mov_b64 exec, 1
L_chk_6:
    buffer_load_dword v18, v16, s[32:35], 0 offen sc1
    s_waitcnt vmcnt(0)
    v_cmp_le_u32 vcc, 4, v18
    s_cbranch_vccnz L_chk_10
    s_sleep 6
    s_sub_u32 s67, s67, 1
    s_cbranch_scc0 L_chk_6
L_chk_10:
    s_mov_b64 exec, -1
L_chk_9:
    v_mov_b32 v16, 158752
    v_mov_b32 v17, 1
    ds_write_b32 v16, v17
L_chk_7:
    s_barrier
    v_mov_b32 v8, 1
    buffer_atomic_add v8, v10, s[24:27], 0 offen
    s_mul_i32 s73, s55, 163840
    s_lshl_b32 s64, s62, 7
    s_add_u32 s73, s73, s64
    s_add_u32 m0, s75, 0
    s_add_u32 s64, s73, 0
    buffer_load_dwordx4 v2, s[8:11], s64 offen lds
    s_add_u32 m0, s75, 4096
    s_add_u32 s64, s73, 40960
    buffer_load_dwordx4 v2, s[8:11], s64 offen lds
    s_add_u32 m0, s75, 8192
    s_add_u32 s64, s73, 81920
    buffer_load_dwordx4 v2, s[8:11], s64 offen lds
    s_add_u32 m0, s75, 12288
    s_add_u32 s64, s73, 122880
    buffer_load_dwordx4 v2, s[8:11], s64 offen lds
    s_mul_i32 s74, s56, 384
    s_mul_i32 s64, s62, 196608
    s_add_u32 s74, s74, s64
    s_add_u32 m0, s76, 16384
    s_add_u32 s64, s74, 0
    buffer_load_dwordx4 v3, s[12:15], s64 offen lds
    s_add_u32 m0, s76, 17408
    s_add_u32 s64, s74, 128
    buffer_load_dwordx4 v3, s[12:15], s64 offen lds
    s_add_u32 m0, s76, 18432
    s_add_u32 s64, s74, 256
    buffer_load_dwordx4 v3, s[12:15], s64 offen lds
    s_add_u32 m0, s76, 28672
    s_add_u32 s64, s74, 98304
    buffer_load_dwordx4 v3, s[12:15], s64 offen lds
    s_add_u32 m0, s76, 29696
    s_add_u32 s64, s74, 98432
    buffer_load_dwordx4 v3, s[12:15], s64 offen lds
    s_add_u32 m0, s76, 30720
    s_add_u32 s64, s74, 98560
    buffer_load_dwordx4 v3, s[12:15], s64 offen lds
    s_add_u32 s62, s62, 1
    s_cmp_eq_u32 s62, 10
    s_cselect_b32 s62, 0, s62
    s_waitcnt vmcnt(11)
    s_barrier
    s_mul_i32 s73, s55, 163840
    s_lshl_b32 s64, s62, 7
    s_add_u32 s73, s73, s64
    s_add_u32 m0, s75, 40960
    s_add_u32 s64, s73, 0
    buffer_load_dwordx4 v2, s[8:11], s64 offen lds
    s_add_u32 m0, s75, 45056
    s_add_u32 s64, s73, 40960
    buffer_load_dwordx4 v2, s[8:11], s64 offen lds
    s_add_u32 m0, s75, 49152
    s_add_u32 s64, s73, 81920
    buffer_load_dwordx4 v2, s[8:11], s64 offen lds
    s_add_u32 m0, s75, 53248
    s_add_u32 s64, s73, 122880
    buffer_load_dwordx4 v2, s[8:11], s64 offen lds
    s_mul_i32 s74, s56, 384
    s_mul_i32 s64, s62, 196608
    s_add_u32 s74, s74, s64
    s_add_u32 m0, s76, 57344
    s_add_u32 s64, s74, 0
    buffer_load_dwordx4 v3, s[12:15], s64 offen lds
    s_add_u32 m0, s76, 58368
    s_add_u32 s64, s74, 128
    buffer_load_dwordx4 v3, s[12:15], s64 offen lds
    s_add_u32 m0, s76, 59392
    s_add_u32 s64, s74, 256
    buffer_load_dwordx4 v3, s[12:15], s64 offen lds
    s_add_u32 m0, s76, 69632
    s_add_u32 s64, s74, 98304
    buffer_load_dwordx4 v3, s[12:15], s64 offen lds
    s_add_u32 m0, s76, 70656
    s_add_u32 s64, s74, 98432
    buffer_load_dwordx4 v3, s[12:15], s64 offen lds
    s_add_u32 m0, s76, 71680
    s_add_u32 s64, s74, 98560
    buffer_load_dwordx4 v3, s[12:15], s64 offen lds
    s_add_u32 s62, s62, 1
    s_cmp_eq_u32 s62, 10
    s_cselect_b32 s62, 0, s62
    s_waitcnt vmcnt(10)
    s_barrier
    s_mul_i32 s73, s55, 163840
    s_lshl_b32 s64, s62, 7
    s_add_u32 s73, s73, s64
    s_add_u32 m0, s75, 81920
    s_add_u32 s64, s73, 0
    buffer_load_dwordx4 v2, s[8:11], s64 offen lds
    s_add_u32 m0, s75, 86016
    s_add_u32 s64, s73, 40960
    buffer_load_dwordx4 v2, s[8:11], s64 offen lds
    s_add_u32 m0, s75, 90112
    s_add_u32 s64, s73, 81920
    buffer_load_dwordx4 v2, s[8:11], s64 offen lds
    s_add_u32 m0, s75, 94208
    s_add_u32 s64, s73, 122880
    buffer_load_dwordx4 v2, s[8:11], s64 offen lds
    s_mul_i32 s74, s56, 384
    s_mul_i32 s64, s62, 196608
    s_add_u32 s74, s74, s64
    s_add_u32 m0, s76, 98304
    s_add_u32 s64, s74, 0
    buffer_load_dwordx4 v3, s[12:15], s64 offen lds
    s_add_u32 m0, s76, 99328
    s_add_u32 s64, s74, 128
    buffer_load_dwordx4 v3, s[12:15], s64 offen lds
    s_add_u32 m0, s76, 100352
    s_add_u32 s64, s74, 256
    buffer_load_dwordx4 v3, s[12:15], s64 offen lds
    s_add_u32 m0, s76, 110592
    s_add_u32 s64, s74, 98304
    buffer_load_dwordx4 v3, s[12:15], s64 offen lds
    s_add_u32 m0, s76, 111616
    s_add_u32 s64, s74, 98432
    buffer_load_dwordx4 v3, s[12:15], s64 offen lds
    s_add_u32 m0, s76, 112640
    s_add_u32 s64, s74, 98560
    buffer_load_dwordx4 v3, s[12:15], s64 offen lds
    s_add_u32 s62, s62, 1
    s_cmp_eq_u32 s62, 10
    s_cselect_b32 s62, 0, s62
    s_waitcnt vmcnt(10)
    s_barrier
    s_load_dword s57, s[42:43], s37 offset:0x1800
    s_load_dword s101, s[42:43], s36 offset:0x1000
    s_mul_i32 s73, s55, 163840
    s_lshl_b32 s64, s62, 7
    s_add_u32 s73, s73, s64
    s_add_u32 m0, s75, 0
    s_add_u32 s64, s73, 0
    buffer_load_dwordx4 v2, s[8:11], s64 offen lds
    s_add_u32 m0, s75, 4096
    s_add_u32 s64, s73, 40960
    buffer_load_dwordx4 v2, s[8:11], s64 offen lds
    s_add_u32 m0, s75, 8192
    s_add_u32 s64, s73, 81920
    buffer_load_dwordx4 v2, s[8:11], s64 offen lds
    s_add_u32 m0, s75, 12288
    s_add_u32 s64, s73, 122880
    buffer_load_dwordx4 v2, s[8:11], s64 offen lds
    s_mul_i32 s74, s56, 384
    s_mul_i32 s64, s62, 196608
    s_add_u32 s74, s74, s64
    s_add_u32 m0, s76, 16384
    s_add_u32 s64, s74, 0
    buffer_load_dwordx4 v3, s[12:15], s64 offen lds
    s_add_u32 m0, s76, 17408
    s_add_u32 s64, s74, 128
    buffer_load_dwordx4 v3, s[12:15], s64 offen lds
    s_add_u32 m0, s76, 18432
    s_add_u32 s64, s74, 256
    buffer_load_dwordx4 v3, s[12:15], s64 offen lds
    s_add_u32 m0, s76, 28672
    s_add_u32 s64, s74, 98304
    buffer_load_dwordx4 v3, s[12:15], s64 offen lds
    s_add_u32 m0, s76, 29696
    s_add_u32 s64, s74, 98432
    buffer_load_dwordx4 v3, s[12:15], s64 offen lds
    s_add_u32 m0, s76, 30720
    s_add_u32 s64, s74, 98560
    buffer_load_dwordx4 v3, s[12:15], s64 offen lds
    s_add_u32 s62, s62, 1
    s_cmp_eq_u32 s62, 10
    s_cselect_b32 s62, 0, s62
    s_waitcnt vmcnt(10)
    s_barrier
    s_waitcnt lgkmcnt(0)
    s_cmp_lt_u32 s101, 8
    s_cbranch_scc1 L_chk_13
    s_cmp_ge_u32 s57, 16
    s_cbranch_scc1 L_chk_17
L_chk_13:
    s_cmp_eq_u32 s63, 0
    s_cbranch_scc1 L_chk_16
    v_mov_b32 v16, 158756
    s_mov_b32 s67, 4194304
L_lw_19:
    ds_read_b32 v17, v16
    s_sub_u32 s67, s67, 1
    s_cbranch_scc1 L_lw_20
    s_waitcnt lgkmcnt(0)
    v_cmp_eq_u32 vcc, 1, v17
    s_sleep 1
    s_cbranch_vccz L_lw_19
L_lw_20:
    s_branch L_chk_15
L_chk_16:
    s_mov_b32 s67, 65536
    s_add_u32 s64, s37, 0x919800
    v_mov_b32 v16, s64
    s_add_u32 s64, s36, 0x919000
    v_mov_b32 v17, s64
    s_mov_b64 exec, 1
L_chk_14:
    buffer_load_dword v18, v16, s[24:27], 0 offen sc1
    buffer_load_dword v19, v17, s[24:27], 0 offen sc1
    s_waitcnt vmcnt(0)
    v_cmp_le_u32 vcc, 16, v18
    v_cmp_le_u32 s[64:65], 8, v19
    s_nop 0
    s_and_b64 vcc, vcc, s[64:65]
    s_cbranch_vccnz L_chk_18
    s_sleep 6
    s_sub_u32 s67, s67, 1
    s_cbranch_scc0 L_chk_14
L_chk_18:
    s_mov_b64 exec, -1
L_chk_17:
    v_mov_b32 v16, 158756
    v_mov_b32 v17, 1
    ds_write_b32 v16, v17
L_chk_15:
    s_lshl_b32 s66, s55, 11
    s_lshl_b32 s65, s63, 9
    s_add_u32 s66, s66, s65
    s_mov_b32 exec_hi, 0
    s_add_u32 m0, s65, 155648
    s_add_u32 s64, s66, 9568256
    buffer_load_dwordx4 v6, s[24:27], s64 offen sc1 lds
    s_mov_b64 exec, -1
    s_mov_b32 s64, 0
    buffer_load_dword v32, v13, s[24:27], s64 offen offset:0 sc1
    buffer_load_dword v33, v13, s[24:27], s64 offen offset:1024 sc1
    buffer_load_dword v34, v13, s[24:27], s64 offen offset:2048 sc1
    buffer_load_dword v35, v13, s[24:27], s64 offen offset:3072 sc1
    s_mov_b32 s64, 4096
    buffer_load_dword v36, v13, s[24:27], s64 offen offset:0 sc1
    buffer_load_dword v37, v13, s[24:27], s64 offen offset:1024 sc1
    buffer_load_dword v38, v13, s[24:27], s64 offen offset:2048 sc1
    buffer_load_dword v39, v13, s[24:27], s64 offen offset:3072 sc1
    s_mov_b32 s64, 8192
    buffer_load_dword v40, v13, s[24:27], s64 offen offset:0 sc1
    buffer_load_dword v41, v13, s[24:27], s64 offen offset:1024 sc1
    s_waitcnt vmcnt(11)
    s_barrier
    buffer_load_dword v252, v24, s[16:19], 0 offen
    buffer_load_dword v253, v25, s[20:23], 0 offen
    s_waitcnt vmcnt(2)
    v_add_f32 v32, v32, v37
    v_add_f32 v33, v33, v38
    v_add_f32 v34, v34, v39
    v_add_f32 v35, v35, v40
    v_add_f32 v36, v36, v41
    v_add_f32 v32, v32, v33
    v_add_f32 v34, v34, v35
    v_add_f32 v32, v32, v34
    v_add_f32 v32, v32, v36
    ds_write_b32 v14, v32
    s_waitcnt lgkmcnt(0)
    s_barrier
    s_lshl_b32 s65, s63, 12
    s_lshl_b32 s66, s60, 7
    s_lshl_b32 s80, s78, 2
    s_add_u32 s80, s80, s63
    s_mul_i32 s80, s80, 40960
    s_add_u32 s80, s80, s66
    s_add_u32 m0, s65, 73728
    s_add_u32 s64, s80, 0
    buffer_load_dwordx4 v4, s[16:19], s64 offen lds
    s_add_u32 m0, s65, 74752
    s_add_u32 s64, s80, 10240
    buffer_load_dwordx4 v4, s[16:19], s64 offen lds
    s_add_u32 m0, s65, 75776
    s_add_u32 s64, s80, 20480
    buffer_load_dwordx4 v4, s[16:19], s64 offen lds
    s_add_u32 m0, s65, 76800
    s_add_u32 s64, s80, 30720
    buffer_load_dwordx4 v4, s[16:19], s64 offen lds
    s_add_u32 s78, s78, 1
    s_cmp_eq_u32 s78, 12
    s_cselect_b32 s78, 0, s78
    s_lshl_b32 s65, s63, 12
    s_lshl_b32 s66, s60, 7
    s_lshl_b32 s80, s78, 2
    s_add_u32 s80, s80, s63
    s_mul_i32 s80, s80, 40960
    s_add_u32 s80, s80, s66
    s_add_u32 m0, s65, 90112
    s_add_u32 s64, s80, 0
    buffer_load_dwordx4 v4, s[16:19], s64 offen lds
    s_add_u32 m0, s65, 91136
    s_add_u32 s64, s80, 10240
    buffer_load_dwordx4 v4, s[16:19], s64 offen lds
    s_add_u32 m0, s65, 92160
    s_add_u32 s64, s80, 20480
    buffer_load_dwordx4 v4, s[16:19], s64 offen lds
    s_add_u32 m0, s65, 93184
    s_add_u32 s64, s80, 30720
    buffer_load_dwordx4 v4, s[16:19], s64 offen lds
    s_add_u32 s78, s78, 1
    s_cmp_eq_u32 s78, 12
    s_cselect_b32 s78, 0, s78
    s_lshl_b32 s65, s63, 12
    s_lshl_b32 s66, s60, 7
    s_lshl_b32 s80, s78, 2
    s_add_u32 s80, s80, s63
    s_mul_i32 s80, s80, 40960
    s_add_u32 s80, s80, s66
    s_add_u32 m0, s65, 106496
    s_add_u32 s64, s80, 0
    buffer_load_dwordx4 v4, s[16:19], s64 offen lds
    s_add_u32 m0, s65, 107520
    s_add_u32 s64, s80, 10240
    buffer_load_dwordx4 v4, s[16:19], s64 offen lds
    s_add_u32 m0, s65, 108544
    s_add_u32 s64, s80, 20480
    buffer_load_dwordx4 v4, s[16:19], s64 offen lds
    s_add_u32 m0, s65, 109568
    s_add_u32 s64, s80, 30720
    buffer_load_dwordx4 v4, s[16:19], s64 offen lds
    s_add_u32 s78, s78, 1
    s_cmp_eq_u32 s78, 12
    s_cselect_b32 s78, 0, s78
    s_lshl_b32 s65, s63, 12
    s_lshl_b32 s66, s60, 7
    s_lshl_b32 s80, s78, 2
    s_add_u32 s80, s80, s63
    s_mul_i32 s80, s80, 40960
    s_add_u32 s80, s80, s66
    s_add_u32 m0, s65, 122880
    s_add_u32 s64, s80, 0
    buffer_load_dwordx4 v4, s[16:19], s64 offen lds
    s_add_u32 m0, s65, 123904
    s_add_u32 s64, s80, 10240
    buffer_load_dwordx4 v4, s[16:19], s64 offen lds
    s_add_u32 m0, s65, 124928
    s_add_u32 s64, s80, 20480
    buffer_load_dwordx4 v4, s[16:19], s64 offen lds
    s_add_u32 m0, s65, 125952
    s_add_u32 s64, s80, 30720
    buffer_load_dwordx4 v4, s[16:19], s64 offen lds
    s_add_u32 s78, s78, 1
    s_cmp_eq_u32 s78, 12
    s_cselect_b32 s78, 0, s78
    s_lshl_b32 s65, s63, 12
    s_lshl_b32 s66, s60, 7
    s_lshl_b32 s80, s78, 2
    s_add_u32 s80, s80, s63
    s_mul_i32 s80, s80, 40960
    s_add_u32 s80, s80, s66
    s_add_u32 m0, s65, 139264
    s_add_u32 s64, s80, 0
    buffer_load_dwordx4 v4, s[16:19], s64 offen lds
    s_add_u32 m0, s65, 140288
    s_add_u32 s64, s80, 10240
    buffer_load_dwordx4 v4, s[16:19], s64 offen lds
    s_add_u32 m0, s65, 141312
    s_add_u32 s64, s80, 20480
    buffer_load_dwordx4 v4, s[16:19], s64 offen lds
    s_add_u32 m0, s65, 142336
    s_add_u32 s64, s80, 30720
    buffer_load_dwordx4 v4, s[16:19], s64 offen lds
    s_add_u32 s78, s78, 1
    s_cmp_eq_u32 s78, 12
    s_cselect_b32 s78, 0, s78
    s_waitcnt vmcnt(4)
    s_barrier
    s_barrier
    s_lshl_b32 s65, s63, 12
    s_lshl_b32 s66, s60, 7
    s_lshl_b32 s80, s78, 2
    s_add_u32 s80, s80, s63
    s_mul_i32 s80, s80, 40960
    s_add_u32 s80, s80, s66
    s_add_u32 m0, s65, 73728
    s_add_u32 s64, s80, 0
    buffer_load_dwordx4 v4, s[16:19], s64 offen lds
    s_add_u32 m0, s65, 74752
    s_add_u32 s64, s80, 10240
    buffer_load_dwordx4 v4, s[16:19], s64 offen lds
    s_add_u32 m0, s65, 75776
    s_add_u32 s64, s80, 20480
    buffer_load_dwordx4 v4, s[16:19], s64 offen lds
    s_add_u32 m0, s65, 76800
    s_add_u32 s64, s80, 30720
    buffer_load_dwordx4 v4, s[16:19], s64 offen lds
    s_add_u32 s78, s78, 1
    s_cmp_eq_u32 s78, 12
    s_cselect_b32 s78, 0, s78
    s_lshl_b32 s65, s63, 12
    s_lshl_b32 s66, s60, 7
    s_lshl_b32 s80, s78, 2
    s_add_u32 s80, s80, s63
    s_mul_i32 s80, s80, 40960
    s_add_u32 s80, s80, s66
    s_add_u32 m0, s65, 90112
    s_add_u32 s64, s80, 0
    buffer_load_dwordx4 v4, s[16:19], s64 offen lds
    s_add_u32 m0, s65, 91136
    s_add_u32 s64, s80, 10240
    buffer_load_dwordx4 v4, s[16:19], s64 offen lds
    s_add_u32 m0, s65, 92160
    s_add_u32 s64, s80, 20480
    buffer_load_dwordx4 v4, s[16:19], s64 offen lds
    s_add_u32 m0, s65, 93184
    s_add_u32 s64, s80, 30720
    buffer_load_dwordx4 v4, s[16:19], s64 offen lds
    s_add_u32 s78, s78, 1
    s_cmp_eq_u32 s78, 12
    s_cselect_b32 s78, 0, s78
    s_lshl_b32 s65, s63, 12
    s_lshl_b32 s66, s60, 7
    s_lshl_b32 s80, s78, 2
    s_add_u32 s80, s80, s63
    s_mul_i32 s80, s80, 40960
    s_add_u32 s80, s80, s66
    s_add_u32 m0, s65, 106496
    s_add_u32 s64, s80, 0
    buffer_load_dwordx4 v4, s[16:19], s64 offen lds
    s_add_u32 m0, s65, 107520
    s_add_u32 s64, s80, 10240
    buffer_load_dwordx4 v4, s[16:19], s64 offen lds
    s_add_u32 m0, s65, 108544
    s_add_u32 s64, s80, 20480
    buffer_load_dwordx4 v4, s[16:19], s64 offen lds
    s_add_u32 m0, s65, 109568
    s_add_u32 s64, s80, 30720
    buffer_load_dwordx4 v4, s[16:19], s64 offen lds
    s_add_u32 s78, s78, 1
    s_cmp_eq_u32 s78, 12
    s_cselect_b32 s78, 0, s78
    s_lshl_b32 s65, s63, 12
    s_lshl_b32 s66, s60, 7
    s_lshl_b32 s80, s78, 2
    s_add_u32 s80, s80, s63
    s_mul_i32 s80, s80, 40960
    s_add_u32 s80, s80, s66
    s_add_u32 m0, s65, 122880
    s_add_u32 s64, s80, 0
    buffer_load_dwordx4 v4, s[16:19], s64 offen lds
    s_add_u32 m0, s65, 123904
    s_add_u32 s64, s80, 10240
    buffer_load_dwordx4 v4, s[16:19], s64 offen lds
    s_add_u32 m0, s65, 124928
    s_add_u32 s64, s80, 20480
    buffer_load_dwordx4 v4, s[16:19], s64 offen lds
    s_add_u32 m0, s65, 125952
    s_add_u32 s64, s80, 30720
    buffer_load_dwordx4 v4, s[16:19], s64 offen lds
    s_add_u32 s78, s78, 1
    s_cmp_eq_u32 s78, 12
    s_cselect_b32 s78, 0, s78
    s_load_dword s57, s[42:43], s38 offset:0x0
    s_load_dword s101, s[42:43], s39 offset:0x0
    s_waitcnt lgkmcnt(0)
    s_cmp_lt_u32 s101, 8
    s_cbranch_scc1 L_chk_21
    s_cmp_ge_u32 s57, 8
    s_cbranch_scc1 L_chk_25
L_chk_21:
    s_cmp_eq_u32 s63, 0
    s_cbranch_scc1 L_chk_24
    v_mov_b32 v16, 158720
    s_mov_b32 s67, 4194304
L_lw_27:
    ds_read_b32 v17, v16
    s_sub_u32 s67, s67, 1
    s_cbranch_scc1 L_lw_28
    s_waitcnt lgkmcnt(0)
    v_cmp_eq_u32 vcc, 1, v17
    s_sleep 1
    s_cbranch_vccz L_lw_27
L_lw_28:
    s_branch L_chk_23
L_chk_24:
    s_mov_b32 s67, 65536
    s_add_u32 s64, s38, 0x918000
    v_mov_b32 v16, s64
    s_add_u32 s64, s39, 0x918000
    v_mov_b32 v17, s64
    s_mov_b64 exec, 1
L_chk_22:
    buffer_load_dword v18, v16, s[24:27], 0 offen sc1
    buffer_load_dword v19, v17, s[24:27], 0 offen sc1
    s_waitcnt vmcnt(0)
    v_cmp_le_u32 vcc, 8, v18
    v_cmp_le_u32 s[64:65], 8, v19
    s_nop 0
    s_and_b64 vcc, vcc, s[64:65]
    s_cbranch_vccnz L_chk_26
    s_sleep 6
    s_sub_u32 s67, s67, 1
    s_cbranch_scc0 L_chk_22
L_chk_26:
    s_mov_b64 exec, -1
L_chk_25:
    v_mov_b32 v16, 158720
    v_mov_b32 v17, 1
    ds_write_b32 v16, v17
L_chk_23:
    s_mul_i32 s65, s63, 6144
    s_mul_i32 s66, s61, 69632
    s_lshl_b32 s79, s77, 2
    s_add_u32 s79, s79, s63
    s_lshl_b32 s79, s79, 10
    s_add_u32 s79, s79, s66
    s_add_u32 m0, s65, 0
    s_add_u32 s64, s79, 0
    buffer_load_dwordx4 v6, s[24:27], s64 offen sc1 lds
    s_add_u32 m0, s65, 1024
    s_add_u32 s64, s79, 69632
    buffer_load_dwordx4 v6, s[24:27], s64 offen sc1 lds
    s_add_u32 m0, s65, 2048
    s_add_u32 s64, s79, 139264
    buffer_load_dwordx4 v6, s[24:27], s64 offen sc1 lds
    s_add_u32 m0, s65, 3072
    s_add_u32 s64, s79, 208896
    buffer_load_dwordx4 v6, s[24:27], s64 offen sc1 lds
    s_add_u32 m0, s65, 4096
    s_add_u32 s64, s79, 278528
    buffer_load_dwordx4 v6, s[24:27], s64 offen sc1 lds
    s_add_u32 m0, s65, 5120
    s_add_u32 s64, s79, 348160
    buffer_load_dwordx4 v6, s[24:27], s64 offen sc1 lds
    s_add_u32 s77, s77, 1
    s_cmp_eq_u32 s77, 12
    s_cselect_b32 s77, 0, s77
    s_waitcnt vmcnt(0)
    s_barrier
    s_mul_i32 s65, s63, 6144
    s_mul_i32 s66, s61, 69632
    s_lshl_b32 s79, s77, 2
    s_add_u32 s79, s79, s63
    s_lshl_b32 s79, s79, 10
    s_add_u32 s79, s79, s66
    s_add_u32 m0, s65, 24576
    s_add_u32 s64, s79, 0
    buffer_load_dwordx4 v6, s[24:27], s64 offen sc1 lds
    s_add_u32 m0, s65, 25600
    s_add_u32 s64, s79, 69632
    buffer_load_dwordx4 v6, s[24:27], s64 offen sc1 lds
    s_add_u32 m0, s65, 26624
    s_add_u32 s64, s79, 139264
    buffer_load_dwordx4 v6, s[24:27], s64 offen sc1 lds
    s_add_u32 m0, s65, 27648
    s_add_u32 s64, s79, 208896
    buffer_load_dwordx4 v6, s[24:27], s64 offen sc1 lds
    s_add_u32 m0, s65, 28672
    s_add_u32 s64, s79, 278528
    buffer_load_dwordx4 v6, s[24:27], s64 offen sc1 lds
    s_add_u32 m0, s65, 29696
    s_add_u32 s64, s79, 348160
    buffer_load_dwordx4 v6, s[24:27], s64 offen sc1 lds
    s_add_u32 s77, s77, 1
    s_cmp_eq_u32 s77, 12
    s_cselect_b32 s77, 0, s77
    s_mul_i32 s65, s63, 6144
    s_mul_i32 s66, s61, 69632
    s_lshl_b32 s79, s77, 2
    s_add_u32 s79, s79, s63
    s_lshl_b32 s79, s79, 10
    s_add_u32 s79, s79, s66
    s_add_u32 m0, s65, 49152
    s_add_u32 s64, s79, 0
    buffer_load_dwordx4 v6, s[24:27], s64 offen sc1 lds
    s_add_u32 m0, s65, 50176
    s_add_u32 s64, s79, 69632
    buffer_load_dwordx4 v6, s[24:27], s64 offen sc1 lds
    s_add_u32 m0, s65, 51200
    s_add_u32 s64, s79, 139264
    buffer_load_dwordx4 v6, s[24:27], s64 offen sc1 lds
    s_add_u32 m0, s65, 52224
    s_add_u32 s64, s79, 208896
    buffer_load_dwordx4 v6, s[24:27], s64 offen sc1 lds
    s_add_u32 m0, s65, 53248
    s_add_u32 s64, s79, 278528
    buffer_load_dwordx4 v6, s[24:27], s64 offen sc1 lds
    s_add_u32 m0, s65, 54272
    s_add_u32 s64, s79, 348160
    buffer_load_dwordx4 v6, s[24:27], s64 offen sc1 lds
    s_add_u32 s77, s77, 1
    s_cmp_eq_u32 s77, 12
    s_cselect_b32 s77, 0, s77
    s_waitcnt vmcnt(6)
    s_barrier
    s_mul_i32 s65, s63, 6144
    s_mul_i32 s66, s61, 69632
    s_lshl_b32 s79, s77, 2
    s_add_u32 s79, s79, s63
    s_lshl_b32 s79, s79, 10
    s_add_u32 s79, s79, s66
    s_add_u32 m0, s65, 0
    s_add_u32 s64, s79, 0
    buffer_load_dwordx4 v6, s[24:27], s64 offen sc1 lds
    s_add_u32 m0, s65, 1024
    s_add_u32 s64, s79, 69632
    buffer_load_dwordx4 v6, s[24:27], s64 offen sc1 lds
    s_add_u32 m0, s65, 2048
    s_add_u32 s64, s79, 139264
    buffer_load_dwordx4 v6, s[24:27], s64 offen sc1 lds
    s_add_u32 m0, s65, 3072
    s_add_u32 s64, s79, 208896
    buffer_load_dwordx4 v6, s[24:27], s64 offen sc1 lds
    s_add_u32 m0, s65, 4096
    s_add_u32 s64, s79, 278528
    buffer_load_dwordx4 v6, s[24:27], s64 offen sc1 lds
    s_add_u32 m0, s65, 5120
    s_add_u32 s64, s79, 348160
    buffer_load_dwordx4 v6, s[24:27], s64 offen sc1 lds
    s_add_u32 s77, s77, 1
    s_cmp_eq_u32 s77, 12
    s_cselect_b32 s77, 0, s77
    s_waitcnt vmcnt(6)
    s_barrier
    s_mul_i32 s65, s63, 6144
    s_mul_i32 s66, s61, 69632
    s_lshl_b32 s79, s77, 2
    s_add_u32 s79, s79, s63
    s_lshl_b32 s79, s79, 10
    s_add_u32 s79, s79, s66
    s_add_u32 m0, s65, 24576
    s_add_u32 s64, s79, 0
    buffer_load_dwordx4 v6, s[24:27], s64 offen sc1 lds
    s_add_u32 m0, s65, 25600
    s_add_u32 s64, s79, 69632
    buffer_load_dwordx4 v6, s[24:27], s64 offen sc1 lds
    s_add_u32 m0, s65, 26624
    s_add_u32 s64, s79, 139264
    buffer_load_dwordx4 v6, s[24:27], s64 offen sc1 lds
    s_add_u32 m0, s65, 27648
    s_add_u32 s64, s79, 208896
    buffer_load_dwordx4 v6, s[24:27], s64 offen sc1 lds
    s_add_u32 m0, s65, 28672
    s_add_u32 s64, s79, 278528
    buffer_load_dwordx4 v6, s[24:27], s64 offen sc1 lds
    s_add_u32 m0, s65, 29696
    s_add_u32 s64, s79, 348160
    buffer_load_dwordx4 v6, s[24:27], s64 offen sc1 lds
    s_add_u32 s77, s77, 1
    s_cmp_eq_u32 s77, 12
    s_cselect_b32 s77, 0, s77
    s_waitcnt vmcnt(6)
    s_barrier
    s_mul_i32 s65, s63, 6144
    s_mul_i32 s66, s61, 69632
    s_lshl_b32 s79, s77, 2
    s_add_u32 s79, s79, s63
    s_lshl_b32 s79, s79, 10
    s_add_u32 s79, s79, s66
    s_add_u32 m0, s65, 49152
    s_add_u32 s64, s79, 0
    buffer_load_dwordx4 v6, s[24:27], s64 offen sc1 lds
    s_add_u32 m0, s65, 50176
    s_add_u32 s64, s79, 69632
    buffer_load_dwordx4 v6, s[24:27], s64 offen sc1 lds
    s_add_u32 m0, s65, 51200
    s_add_u32 s64, s79, 139264
    buffer_load_dwordx4 v6, s[24:27], s64 offen sc1 lds
    s_add_u32 m0, s65, 52224
    s_add_u32 s64, s79, 208896
    buffer_load_dwordx4 v6, s[24:27], s64 offen sc1 lds
    s_add_u32 m0, s65, 53248
    s_add_u32 s64, s79, 278528
    buffer_load_dwordx4 v6, s[24:27], s64 offen sc1 lds
    s_add_u32 m0, s65, 54272
    s_add_u32 s64, s79, 348160
    buffer_load_dwordx4 v6, s[24:27], s64 offen sc1 lds
    s_add_u32 s77, s77, 1
    s_cmp_eq_u32 s77, 12
    s_cselect_b32 s77, 0, s77
    s_waitcnt vmcnt(6)
    s_barrier
    s_mul_i32 s65, s63, 6144
    s_mul_i32 s66, s61, 69632
    s_lshl_b32 s79, s77, 2
    s_add_u32 s79, s79, s63
    s_lshl_b32 s79, s79, 10
    s_add_u32 s79, s79, s66
    s_add_u32 m0, s65, 0
    s_add_u32 s64, s79, 0
    buffer_load_dwordx4 v6, s[24:27], s64 offen sc1 lds
    s_add_u32 m0, s65, 1024
    s_add_u32 s64, s79, 69632
    buffer_load_dwordx4 v6, s[24:27], s64 offen sc1 lds
    s_add_u32 m0, s65, 2048
    s_add_u32 s64, s79, 139264
    buffer_load_dwordx4 v6, s[24:27], s64 offen sc1 lds
    s_add_u32 m0, s65, 3072
    s_add_u32 s64, s79, 208896
    buffer_load_dwordx4 v6, s[24:27], s64 offen sc1 lds
    s_add_u32 m0, s65, 4096
    s_add_u32 s64, s79, 278528
    buffer_load_dwordx4 v6, s[24:27], s64 offen sc1 lds
    s_add_u32 m0, s65, 5120
    s_add_u32 s64, s79, 348160
    buffer_load_dwordx4 v6, s[24:27], s64 offen sc1 lds
    s_add_u32 s77, s77, 1
    s_cmp_eq_u32 s77, 12
    s_cselect_b32 s77, 0, s77
    s_waitcnt vmcnt(6)
    s_barrier
    s_mul_i32 s65, s63, 6144
    s_mul_i32 s66, s61, 69632
    s_lshl_b32 s79, s77, 2
    s_add_u32 s79, s79, s63
    s_lshl_b32 s79, s79, 10
    s_add_u32 s79, s79, s66
    s_add_u32 m0, s65, 24576
    s_add_u32 s64, s79, 0
    buffer_load_dwordx4 v6, s[24:27], s64 offen sc1 lds
    s_add_u32 m0, s65, 25600
    s_add_u32 s64, s79, 69632
    buffer_load_dwordx4 v6, s[24:27], s64 offen sc1 lds
    s_add_u32 m0, s65, 26624
    s_add_u32 s64, s79, 139264
    buffer_load_dwordx4 v6, s[24:27], s64 offen sc1 lds
    s_add_u32 m0, s65, 27648
    s_add_u32 s64, s79, 208896
    buffer_load_dwordx4 v6, s[24:27], s64 offen sc1 lds
    s_add_u32 m0, s65, 28672
    s_add_u32 s64, s79, 278528
    buffer_load_dwordx4 v6, s[24:27], s64 offen sc1 lds
    s_add_u32 m0, s65, 29696
    s_add_u32 s64, s79, 348160
    buffer_load_dwordx4 v6, s[24:27], s64 offen sc1 lds
    s_add_u32 s77, s77, 1
    s_cmp_eq_u32 s77, 12
    s_cselect_b32 s77, 0, s77
    s_lshl_b32 s65, s63, 12
    s_lshl_b32 s66, s60, 7
    s_lshl_b32 s80, s78, 2
    s_add_u32 s80, s80, s63
    s_mul_i32 s80, s80, 40960
    s_add_u32 s80, s80, s66
    s_add_u32 m0, s65, 139264
    s_add_u32 s64, s80, 0
    buffer_load_dwordx4 v4, s[16:19], s64 offen lds
    s_add_u32 m0, s65, 140288
    s_add_u32 s64, s80, 10240
    buffer_load_dwordx4 v4, s[16:19], s64 offen lds
    s_add_u32 m0, s65, 141312
    s_add_u32 s64, s80, 20480
    buffer_load_dwordx4 v4, s[16:19], s64 offen lds
    s_add_u32 m0, s65, 142336
    s_add_u32 s64, s80, 30720
    buffer_load_dwordx4 v4, s[16:19], s64 offen lds
    s_add_u32 s78, s78, 1
    s_cmp_eq_u32 s78, 12
    s_cselect_b32 s78, 0, s78
    s_waitcnt vmcnt(10)
    s_barrier
    s_mul_i32 s65, s63, 6144
    s_mul_i32 s66, s61, 69632
    s_lshl_b32 s79, s77, 2
    s_add_u32 s79, s79, s63
    s_lshl_b32 s79, s79, 10
    s_add_u32 s79, s79, s66
    s_add_u32 m0, s65, 49152
    s_add_u32 s64, s79, 0
    buffer_load_dwordx4 v6, s[24:27], s64 offen sc1 lds
    s_add_u32 m0, s65, 50176
    s_add_u32 s64, s79, 69632
    buffer_load_dwordx4 v6, s[24:27], s64 offen sc1 lds
    s_add_u32 m0, s65, 51200
    s_add_u32 s64, s79, 139264
    buffer_load_dwordx4 v6, s[24:27], s64 offen sc1 lds
    s_add_u32 m0, s65, 52224
    s_add_u32 s64, s79, 208896
    buffer_load_dwordx4 v6, s[24:27], s64 offen sc1 lds
    s_add_u32 m0, s65, 53248
    s_add_u32 s64, s79, 278528
    buffer_load_dwordx4 v6, s[24:27], s64 offen sc1 lds
    s_add_u32 m0, s65, 54272
    s_add_u32 s64, s79, 348160
    buffer_load_dwordx4 v6, s[24:27], s64 offen sc1 lds
    s_add_u32 s77, s77, 1
    s_cmp_eq_u32 s77, 12
    s_cselect_b32 s77, 0, s77
    s_lshl_b32 s65, s63, 12
    s_lshl_b32 s66, s60, 7
    s_lshl_b32 s80, s78, 2
    s_add_u32 s80, s80, s63
    s_mul_i32 s80, s80, 40960
    s_add_u32 s80, s80, s66
    s_add_u32 m0, s65, 73728
    s_add_u32 s64, s80, 0
    buffer_load_dwordx4 v4, s[16:19], s64 offen lds
    s_add_u32 m0, s65, 74752
    s_add_u32 s64, s80, 10240
    buffer_load_dwordx4 v4, s[16:19], s64 offen lds
    s_add_u32 m0, s65, 75776
    s_add_u32 s64, s80, 20480
    buffer_load_dwordx4 v4, s[16:19], s64 offen lds
    s_add_u32 m0, s65, 76800
    s_add_u32 s64, s80, 30720
    buffer_load_dwordx4 v4, s[16:19], s64 offen lds
    s_add_u32 s78, s78, 1
    s_cmp_eq_u32 s78, 12
    s_cselect_b32 s78, 0, s78
    s_waitcnt vmcnt(14)
    s_barrier
    s_mul_i32 s65, s63, 6144
    s_mul_i32 s66, s61, 69632
    s_lshl_b32 s79, s77, 2
    s_add_u32 s79, s79, s63
    s_lshl_b32 s79, s79, 10
    s_add_u32 s79, s79, s66
    s_add_u32 m0, s65, 0
    s_add_u32 s64, s79, 0
    buffer_load_dwordx4 v6, s[24:27], s64 offen sc1 lds
    s_add_u32 m0, s65, 1024
    s_add_u32 s64, s79, 69632
    buffer_load_dwordx4 v6, s[24:27], s64 offen sc1 lds
    s_add_u32 m0, s65, 2048
    s_add_u32 s64, s79, 139264
    buffer_load_dwordx4 v6, s[24:27], s64 offen sc1 lds
    s_add_u32 m0, s65, 3072
    s_add_u32 s64, s79, 208896
    buffer_load_dwordx4 v6, s[24:27], s64 offen sc1 lds
    s_add_u32 m0, s65, 4096
    s_add_u32 s64, s79, 278528
    buffer_load_dwordx4 v6, s[24:27], s64 offen sc1 lds
    s_add_u32 m0, s65, 5120
    s_add_u32 s64, s79, 348160
    buffer_load_dwordx4 v6, s[24:27], s64 offen sc1 lds
    s_add_u32 s77, s77, 1
    s_cmp_eq_u32 s77, 12
    s_cselect_b32 s77, 0, s77
    s_lshl_b32 s65, s63, 12
    s_lshl_b32 s66, s60, 7
    s_lshl_b32 s80, s78, 2
    s_add_u32 s80, s80, s63
    s_mul_i32 s80, s80, 40960
    s_add_u32 s80, s80, s66
    s_add_u32 m0, s65, 90112
    s_add_u32 s64, s80, 0
    buffer_load_dwordx4 v4, s[16:19], s64 offen lds
    s_add_u32 m0, s65, 91136
    s_add_u32 s64, s80, 10240
    buffer_load_dwordx4 v4, s[16:19], s64 offen lds
    s_add_u32 m0, s65, 92160
    s_add_u32 s64, s80, 20480
    buffer_load_dwordx4 v4, s[16:19], s64 offen lds
    s_add_u32 m0, s65, 93184
    s_add_u32 s64, s80, 30720
    buffer_load_dwordx4 v4, s[16:19], s64 offen lds
    s_mov_b32 s78, s72
    s_waitcnt vmcnt(14)
    s_barrier
    s_mul_i32 s65, s63, 6144
    s_mul_i32 s66, s61, 69632
    s_lshl_b32 s79, s77, 2
    s_add_u32 s79, s79, s63
    s_lshl_b32 s79, s79, 10
    s_add_u32 s79, s79, s66
    s_add_u32 m0, s65, 24576
    s_add_u32 s64, s79, 0
    buffer_load_dwordx4 v6, s[24:27], s64 offen sc1 lds
    s_add_u32 m0, s65, 25600
    s_add_u32 s64, s79, 69632
    buffer_load_dwordx4 v6, s[24:27], s64 offen sc1 lds
    s_add_u32 m0, s65, 26624
    s_add_u32 s64, s79, 139264
    buffer_load_dwordx4 v6, s[24:27], s64 offen sc1 lds
    s_add_u32 m0, s65, 27648
    s_add_u32 s64, s79, 208896
    buffer_load_dwordx4 v6, s[24:27], s64 offen sc1 lds
    s_add_u32 m0, s65, 28672
    s_add_u32 s64, s79, 278528
    buffer_load_dwordx4 v6, s[24:27], s64 offen sc1 lds
    s_add_u32 m0, s65, 29696
    s_add_u32 s64, s79, 348160
    buffer_load_dwordx4 v6, s[24:27], s64 offen sc1 lds
    s_add_u32 s77, s77, 1
    s_cmp_eq_u32 s77, 12
    s_cselect_b32 s77, 0, s77
    s_lshl_b32 s65, s63, 12
    s_lshl_b32 s66, s60, 7
    s_mov_b32 s80, s63
    s_mul_i32 s80, s80, 204800
    s_add_u32 s80, s80, s66
    s_add_u32 m0, s65, 106496
    s_add_u32 s64, s80, 20480
    buffer_load_dwordx4 v5, s[20:23], s64 offen lds
    s_add_u32 m0, s65, 107520
    s_add_u32 s64, s80, 122880
    buffer_load_dwordx4 v5, s[20:23], s64 offen lds
    s_add_u32 m0, s65, 108544
    s_add_u32 s64, s80, 46080
    buffer_load_dwordx4 v5, s[20:23], s64 offen lds
    s_add_u32 m0, s65, 109568
    s_add_u32 s64, s80, 148480
    buffer_load_dwordx4 v5, s[20:23], s64 offen lds
    s_waitcnt vmcnt(14)
    s_barrier
    s_load_dword s57, s[42:43], s38 offset:0x800
    s_load_dword s101, s[42:43], s39 offset:0x800
    s_mul_i32 s65, s63, 6144
    s_mul_i32 s66, s61, 69632
    s_lshl_b32 s79, s77, 2
    s_add_u32 s79, s79, s63
    s_lshl_b32 s79, s79, 10
    s_add_u32 s79, s79, s66
    s_add_u32 m0, s65, 49152
    s_add_u32 s64, s79, 0
    buffer_load_dwordx4 v6, s[24:27], s64 offen sc1 lds
    s_add_u32 m0, s65, 50176
    s_add_u32 s64, s79, 69632
    buffer_load_dwordx4 v6, s[24:27], s64 offen sc1 lds
    s_add_u32 m0, s65, 51200
    s_add_u32 s64, s79, 139264
    buffer_load_dwordx4 v6, s[24:27], s64 offen sc1 lds
    s_add_u32 m0, s65, 52224
    s_add_u32 s64, s79, 208896
    buffer_load_dwordx4 v6, s[24:27], s64 offen sc1 lds
    s_add_u32 m0, s65, 53248
    s_add_u32 s64, s79, 278528
    buffer_load_dwordx4 v6, s[24:27], s64 offen sc1 lds
    s_add_u32 m0, s65, 54272
    s_add_u32 s64, s79, 348160
    buffer_load_dwordx4 v6, s[24:27], s64 offen sc1 lds
    s_mov_b32 s77, s72
    s_lshl_b32 s65, s63, 12
    s_lshl_b32 s66, s60, 7
    s_lshl_b32 s80, s78, 2
    s_add_u32 s80, s80, s63
    s_mul_i32 s80, s80, 51200
    s_add_u32 s80, s80, s66
    s_add_u32 m0, s65, 122880
    s_add_u32 s64, s80, 0
    buffer_load_dwordx4 v4, s[20:23], s64 offen lds
    s_add_u32 m0, s65, 123904
    s_add_u32 s64, s80, 10240
    buffer_load_dwordx4 v4, s[20:23], s64 offen lds
    s_add_u32 m0, s65, 124928
    s_add_u32 s64, s80, 25600
    buffer_load_dwordx4 v4, s[20:23], s64 offen lds
    s_add_u32 m0, s65, 125952
    s_add_u32 s64, s80, 35840
    buffer_load_dwordx4 v4, s[20:23], s64 offen lds
    s_add_u32 s78, s78, 1
    s_and_b32 s78, s78, 3
    s_waitcnt vmcnt(14)
    s_barrier
    s_lshl_b32 s65, s63, 12
    s_lshl_b32 s66, s60, 7
    s_lshl_b32 s80, s78, 2
    s_add_u32 s80, s80, s63
    s_mul_i32 s80, s80, 51200
    s_add_u32 s80, s80, s66
    s_add_u32 m0, s65, 139264
    s_add_u32 s64, s80, 0
    buffer_load_dwordx4 v4, s[20:23], s64 offen lds
    s_add_u32 m0, s65, 140288
    s_add_u32 s64, s80, 10240
    buffer_load_dwordx4 v4, s[20:23], s64 offen lds
    s_add_u32 m0, s65, 141312
    s_add_u32 s64, s80, 25600
    buffer_load_dwordx4 v4, s[20:23], s64 offen lds
    s_add_u32 m0, s65, 142336
    s_add_u32 s64, s80, 35840
    buffer_load_dwordx4 v4, s[20:23], s64 offen lds
    s_add_u32 s78, s78, 1
    s_and_b32 s78, s78, 3
    s_waitcnt lgkmcnt(0)
    s_cmp_lt_u32 s101, 8
    s_cbranch_scc1 L_chk_29
    s_cmp_ge_u32 s57, 8
    s_cbranch_scc1 L_chk_33
L_chk_29:
    s_cmp_eq_u32 s63, 0
    s_cbranch_scc1 L_chk_32
    v_mov_b32 v16, 158732
    s_mov_b32 s67, 4194304
L_lw_35:
    ds_read_b32 v17, v16
    s_sub_u32 s67, s67, 1
    s_cbranch_scc1 L_lw_36
    s_waitcnt lgkmcnt(0)
    v_cmp_eq_u32 vcc, 1, v17
    s_sleep 1
    s_cbranch_vccz L_lw_35
L_lw_36:
    s_branch L_chk_31
L_chk_32:
    s_mov_b32 s67, 65536
    s_add_u32 s64, s38, 0x918800
    v_mov_b32 v16, s64
    s_add_u32 s64, s39, 0x918800
    v_mov_b32 v17, s64
    s_mov_b64 exec, 1
L_chk_30:
    buffer_load_dword v18, v16, s[24:27], 0 offen sc1
    buffer_load_dword v19, v17, s[24:27], 0 offen sc1
    s_waitcnt vmcnt(0)
    v_cmp_le_u32 vcc, 8, v18
    v_cmp_le_u32 s[64:65], 8, v19
    s_nop 0
    s_and_b64 vcc, vcc, s[64:65]
    s_cbranch_vccnz L_chk_34
    s_sleep 6
    s_sub_u32 s67, s67, 1
    s_cbranch_scc0 L_chk_30
L_chk_34:
    s_mov_b64 exec, -1
L_chk_33:
    v_mov_b32 v16, 158732
    v_mov_b32 v17, 1
    ds_write_b32 v16, v17
L_chk_31:
    s_mul_i32 s65, s63, 6144
    s_mul_i32 s66, s61, 69632
    s_mov_b32 s79, s63
    s_lshl_b32 s79, s79, 10
    s_add_u32 s79, s79, s66
    s_add_u32 m0, s65, 0
    s_add_u32 s64, s79, 65536
    buffer_load_dwordx4 v6, s[24:27], s64 offen sc1 lds
    s_add_u32 m0, s65, 1024
    s_add_u32 s64, s79, 135168
    buffer_load_dwordx4 v6, s[24:27], s64 offen sc1 lds
    s_add_u32 m0, s65, 2048
    s_add_u32 s64, s79, 204800
    buffer_load_dwordx4 v6, s[24:27], s64 offen sc1 lds
    s_add_u32 m0, s65, 3072
    s_add_u32 s64, s79, 274432
    buffer_load_dwordx4 v6, s[24:27], s64 offen sc1 lds
    s_add_u32 m0, s65, 4096
    s_add_u32 s64, s79, 344064
    buffer_load_dwordx4 v6, s[24:27], s64 offen sc1 lds
    s_add_u32 m0, s65, 5120
    s_add_u32 s64, s79, 413696
    buffer_load_dwordx4 v6, s[24:27], s64 offen sc1 lds
    s_waitcnt vmcnt(14)
    s_barrier
    s_mul_i32 s65, s63, 6144
    s_mul_i32 s66, s61, 69632
    s_lshl_b32 s79, s77, 2
    s_add_u32 s79, s79, s63
    s_lshl_b32 s79, s79, 10
    s_add_u32 s79, s79, s66
    s_add_u32 m0, s65, 24576
    s_add_u32 s64, s79, 49152
    buffer_load_dwordx4 v6, s[24:27], s64 offen sc1 lds
    s_add_u32 m0, s65, 25600
    s_add_u32 s64, s79, 118784
    buffer_load_dwordx4 v6, s[24:27], s64 offen sc1 lds
    s_add_u32 m0, s65, 26624
    s_add_u32 s64, s79, 188416
    buffer_load_dwordx4 v6, s[24:27], s64 offen sc1 lds
    s_add_u32 m0, s65, 27648
    s_add_u32 s64, s79, 258048
    buffer_load_dwordx4 v6, s[24:27], s64 offen sc1 lds
    s_add_u32 m0, s65, 28672
    s_add_u32 s64, s79, 327680
    buffer_load_dwordx4 v6, s[24:27], s64 offen sc1 lds
    s_add_u32 m0, s65, 29696
    s_add_u32 s64, s79, 397312
    buffer_load_dwordx4 v6, s[24:27], s64 offen sc1 lds
    s_add_u32 s77, s77, 1
    s_and_b32 s77, s77, 3
    s_lshl_b32 s65, s63, 12
    s_lshl_b32 s66, s60, 7
    s_lshl_b32 s80, s78, 2
    s_add_u32 s80, s80, s63
    s_mul_i32 s80, s80, 51200
    s_add_u32 s80, s80, s66
    s_add_u32 m0, s65, 73728
    s_add_u32 s64, s80, 0
    buffer_load_dwordx4 v4, s[20:23], s64 offen lds
    s_add_u32 m0, s65, 74752
    s_add_u32 s64, s80, 10240
    buffer_load_dwordx4 v4, s[20:23], s64 offen lds
    s_add_u32 m0, s65, 75776
    s_add_u32 s64, s80, 25600
    buffer_load_dwordx4 v4, s[20:23], s64 offen lds
    s_add_u32 m0, s65, 76800
    s_add_u32 s64, s80, 35840
    buffer_load_dwordx4 v4, s[20:23], s64 offen lds
    s_add_u32 s78, s78, 1
    s_and_b32 s78, s78, 3
    s_waitcnt vmcnt(10)
    s_barrier
    s_mul_i32 s65, s63, 6144
    s_mul_i32 s66, s61, 69632
    s_lshl_b32 s79, s77, 2
    s_add_u32 s79, s79, s63
    s_lshl_b32 s79, s79, 10
    s_add_u32 s79, s79, s66
    s_add_u32 m0, s65, 49152
    s_add_u32 s64, s79, 49152
    buffer_load_dwordx4 v6, s[24:27], s64 offen sc1 lds
    s_add_u32 m0, s65, 50176
    s_add_u32 s64, s79, 118784
    buffer_load_dwordx4 v6, s[24:27], s64 offen sc1 lds
    s_add_u32 m0, s65, 51200
    s_add_u32 s64, s79, 188416
    buffer_load_dwordx4 v6, s[24:27], s64 offen sc1 lds
    s_add_u32 m0, s65, 52224
    s_add_u32 s64, s79, 258048
    buffer_load_dwordx4 v6, s[24:27], s64 offen sc1 lds
    s_add_u32 m0, s65, 53248
    s_add_u32 s64, s79, 327680
    buffer_load_dwordx4 v6, s[24:27], s64 offen sc1 lds
    s_add_u32 m0, s65, 54272
    s_add_u32 s64, s79, 397312
    buffer_load_dwordx4 v6, s[24:27], s64 offen sc1 lds
    s_add_u32 s77, s77, 1
    s_and_b32 s77, s77, 3
    s_lshl_b32 s65, s63, 12
    s_lshl_b32 s66, s60, 7
    s_lshl_b32 s80, s78, 2
    s_add_u32 s80, s80, s63
    s_mul_i32 s80, s80, 51200
    s_add_u32 s80, s80, s66
    s_add_u32 m0, s65, 90112
    s_add_u32 s64, s80, 0
    buffer_load_dwordx4 v4, s[20:23], s64 offen lds
    s_add_u32 m0, s65, 91136
    s_add_u32 s64, s80, 10240
    buffer_load_dwordx4 v4, s[20:23], s64 offen lds
    s_add_u32 m0, s65, 92160
    s_add_u32 s64, s80, 25600
    buffer_load_dwordx4 v4, s[20:23], s64 offen lds
    s_add_u32 m0, s65, 93184
    s_add_u32 s64, s80, 35840
    buffer_load_dwordx4 v4, s[20:23], s64 offen lds
    s_add_u32 s78, s78, 1
    s_and_b32 s78, s78, 3
    s_waitcnt vmcnt(14)
    s_barrier
    s_mul_i32 s65, s63, 6144
    s_mul_i32 s66, s61, 69632
    s_lshl_b32 s79, s77, 2
    s_add_u32 s79, s79, s63
    s_lshl_b32 s79, s79, 10
    s_add_u32 s79, s79, s66
    s_add_u32 m0, s65, 0
    s_add_u32 s64, s79, 49152
    buffer_load_dwordx4 v6, s[24:27], s64 offen sc1 lds
    s_add_u32 m0, s65, 1024
    s_add_u32 s64, s79, 118784
    buffer_load_dwordx4 v6, s[24:27], s64 offen sc1 lds
    s_add_u32 m0, s65, 2048
    s_add_u32 s64, s79, 188416
    buffer_load_dwordx4 v6, s[24:27], s64 offen sc1 lds
    s_add_u32 m0, s65, 3072
    s_add_u32 s64, s79, 258048
    buffer_load_dwordx4 v6, s[24:27], s64 offen sc1 lds
    s_add_u32 m0, s65, 4096
    s_add_u32 s64, s79, 327680
    buffer_load_dwordx4 v6, s[24:27], s64 offen sc1 lds
    s_add_u32 m0, s65, 5120
    s_add_u32 s64, s79, 397312
    buffer_load_dwordx4 v6, s[24:27], s64 offen sc1 lds
    s_add_u32 s77, s77, 1
    s_and_b32 s77, s77, 3
    s_mul_i32 s66, s61, 20480
    s_lshl_b32 s65, s60, 7
    s_add_u32 s66, s66, s65
    s_mul_i32 s65, s63, 10240
    s_add_u32 s66, s66, s65
    s_add_u32 m0, s75, 106496
    s_add_u32 s64, s66, 0
    buffer_load_dwordx4 v4, s[8:11], s64 offen lds
    s_add_u32 m0, s75, 110592
    s_add_u32 s64, s66, 40960
    buffer_load_dwordx4 v4, s[8:11], s64 offen lds
    s_add_u32 m0, s75, 114688
    s_add_u32 s64, s66, 81920
    buffer_load_dwordx4 v4, s[8:11], s64 offen lds
    s_waitcnt vmcnt(13)
    s_barrier
    s_mul_i32 s65, s63, 6144
    s_mul_i32 s66, s61, 69632
    s_lshl_b32 s79, s77, 2
    s_add_u32 s79, s79, s63
    s_lshl_b32 s79, s79, 10
    s_add_u32 s79, s79, s66
    s_add_u32 m0, s65, 24576
    s_add_u32 s64, s79, 49152
    buffer_load_dwordx4 v6, s[24:27], s64 offen sc1 lds
    s_add_u32 m0, s65, 25600
    s_add_u32 s64, s79, 118784
    buffer_load_dwordx4 v6, s[24:27], s64 offen sc1 lds
    s_add_u32 m0, s65, 26624
    s_add_u32 s64, s79, 188416
    buffer_load_dwordx4 v6, s[24:27], s64 offen sc1 lds
    s_add_u32 m0, s65, 27648
    s_add_u32 s64, s79, 258048
    buffer_load_dwordx4 v6, s[24:27], s64 offen sc1 lds
    s_add_u32 m0, s65, 28672
    s_add_u32 s64, s79, 327680
    buffer_load_dwordx4 v6, s[24:27], s64 offen sc1 lds
    s_add_u32 m0, s65, 29696
    s_add_u32 s64, s79, 397312
    buffer_load_dwordx4 v6, s[24:27], s64 offen sc1 lds
    s_add_u32 s77, s77, 1
    s_and_b32 s77, s77, 3
    s_waitcnt vmcnt(9)
    s_barrier
    s_waitcnt vmcnt(0)
    s_waitcnt vmcnt(0)
    s_barrier
    v_mov_b32 v7, v4
    s_branch L_final_F
L_loader_Q:
    s_lshl_b32 s64, s63, 6
    v_add_u32 v1, s64, v0
    v_mul_u32_u24 v3, 2185, v1
    v_lshrrev_b32 v3, 16, v3
    v_mul_u32_u24 v8, 30, v3
    v_sub_u32 v1, v1, v8
    v_mul_u32_u24 v8, 26, v1
    v_lshrrev_b32 v8, 8, v8
    v_mul_u32_u24 v8, 1120, v8
    v_mul_u32_u24 v3, 3840, v3
    v_lshl_add_u32 v3, v1, 4, v3
    v_add_u32 v3, v3, v8
    s_cmp_eq_u32 s63, 3
    s_cselect_b32 s82, 0xffff, -1
    s_mov_b32 s12, s38
    s_mov_b32 s13, s39
    s_mov_b32 s14, 0x258000
    s_mov_b32 s15, 0x20000
    s_mov_b32 s81, s62
    s_mul_i32 s74, s56, 160
    s_mul_i32 s64, s62, 245760
    s_add_u32 s74, s74, s64
    s_mov_b32 exec_hi, s82
    s_add_u32 m0, s75, 16384
    s_add_u32 s64, s74, 0
    buffer_load_dwordx4 v3, s[12:15], s64 offen lds
    s_add_u32 m0, s75, 20608
    s_add_u32 s64, s74, 30720
    buffer_load_dwordx4 v3, s[12:15], s64 offen lds
    s_add_u32 m0, s75, 24576
    s_add_u32 s64, s74, 61440
    buffer_load_dwordx4 v3, s[12:15], s64 offen lds
    s_add_u32 m0, s75, 28800
    s_add_u32 s64, s74, 92160
    buffer_load_dwordx4 v3, s[12:15], s64 offen lds
    s_add_u32 m0, s75, 32768
    s_add_u32 s64, s74, 122880
    buffer_load_dwordx4 v3, s[12:15], s64 offen lds
    s_add_u32 m0, s75, 36992
    s_add_u32 s64, s74, 153600
    buffer_load_dwordx4 v3, s[12:15], s64 offen lds
    s_add_u32 m0, s75, 40960
    s_add_u32 s64, s74, 184320
    buffer_load_dwordx4 v3, s[12:15], s64 offen lds
    s_add_u32 m0, s75, 45184
    s_add_u32 s64, s74, 215040
    buffer_load_dwordx4 v3, s[12:15], s64 offen lds
    s_mov_b32 exec_hi, -1
    s_add_u32 s62, s62, 1
    s_cmp_eq_u32 s62, 10
    s_cselect_b32 s62, 0, s62
    s_mul_i32 s73, s55, 163840
    s_lshl_b32 s64, s62, 7
    s_add_u32 s73, s73, s64
    s_add_u32 m0, s75, 49152
    s_add_u32 s64, s73, 0
    buffer_load_dwordx4 v2, s[8:11], s64 offen lds
    s_add_u32 m0, s75, 53248
    s_add_u32 s64, s73, 40960
    buffer_load_dwordx4 v2, s[8:11], s64 offen lds
    s_add_u32 m0, s75, 57344
    s_add_u32 s64, s73, 81920
    buffer_load_dwordx4 v2, s[8:11], s64 offen lds
    s_add_u32 m0, s75, 61440
    s_add_u32 s64, s73, 122880
    buffer_load_dwordx4 v2, s[8:11], s64 offen lds
    s_setprio 0
    s_mov_b32 s16, s46
    s_mov_b32 s17, s47
    s_mov_b32 s18, 0x1e0000
    s_mov_b32 s19, 0x20000
    s_mov_b32 s20, s40
    s_mov_b32 s21, s41
    s_mov_b32 s22, 0xc8000
    s_mov_b32 s23, 0x20000
    s_mov_b32 s24, s52
    s_mov_b32 s25, s53
    s_mov_b32 s26, 0xb00000
    s_mov_b32 s27, 0x20000
    s_mov_b32 s28, s48
    s_mov_b32 s29, s49
    s_mov_b32 s30, 0x280000
    s_mov_b32 s31, 0x20000
    s_mov_b32 s32, s50
    s_mov_b32 s33, s51
    s_mov_b32 s34, 0x100
    s_mov_b32 s35, 0x20000
    s_lshr_b32 s64, s70, 1
    s_and_b32 s65, s70, 1
    s_add_u32 s65, s65, 6
    s_sub_u32 s66, s70, 3
    s_sub_u32 s67, s70, 8
    s_cmp_ge_u32 s70, 11
    s_cselect_b32 s66, s67, s66
    s_cselect_b32 s67, 4, 3
    s_cmp_ge_u32 s70, 6
    s_cselect_b32 s64, s67, s64
    s_cselect_b32 s65, s66, s65
    s_lshl_b32 s65, s65, 2
    s_mul_i32 s60, s59, 5
    s_add_u32 s60, s60, s64
    s_lshl_b32 s61, s58, 5
    s_add_u32 s61, s61, s65
    s_lshl_b32 s66, s64, 2
    s_lshr_b32 s67, 0xA2840, s66
    s_and_b32 s67, s67, 15
    s_add_u32 s71, s67, s59
    s_and_b32 s72, s60, 3
    v_lshrrev_b32 v1, 4, v0
    v_lshlrev_b32 v1, 1, v1
    v_xor_b32 v1, v1, v0
    v_and_b32 v1, 7, v1
    v_lshlrev_b32 v1, 4, v1
    v_lshrrev_b32 v4, 3, v0
    v_mul_u32_u24 v4, 1280, v4
    v_add_u32 v4, v4, v1
    v_lshrrev_b32 v1, 5, v0
    v_mul_u32_u24 v1, 46080, v1
    v_add_u32 v5, v4, v1
    v_lshlrev_b32 v6, 4, v0
    s_add_u32 s42, s52, 0x918000
    s_addc_u32 s43, s53, 0
    s_lshl_b32 s36, s55, 7
    s_lshl_b32 s37, s56, 7
    s_lshr_b32 s64, s61, 3
    s_lshl_b32 s38, s64, 7
    s_add_u32 s64, s61, 3
    s_lshr_b32 s64, s64, 3
    s_lshl_b32 s39, s64, 7
    s_mov_b32 s67, 0x40000000
    s_cmp_eq_u32 s63, 0
    s_cselect_b32 s67, 0x918000, s67
    v_mov_b32 v7, 0x40000000
    s_add_u32 s64, s67, s37
    s_add_u32 s64, s64, 7168
    v_mov_b32 v1, s64
    v_cmp_eq_u32 vcc, 0, v0
    s_nop 1
    v_cndmask_b32 v10, v7, v1, vcc
    s_lshl_b32 s64, s63, 6
    v_add_u32 v1, s64, v0
    v_lshlrev_b32 v15, 4, v1
    s_mul_i32 s65, s56, 55296
    s_add_u32 s65, s65, 0x8a8000
    v_add_u32 v15, s65, v15
    v_cmp_gt_u32 vcc, 210, v1
    s_nop 1
    v_cndmask_b32 v15, v7, v15, vcc
    s_mul_i32 s100, s56, 10240
    s_add_u32 s100, s100, 0x894000
    v_and_b32 v16, 0xe0, v1
    v_and_b32_e64 v17, 7, v1
    v_lshl_add_u32 v16, v17, 2, v16
    v_bfe_u32 v17, v1, 3, 2
    v_add_u32_e64 v16, v16, v17
    v_lshl_add_u32 v16, v16, 2, s100
    v_cmp_gt_u32 vcc, 240, v1
    s_nop 1
    v_cndmask_b32 v13, v7, v16, vcc
    v_lshlrev_b32_e64 v1, 2, v1
    v_add_u32 v14, 157696, v1
    v_mov_b32 v1, 158720
    v_mov_b32 v16, 0
    v_mov_b32 v17, 0
    v_mov_b32 v18, 0
    v_mov_b32 v19, 0
    ds_write_b128 v1, v[16:19]
    ds_write_b128 v1, v[16:19] offset:16
    ds_write_b128 v1, v[16:19] offset:32
    s_mov_b32 s77, s71
    s_mov_b32 s78, s71
    s_waitcnt vmcnt(4)
    s_waitcnt lgkmcnt(0)
    s_barrier
    s_mul_i32 s74, s56, 160
    s_mul_i32 s64, s62, 245760
    s_add_u32 s74, s74, s64
    s_mov_b32 exec_hi, s82
    s_add_u32 m0, s75, 65536
    s_add_u32 s64, s74, 0
    buffer_load_dwordx4 v3, s[12:15], s64 offen lds
    s_add_u32 m0, s75, 69760
    s_add_u32 s64, s74, 30720
    buffer_load_dwordx4 v3, s[12:15], s64 offen lds
    s_add_u32 m0, s75, 73728
    s_add_u32 s64, s74, 61440
    buffer_load_dwordx4 v3, s[12:15], s64 offen lds
    s_add_u32 m0, s75, 77952
    s_add_u32 s64, s74, 92160
    buffer_load_dwordx4 v3, s[12:15], s64 offen lds
    s_add_u32 m0, s75, 81920
    s_add_u32 s64, s74, 122880
    buffer_load_dwordx4 v3, s[12:15], s64 offen lds
    s_add_u32 m0, s75, 86144
    s_add_u32 s64, s74, 153600
    buffer_load_dwordx4 v3, s[12:15], s64 offen lds
    s_add_u32 m0, s75, 90112
    s_add_u32 s64, s74, 184320
    buffer_load_dwordx4 v3, s[12:15], s64 offen lds
    s_add_u32 m0, s75, 94336
    s_add_u32 s64, s74, 215040
    buffer_load_dwordx4 v3, s[12:15], s64 offen lds
    s_mov_b32 exec_hi, -1
    s_add_u32 s62, s62, 1
    s_cmp_eq_u32 s62, 10
    s_cselect_b32 s62, 0, s62
    s_mul_i32 s73, s55, 163840
    s_lshl_b32 s64, s62, 7
    s_add_u32 s73, s73, s64
    s_add_u32 m0, s75, 98304
    s_add_u32 s64, s73, 0
    buffer_load_dwordx4 v2, s[8:11], s64 offen lds
    s_add_u32 m0, s75, 102400
    s_add_u32 s64, s73, 40960
    buffer_load_dwordx4 v2, s[8:11], s64 offen lds
    s_add_u32 m0, s75, 106496
    s_add_u32 s64, s73, 81920
    buffer_load_dwordx4 v2, s[8:11], s64 offen lds
    s_add_u32 m0, s75, 110592
    s_add_u32 s64, s73, 122880
    buffer_load_dwordx4 v2, s[8:11], s64 offen lds
    v_mov_b32 v20, 0x40000000
    s_bitcmp0_b32 0x3ff, s55
    s_cbranch_scc1 L_cs_37
    s_cmp_ge_u32 s63, 2
    s_cbranch_scc1 L_cs_37
    v_and_b32 v1, 15, v0
    v_lshrrev_b32 v16, 4, v0
    s_lshl_b32 s64, s81, 10
    s_add_u32 s64, s64, s100
    s_cmp_lg_u32 s63, 0
    s_cbranch_scc1 L_cs_39
    v_min_u32 v17, 15, v1
    s_add_u32 s64, s64, 0
    s_mov_b32 s65, 4
    v_mul_u32_u24 v18, 480, v16
    v_lshl_add_u32 v18, v17, 4, v18
    v_add_u32 v22, 16384, v18
    ds_read_b128 v[64:67], v22 offset:0
    ds_read_b128 v[68:71], v22 offset:1920
    ds_read_b128 v[72:75], v22 offset:4224
    ds_read_b128 v[76:79], v22 offset:6144
    ds_read_b128 v[80:83], v22 offset:8192
    ds_read_b128 v[84:87], v22 offset:10112
    ds_read_b128 v[88:91], v22 offset:12416
    ds_read_b128 v[92:95], v22 offset:14336
    ds_read_b128 v[96:99], v22 offset:16384
    ds_read_b128 v[100:103], v22 offset:18304
    ds_read_b128 v[104:107], v22 offset:20608
    ds_read_b128 v[108:111], v22 offset:22528
    ds_read_b128 v[112:115], v22 offset:24576
    ds_read_b128 v[116:119], v22 offset:26496
    ds_read_b128 v[120:123], v22 offset:28800
    ds_read_b128 v[124:127], v22 offset:30720
    s_branch L_cs_38
L_cs_39:
    v_min_u32 v17, 13, v1
    s_add_u32 s64, s64, 512
    s_mov_b32 s65, 4
    v_mul_u32_u24 v18, 480, v16
    v_lshl_add_u32 v18, v17, 4, v18
    v_add_u32 v22, 16640, v18
    ds_read_b128 v[64:67], v22 offset:0
    ds_read_b128 v[68:71], v22 offset:1920
    ds_read_b128 v[72:75], v22 offset:4224
    ds_read_b128 v[76:79], v22 offset:6144
    ds_read_b128 v[80:83], v22 offset:8192
    ds_read_b128 v[84:87], v22 offset:10112
    ds_read_b128 v[88:91], v22 offset:12416
    ds_read_b128 v[92:95], v22 offset:14336
    ds_read_b128 v[96:99], v22 offset:16384
    ds_read_b128 v[100:103], v22 offset:18304
    ds_read_b128 v[104:107], v22 offset:20608
    ds_read_b128 v[108:111], v22 offset:22528
    ds_read_b128 v[112:115], v22 offset:24576
    ds_read_b128 v[116:119], v22 offset:26496
    ds_read_b128 v[120:123], v22 offset:28800
    ds_read_b128 v[124:127], v22 offset:30720
L_cs_40:
L_cs_38:
    v_lshlrev_b32 v17, 3, v16
    v_and_b32 v18, 7, v0
    v_add_u32 v17, v17, v18
    v_lshl_add_u32 v17, v17, 4, s64
    v_cmp_gt_u32 vcc, 8, v1
    s_nop 1
    v_cndmask_b32 v17, v20, v17, vcc
    v_cmp_gt_u32 vcc, s65, v16
    s_nop 1
    v_cndmask_b32 v20, v20, v17, vcc
    v_lshrrev_b32 v60, 1, v1
    v_and_b32 v1, 1, v1
    v_lshlrev_b32 v1, 4, v1
    v_mov_b32 v61, 0x3f80
    v_lshlrev_b32 v61, v1, v61
    v_mov_b32 v62, 0
    v_cmp_eq_u32 vcc, 0, v60
    s_nop 1
    v_cndmask_b32 v16, v62, v61, vcc
    v_cmp_eq_u32 vcc, 1, v60
    s_nop 1
    v_cndmask_b32 v17, v62, v61, vcc
    v_cmp_eq_u32 vcc, 2, v60
    s_nop 1
    v_cndmask_b32 v18, v62, v61, vcc
    v_cmp_eq_u32 vcc, 3, v60
    s_nop 1
    v_cndmask_b32 v19, v62, v61, vcc
    s_waitcnt lgkmcnt(0)
    s_nop 0
    v_mfma_f32_16x16x32_bf16 v[60:63], v[64:67], v[16:19], 0
    v_mfma_f32_16x16x32_bf16 v[60:63], v[68:71], v[16:19], v[60:63]
    v_mfma_f32_16x16x32_bf16 v[60:63], v[72:75], v[16:19], v[60:63]
    v_mfma_f32_16x16x32_bf16 v[60:63], v[76:79], v[16:19], v[60:63]
    v_mfma_f32_16x16x32_bf16 v[60:63], v[80:83], v[16:19], v[60:63]
    v_mfma_f32_16x16x32_bf16 v[60:63], v[84:87], v[16:19], v[60:63]
    v_mfma_f32_16x16x32_bf16 v[60:63], v[88:91], v[16:19], v[60:63]
    v_mfma_f32_16x16x32_bf16 v[60:63], v[92:95], v[16:19], v[60:63]
    v_mfma_f32_16x16x32_bf16 v[60:63], v[96:99], v[16:19], v[60:63]
    v_mfma_f32_16x16x32_bf16 v[60:63], v[100:103], v[16:19], v[60:63]
    v_mfma_f32_16x16x32_bf16 v[60:63], v[104:107], v[16:19], v[60:63]
    v_mfma_f32_16x16x32_bf16 v[60:63], v[108:111], v[16:19], v[60:63]
    v_mfma_f32_16x16x32_bf16 v[60:63], v[112:115], v[16:19], v[60:63]
    v_mfma_f32_16x16x32_bf16 v[60:63], v[116:119], v[16:19], v[60:63]
    v_mfma_f32_16x16x32_bf16 v[60:63], v[120:123], v[16:19], v[60:63]
    v_mfma_f32_16x16x32_bf16 v[60:63], v[124:127], v[16:19], v[60:63]
L_cs_37:
    s_nop 7
    buffer_store_dwordx4 v[60:63], v20, s[24:27], 0 offen sc1
    v_mov_b32 v16, -1
    v_mov_b32 v17, -1
    v_mov_b32 v18, -1
    v_mov_b32 v19, -1
    s_mul_i32 s64, s55, 3456
    buffer_store_dwordx4 v[16:19], v15, s[24:27], s64 offen sc1
    s_waitcnt vmcnt(6)
    s_barrier
    s_load_dword s57, s[50:51], 0x0
    s_mul_i32 s74, s56, 160
    s_mul_i32 s64, s62, 245760
    s_add_u32 s74, s74, s64
    s_mov_b32 exec_hi, s82
    s_add_u32 m0, s75, 114688
    s_add_u32 s64, s74, 0
    buffer_load_dwordx4 v3, s[12:15], s64 offen lds
    s_add_u32 m0, s75, 118912
    s_add_u32 s64, s74, 30720
    buffer_load_dwordx4 v3, s[12:15], s64 offen lds
    s_add_u32 m0, s75, 122880
    s_add_u32 s64, s74, 61440
    buffer_load_dwordx4 v3, s[12:15], s64 offen lds
    s_add_u32 m0, s75, 127104
    s_add_u32 s64, s74, 92160
    buffer_load_dwordx4 v3, s[12:15], s64 offen lds
    s_add_u32 m0, s75, 131072
    s_add_u32 s64, s74, 122880
    buffer_load_dwordx4 v3, s[12:15], s64 offen lds
    s_add_u32 m0, s75, 135296
    s_add_u32 s64, s74, 153600
    buffer_load_dwordx4 v3, s[12:15], s64 offen lds
    s_add_u32 m0, s75, 139264
    s_add_u32 s64, s74, 184320
    buffer_load_dwordx4 v3, s[12:15], s64 offen lds
    s_add_u32 m0, s75, 143488
    s_add_u32 s64, s74, 215040
    buffer_load_dwordx4 v3, s[12:15], s64 offen lds
    s_mov_b32 exec_hi, -1
    s_add_u32 s62, s62, 1
    s_cmp_eq_u32 s62, 10
    s_cselect_b32 s62, 0, s62
    s_mul_i32 s73, s55, 163840
    s_lshl_b32 s64, s62, 7
    s_add_u32 s73, s73, s64
    s_add_u32 m0, s75, 0
    s_add_u32 s64, s73, 0
    buffer_load_dwordx4 v2, s[8:11], s64 offen lds
    s_add_u32 m0, s75, 4096
    s_add_u32 s64, s73, 40960
    buffer_load_dwordx4 v2, s[8:11], s64 offen lds
    s_add_u32 m0, s75, 8192
    s_add_u32 s64, s73, 81920
    buffer_load_dwordx4 v2, s[8:11], s64 offen lds
    s_add_u32 m0, s75, 12288
    s_add_u32 s64, s73, 122880
    buffer_load_dwordx4 v2, s[8:11], s64 offen lds
    s_mul_i32 s74, s56, 160
    s_mul_i32 s64, s62, 245760
    s_add_u32 s74, s74, s64
    s_mov_b32 exec_hi, s82
    s_add_u32 m0, s75, 16384
    s_add_u32 s64, s74, 0
    buffer_load_dwordx4 v3, s[12:15], s64 offen lds
    s_add_u32 m0, s75, 20608
    s_add_u32 s64, s74, 30720
    buffer_load_dwordx4 v3, s[12:15], s64 offen lds
    s_add_u32 m0, s75, 24576
    s_add_u32 s64, s74, 61440
    buffer_load_dwordx4 v3, s[12:15], s64 offen lds
    s_add_u32 m0, s75, 28800
    s_add_u32 s64, s74, 92160
    buffer_load_dwordx4 v3, s[12:15], s64 offen lds
    s_add_u32 m0, s75, 32768
    s_add_u32 s64, s74, 122880
    buffer_load_dwordx4 v3, s[12:15], s64 offen lds
    s_add_u32 m0, s75, 36992
    s_add_u32 s64, s74, 153600
    buffer_load_dwordx4 v3, s[12:15], s64 offen lds
    s_add_u32 m0, s75, 40960
    s_add_u32 s64, s74, 184320
    buffer_load_dwordx4 v3, s[12:15], s64 offen lds
    s_add_u32 m0, s75, 45184
    s_add_u32 s64, s74, 215040
    buffer_load_dwordx4 v3, s[12:15], s64 offen lds
    s_mov_b32 exec_hi, -1
    s_add_u32 s62, s62, 1
    s_cmp_eq_u32 s62, 10
    s_cselect_b32 s62, 0, s62
    s_waitcnt vmcnt(12)
    s_waitcnt lgkmcnt(0)
    s_cmp_ge_u32 s57, 4
    s_cbranch_scc1 L_chk_45
L_chk_41:
    s_cmp_eq_u32 s63, 0
    s_cbranch_scc1 L_chk_44
    v_mov_b32 v16, 158752
    s_mov_b32 s67, 4194304
L_lw_47:
    ds_read_b32 v17, v16
    s_sub_u32 s67, s67, 1
    s_cbranch_scc1 L_lw_48
    s_waitcnt lgkmcnt(0)
    v_cmp_eq_u32 vcc, 1, v17
    s_sleep 1
    s_cbranch_vccz L_lw_47
L_lw_48:
    s_branch L_chk_43
L_chk_44:
    s_mov_b32 s67, 65536
    v_mov_b32 v16, 0
    s_mov_b64 exec, 1
L_chk_42:
    buffer_load_dword v18, v16, s[32:35], 0 offen sc1
    s_waitcnt vmcnt(0)
    v_cmp_le_u32 vcc, 4, v18
    s_cbranch_vccnz L_chk_46
    s_sleep 6
    s_sub_u32 s67, s67, 1
    s_cbranch_scc0 L_chk_42
L_chk_46:
    s_mov_b64 exec, -1
L_chk_45:
    v_mov_b32 v16, 158752
    v_mov_b32 v17, 1
    ds_write_b32 v16, v17
L_chk_43:
    s_barrier
    v_mov_b32 v8, 1
    buffer_atomic_add v8, v10, s[24:27], 0 offen
    s_mul_i32 s73, s55, 163840
    s_lshl_b32 s64, s62, 7
    s_add_u32 s73, s73, s64
    s_add_u32 m0, s75, 49152
    s_add_u32 s64, s73, 0
    buffer_load_dwordx4 v2, s[8:11], s64 offen lds
    s_add_u32 m0, s75, 53248
    s_add_u32 s64, s73, 40960
    buffer_load_dwordx4 v2, s[8:11], s64 offen lds
    s_add_u32 m0, s75, 57344
    s_add_u32 s64, s73, 81920
    buffer_load_dwordx4 v2, s[8:11], s64 offen lds
    s_add_u32 m0, s75, 61440
    s_add_u32 s64, s73, 122880
    buffer_load_dwordx4 v2, s[8:11], s64 offen lds
    s_mul_i32 s74, s56, 160
    s_mul_i32 s64, s62, 245760
    s_add_u32 s74, s74, s64
    s_mov_b32 exec_hi, s82
    s_add_u32 m0, s75, 65536
    s_add_u32 s64, s74, 0
    buffer_load_dwordx4 v3, s[12:15], s64 offen lds
    s_add_u32 m0, s75, 69760
    s_add_u32 s64, s74, 30720
    buffer_load_dwordx4 v3, s[12:15], s64 offen lds
    s_add_u32 m0, s75, 73728
    s_add_u32 s64, s74, 61440
    buffer_load_dwordx4 v3, s[12:15], s64 offen lds
    s_add_u32 m0, s75, 77952
    s_add_u32 s64, s74, 92160
    buffer_load_dwordx4 v3, s[12:15], s64 offen lds
    s_add_u32 m0, s75, 81920
    s_add_u32 s64, s74, 122880
    buffer_load_dwordx4 v3, s[12:15], s64 offen lds
    s_add_u32 m0, s75, 86144
    s_add_u32 s64, s74, 153600
    buffer_load_dwordx4 v3, s[12:15], s64 offen lds
    s_add_u32 m0, s75, 90112
    s_add_u32 s64, s74, 184320
    buffer_load_dwordx4 v3, s[12:15], s64 offen lds
    s_add_u32 m0, s75, 94336
    s_add_u32 s64, s74, 215040
    buffer_load_dwordx4 v3, s[12:15], s64 offen lds
    s_mov_b32 exec_hi, -1
    s_add_u32 s62, s62, 1
    s_cmp_eq_u32 s62, 10
    s_cselect_b32 s62, 0, s62
    s_waitcnt vmcnt(13)
    s_barrier
    s_mul_i32 s73, s55, 163840
    s_lshl_b32 s64, s62, 7
    s_add_u32 s73, s73, s64
    s_add_u32 m0, s75, 98304
    s_add_u32 s64, s73, 0
    buffer_load_dwordx4 v2, s[8:11], s64 offen lds
    s_add_u32 m0, s75, 102400
    s_add_u32 s64, s73, 40960
    buffer_load_dwordx4 v2, s[8:11], s64 offen lds
    s_add_u32 m0, s75, 106496
    s_add_u32 s64, s73, 81920
    buffer_load_dwordx4 v2, s[8:11], s64 offen lds
    s_add_u32 m0, s75, 110592
    s_add_u32 s64, s73, 122880
    buffer_load_dwordx4 v2, s[8:11], s64 offen lds
    s_mul_i32 s74, s56, 160
    s_mul_i32 s64, s62, 245760
    s_add_u32 s74, s74, s64
    s_mov_b32 exec_hi, s82
    s_add_u32 m0, s75, 114688
    s_add_u32 s64, s74, 0
    buffer_load_dwordx4 v3, s[12:15], s64 offen lds
    s_add_u32 m0, s75, 118912
    s_add_u32 s64, s74, 30720
    buffer_load_dwordx4 v3, s[12:15], s64 offen lds
    s_add_u32 m0, s75, 122880
    s_add_u32 s64, s74, 61440
    buffer_load_dwordx4 v3, s[12:15], s64 offen lds
    s_add_u32 m0, s75, 127104
    s_add_u32 s64, s74, 92160
    buffer_load_dwordx4 v3, s[12:15], s64 offen lds
    s_add_u32 m0, s75, 131072
    s_add_u32 s64, s74, 122880
    buffer_load_dwordx4 v3, s[12:15], s64 offen lds
    s_add_u32 m0, s75, 135296
    s_add_u32 s64, s74, 153600
    buffer_load_dwordx4 v3, s[12:15], s64 offen lds
    s_add_u32 m0, s75, 139264
    s_add_u32 s64, s74, 184320
    buffer_load_dwordx4 v3, s[12:15], s64 offen lds
    s_add_u32 m0, s75, 143488
    s_add_u32 s64, s74, 215040
    buffer_load_dwordx4 v3, s[12:15], s64 offen lds
    s_mov_b32 exec_hi, -1
    s_add_u32 s62, s62, 1
    s_cmp_eq_u32 s62, 10
    s_cselect_b32 s62, 0, s62
    s_waitcnt vmcnt(12)
    s_barrier
    s_mul_i32 s73, s55, 163840
    s_lshl_b32 s64, s62, 7
    s_add_u32 s73, s73, s64
    s_add_u32 m0, s75, 0
    s_add_u32 s64, s73, 0
    buffer_load_dwordx4 v2, s[8:11], s64 offen lds
    s_add_u32 m0, s75, 4096
    s_add_u32 s64, s73, 40960
    buffer_load_dwordx4 v2, s[8:11], s64 offen lds
    s_add_u32 m0, s75, 8192
    s_add_u32 s64, s73, 81920
    buffer_load_dwordx4 v2, s[8:11], s64 offen lds
    s_add_u32 m0, s75, 12288
    s_add_u32 s64, s73, 122880
    buffer_load_dwordx4 v2, s[8:11], s64 offen lds
    s_mul_i32 s74, s56, 160
    s_mul_i32 s64, s62, 245760
    s_add_u32 s74, s74, s64
    s_mov_b32 exec_hi, s82
    s_add_u32 m0, s75, 16384
    s_add_u32 s64, s74, 0
    buffer_load_dwordx4 v3, s[12:15], s64 offen lds
    s_add_u32 m0, s75, 20608
    s_add_u32 s64, s74, 30720
    buffer_load_dwordx4 v3, s[12:15], s64 offen lds
    s_add_u32 m0, s75, 24576
    s_add_u32 s64, s74, 61440
    buffer_load_dwordx4 v3, s[12:15], s64 offen lds
    s_add_u32 m0, s75, 28800
    s_add_u32 s64, s74, 92160
    buffer_load_dwordx4 v3, s[12:15], s64 offen lds
    s_add_u32 m0, s75, 32768
    s_add_u32 s64, s74, 122880
    buffer_load_dwordx4 v3, s[12:15], s64 offen lds
    s_add_u32 m0, s75, 36992
    s_add_u32 s64, s74, 153600
    buffer_load_dwordx4 v3, s[12:15], s64 offen lds
    s_add_u32 m0, s75, 40960
    s_add_u32 s64, s74, 184320
    buffer_load_dwordx4 v3, s[12:15], s64 offen lds
    s_add_u32 m0, s75, 45184
    s_add_u32 s64, s74, 215040
    buffer_load_dwordx4 v3, s[12:15], s64 offen lds
    s_mov_b32 exec_hi, -1
    s_add_u32 s62, s62, 1
    s_cmp_eq_u32 s62, 10
    s_cselect_b32 s62, 0, s62
    s_waitcnt vmcnt(12)
    s_barrier
    s_mul_i32 s73, s55, 163840
    s_lshl_b32 s64, s62, 7
    s_add_u32 s73, s73, s64
    s_add_u32 m0, s75, 49152
    s_add_u32 s64, s73, 0
    buffer_load_dwordx4 v2, s[8:11], s64 offen lds
    s_add_u32 m0, s75, 53248
    s_add_u32 s64, s73, 40960
    buffer_load_dwordx4 v2, s[8:11], s64 offen lds
    s_add_u32 m0, s75, 57344
    s_add_u32 s64, s73, 81920
    buffer_load_dwordx4 v2, s[8:11], s64 offen lds
    s_add_u32 m0, s75, 61440
    s_add_u32 s64, s73, 122880
    buffer_load_dwordx4 v2, s[8:11], s64 offen lds
    s_mul_i32 s74, s56, 160
    s_mul_i32 s64, s62, 245760
    s_add_u32 s74, s74, s64
    s_mov_b32 exec_hi, s82
    s_add_u32 m0, s75, 65536
    s_add_u32 s64, s74, 0
    buffer_load_dwordx4 v3, s[12:15], s64 offen lds
    s_add_u32 m0, s75, 69760
    s_add_u32 s64, s74, 30720
    buffer_load_dwordx4 v3, s[12:15], s64 offen lds
    s_add_u32 m0, s75, 73728
    s_add_u32 s64, s74, 61440
    buffer_load_dwordx4 v3, s[12:15], s64 offen lds
    s_add_u32 m0, s75, 77952
    s_add_u32 s64, s74, 92160
    buffer_load_dwordx4 v3, s[12:15], s64 offen lds
    s_add_u32 m0, s75, 81920
    s_add_u32 s64, s74, 122880
    buffer_load_dwordx4 v3, s[12:15], s64 offen lds
    s_add_u32 m0, s75, 86144
    s_add_u32 s64, s74, 153600
    buffer_load_dwordx4 v3, s[12:15], s64 offen lds
    s_add_u32 m0, s75, 90112
    s_add_u32 s64, s74, 184320
    buffer_load_dwordx4 v3, s[12:15], s64 offen lds
    s_add_u32 m0, s75, 94336
    s_add_u32 s64, s74, 215040
    buffer_load_dwordx4 v3, s[12:15], s64 offen lds
    s_mov_b32 exec_hi, -1
    s_add_u32 s62, s62, 1
    s_cmp_eq_u32 s62, 10
    s_cselect_b32 s62, 0, s62
    s_waitcnt vmcnt(12)
    s_barrier
    s_mul_i32 s73, s55, 163840
    s_lshl_b32 s64, s62, 7
    s_add_u32 s73, s73, s64
    s_add_u32 m0, s75, 98304
    s_add_u32 s64, s73, 0
    buffer_load_dwordx4 v2, s[8:11], s64 offen lds
    s_add_u32 m0, s75, 102400
    s_add_u32 s64, s73, 40960
    buffer_load_dwordx4 v2, s[8:11], s64 offen lds
    s_add_u32 m0, s75, 106496
    s_add_u32 s64, s73, 81920
    buffer_load_dwordx4 v2, s[8:11], s64 offen lds
    s_add_u32 m0, s75, 110592
    s_add_u32 s64, s73, 122880
    buffer_load_dwordx4 v2, s[8:11], s64 offen lds
    s_mul_i32 s74, s56, 160
    s_mul_i32 s64, s62, 245760
    s_add_u32 s74, s74, s64
    s_mov_b32 exec_hi, s82
    s_add_u32 m0, s75, 114688
    s_add_u32 s64, s74, 0
    buffer_load_dwordx4 v3, s[12:15], s64 offen lds
    s_add_u32 m0, s75, 118912
    s_add_u32 s64, s74, 30720
    buffer_load_dwordx4 v3, s[12:15], s64 offen lds
    s_add_u32 m0, s75, 122880
    s_add_u32 s64, s74, 61440
    buffer_load_dwordx4 v3, s[12:15], s64 offen lds
    s_add_u32 m0, s75, 127104
    s_add_u32 s64, s74, 92160
    buffer_load_dwordx4 v3, s[12:15], s64 offen lds
    s_add_u32 m0, s75, 131072
    s_add_u32 s64, s74, 122880
    buffer_load_dwordx4 v3, s[12:15], s64 offen lds
    s_add_u32 m0, s75, 135296
    s_add_u32 s64, s74, 153600
    buffer_load_dwordx4 v3, s[12:15], s64 offen lds
    s_add_u32 m0, s75, 139264
    s_add_u32 s64, s74, 184320
    buffer_load_dwordx4 v3, s[12:15], s64 offen lds
    s_add_u32 m0, s75, 143488
    s_add_u32 s64, s74, 215040
    buffer_load_dwordx4 v3, s[12:15], s64 offen lds
    s_mov_b32 exec_hi, -1
    s_add_u32 s62, s62, 1
    s_cmp_eq_u32 s62, 10
    s_cselect_b32 s62, 0, s62
    s_waitcnt vmcnt(12)
    s_barrier
    s_load_dword s57, s[42:43], s37 offset:0x1c00
    s_load_dword s101, s[42:43], s36 offset:0x1000
    s_mul_i32 s73, s55, 163840
    s_lshl_b32 s64, s62, 7
    s_add_u32 s73, s73, s64
    s_add_u32 m0, s75, 0
    s_add_u32 s64, s73, 0
    buffer_load_dwordx4 v2, s[8:11], s64 offen lds
    s_add_u32 m0, s75, 4096
    s_add_u32 s64, s73, 40960
    buffer_load_dwordx4 v2, s[8:11], s64 offen lds
    s_add_u32 m0, s75, 8192
    s_add_u32 s64, s73, 81920
    buffer_load_dwordx4 v2, s[8:11], s64 offen lds
    s_add_u32 m0, s75, 12288
    s_add_u32 s64, s73, 122880
    buffer_load_dwordx4 v2, s[8:11], s64 offen lds
    s_mul_i32 s74, s56, 160
    s_mul_i32 s64, s62, 245760
    s_add_u32 s74, s74, s64
    s_mov_b32 exec_hi, s82
    s_add_u32 m0, s75, 16384
    s_add_u32 s64, s74, 0
    buffer_load_dwordx4 v3, s[12:15], s64 offen lds
    s_add_u32 m0, s75, 20608
    s_add_u32 s64, s74, 30720
    buffer_load_dwordx4 v3, s[12:15], s64 offen lds
    s_add_u32 m0, s75, 24576
    s_add_u32 s64, s74, 61440
    buffer_load_dwordx4 v3, s[12:15], s64 offen lds
    s_add_u32 m0, s75, 28800
    s_add_u32 s64, s74, 92160
    buffer_load_dwordx4 v3, s[12:15], s64 offen lds
    s_add_u32 m0, s75, 32768
    s_add_u32 s64, s74, 122880
    buffer_load_dwordx4 v3, s[12:15], s64 offen lds
    s_add_u32 m0, s75, 36992
    s_add_u32 s64, s74, 153600
    buffer_load_dwordx4 v3, s[12:15], s64 offen lds
    s_add_u32 m0, s75, 40960
    s_add_u32 s64, s74, 184320
    buffer_load_dwordx4 v3, s[12:15], s64 offen lds
    s_add_u32 m0, s75, 45184
    s_add_u32 s64, s74, 215040
    buffer_load_dwordx4 v3, s[12:15], s64 offen lds
    s_mov_b32 exec_hi, -1
    s_add_u32 s62, s62, 1
    s_cmp_eq_u32 s62, 10
    s_cselect_b32 s62, 0, s62
    s_waitcnt vmcnt(12)
    s_barrier
    s_waitcnt lgkmcnt(0)
    s_cmp_lt_u32 s101, 8
    s_cbranch_scc1 L_chk_49
    s_cmp_ge_u32 s57, 16
    s_cbranch_scc1 L_chk_53
L_chk_49:
    s_cmp_eq_u32 s63, 0
    s_cbranch_scc1 L_chk_52
    v_mov_b32 v16, 158756
    s_mov_b32 s67, 4194304
L_lw_55:
    ds_read_b32 v17, v16
    s_sub_u32 s67, s67, 1
    s_cbranch_scc1 L_lw_56
    s_waitcnt lgkmcnt(0)
    v_cmp_eq_u32 vcc, 1, v17
    s_sleep 1
    s_cbranch_vccz L_lw_55
L_lw_56:
    s_branch L_chk_51
L_chk_52:
    s_mov_b32 s67, 65536
    s_add_u32 s64, s37, 0x919c00
    v_mov_b32 v16, s64
    s_add_u32 s64, s36, 0x919000
    v_mov_b32 v17, s64
    s_mov_b64 exec, 1
L_chk_50:
    buffer_load_dword v18, v16, s[24:27], 0 offen sc1
    buffer_load_dword v19, v17, s[24:27], 0 offen sc1
    s_waitcnt vmcnt(0)
    v_cmp_le_u32 vcc, 16, v18
    v_cmp_le_u32 s[64:65], 8, v19
    s_nop 0
    s_and_b64 vcc, vcc, s[64:65]
    s_cbranch_vccnz L_chk_54
    s_sleep 6
    s_sub_u32 s67, s67, 1
    s_cbranch_scc0 L_chk_50
L_chk_54:
    s_mov_b64 exec, -1
L_chk_53:
    v_mov_b32 v16, 158756
    v_mov_b32 v17, 1
    ds_write_b32 v16, v17
L_chk_51:
    s_lshl_b32 s66, s55, 11
    s_lshl_b32 s65, s63, 9
    s_add_u32 s66, s66, s65
    s_mov_b32 exec_hi, 0
    s_add_u32 m0, s65, 155648
    s_add_u32 s64, s66, 9568256
    buffer_load_dwordx4 v6, s[24:27], s64 offen sc1 lds
    s_mov_b64 exec, -1
    s_mov_b32 s64, 0
    buffer_load_dword v32, v13, s[24:27], s64 offen offset:0 sc1
    buffer_load_dword v33, v13, s[24:27], s64 offen offset:1024 sc1
    buffer_load_dword v34, v13, s[24:27], s64 offen offset:2048 sc1
    buffer_load_dword v35, v13, s[24:27], s64 offen offset:3072 sc1
    s_mov_b32 s64, 4096
    buffer_load_dword v36, v13, s[24:27], s64 offen offset:0 sc1
    buffer_load_dword v37, v13, s[24:27], s64 offen offset:1024 sc1
    buffer_load_dword v38, v13, s[24:27], s64 offen offset:2048 sc1
    buffer_load_dword v39, v13, s[24:27], s64 offen offset:3072 sc1
    s_mov_b32 s64, 8192
    buffer_load_dword v40, v13, s[24:27], s64 offen offset:0 sc1
    buffer_load_dword v41, v13, s[24:27], s64 offen offset:1024 sc1
    s_waitcnt vmcnt(11)
    s_barrier
    s_waitcnt vmcnt(0)
    v_add_f32 v32, v32, v37
    v_add_f32 v33, v33, v38
    v_add_f32 v34, v34, v39
    v_add_f32 v35, v35, v40
    v_add_f32 v36, v36, v41
    v_add_f32 v32, v32, v33
    v_add_f32 v34, v34, v35
    v_add_f32 v32, v32, v34
    v_add_f32 v32, v32, v36
    ds_write_b32 v14, v32
    s_waitcnt lgkmcnt(0)
    s_barrier
    s_lshl_b32 s65, s63, 12
    s_lshl_b32 s66, s60, 7
    s_lshl_b32 s80, s78, 2
    s_add_u32 s80, s80, s63
    s_mul_i32 s80, s80, 40960
    s_add_u32 s80, s80, s66
    s_add_u32 m0, s65, 49152
    s_add_u32 s64, s80, 0
    buffer_load_dwordx4 v4, s[16:19], s64 offen lds
    s_add_u32 m0, s65, 50176
    s_add_u32 s64, s80, 10240
    buffer_load_dwordx4 v4, s[16:19], s64 offen lds
    s_add_u32 m0, s65, 51200
    s_add_u32 s64, s80, 20480
    buffer_load_dwordx4 v4, s[16:19], s64 offen lds
    s_add_u32 m0, s65, 52224
    s_add_u32 s64, s80, 30720
    buffer_load_dwordx4 v4, s[16:19], s64 offen lds
    s_add_u32 s78, s78, 1
    s_cmp_eq_u32 s78, 12
    s_cselect_b32 s78, 0, s78
    s_lshl_b32 s65, s63, 12
    s_lshl_b32 s66, s60, 7
    s_lshl_b32 s80, s78, 2
    s_add_u32 s80, s80, s63
    s_mul_i32 s80, s80, 40960
    s_add_u32 s80, s80, s66
    s_add_u32 m0, s65, 65536
    s_add_u32 s64, s80, 0
    buffer_load_dwordx4 v4, s[16:19], s64 offen lds
    s_add_u32 m0, s65, 66560
    s_add_u32 s64, s80, 10240
    buffer_load_dwordx4 v4, s[16:19], s64 offen lds
    s_add_u32 m0, s65, 67584
    s_add_u32 s64, s80, 20480
    buffer_load_dwordx4 v4, s[16:19], s64 offen lds
    s_add_u32 m0, s65, 68608
    s_add_u32 s64, s80, 30720
    buffer_load_dwordx4 v4, s[16:19], s64 offen lds
    s_add_u32 s78, s78, 1
    s_cmp_eq_u32 s78, 12
    s_cselect_b32 s78, 0, s78
    s_lshl_b32 s65, s63, 12
    s_lshl_b32 s66, s60, 7
    s_lshl_b32 s80, s78, 2
    s_add_u32 s80, s80, s63
    s_mul_i32 s80, s80, 40960
    s_add_u32 s80, s80, s66
    s_add_u32 m0, s65, 81920
    s_add_u32 s64, s80, 0
    buffer_load_dwordx4 v4, s[16:19], s64 offen lds
    s_add_u32 m0, s65, 82944
    s_add_u32 s64, s80, 10240
    buffer_load_dwordx4 v4, s[16:19], s64 offen lds
    s_add_u32 m0, s65, 83968
    s_add_u32 s64, s80, 20480
    buffer_load_dwordx4 v4, s[16:19], s64 offen lds
    s_add_u32 m0, s65, 84992
    s_add_u32 s64, s80, 30720
    buffer_load_dwordx4 v4, s[16:19], s64 offen lds
    s_add_u32 s78, s78, 1
    s_cmp_eq_u32 s78, 12
    s_cselect_b32 s78, 0, s78
    s_lshl_b32 s65, s63, 12
    s_lshl_b32 s66, s60, 7
    s_lshl_b32 s80, s78, 2
    s_add_u32 s80, s80, s63
    s_mul_i32 s80, s80, 40960
    s_add_u32 s80, s80, s66
    s_add_u32 m0, s65, 98304
    s_add_u32 s64, s80, 0
    buffer_load_dwordx4 v4, s[16:19], s64 offen lds
    s_add_u32 m0, s65, 99328
    s_add_u32 s64, s80, 10240
    buffer_load_dwordx4 v4, s[16:19], s64 offen lds
    s_add_u32 m0, s65, 100352
    s_add_u32 s64, s80, 20480
    buffer_load_dwordx4 v4, s[16:19], s64 offen lds
    s_add_u32 m0, s65, 101376
    s_add_u32 s64, s80, 30720
    buffer_load_dwordx4 v4, s[16:19], s64 offen lds
    s_add_u32 s78, s78, 1
    s_cmp_eq_u32 s78, 12
    s_cselect_b32 s78, 0, s78
    s_lshl_b32 s65, s63, 12
    s_lshl_b32 s66, s60, 7
    s_lshl_b32 s80, s78, 2
    s_add_u32 s80, s80, s63
    s_mul_i32 s80, s80, 40960
    s_add_u32 s80, s80, s66
    s_add_u32 m0, s65, 114688
    s_add_u32 s64, s80, 0
    buffer_load_dwordx4 v4, s[16:19], s64 offen lds
    s_add_u32 m0, s65, 115712
    s_add_u32 s64, s80, 10240
    buffer_load_dwordx4 v4, s[16:19], s64 offen lds
    s_add_u32 m0, s65, 116736
    s_add_u32 s64, s80, 20480
    buffer_load_dwordx4 v4, s[16:19], s64 offen lds
    s_add_u32 m0, s65, 117760
    s_add_u32 s64, s80, 30720
    buffer_load_dwordx4 v4, s[16:19], s64 offen lds
    s_add_u32 s78, s78, 1
    s_cmp_eq_u32 s78, 12
    s_cselect_b32 s78, 0, s78
    s_lshl_b32 s65, s63, 12
    s_lshl_b32 s66, s60, 7
    s_lshl_b32 s80, s78, 2
    s_add_u32 s80, s80, s63
    s_mul_i32 s80, s80, 40960
    s_add_u32 s80, s80, s66
    s_add_u32 m0, s65, 131072
    s_add_u32 s64, s80, 0
    buffer_load_dwordx4 v4, s[16:19], s64 offen lds
    s_add_u32 m0, s65, 132096
    s_add_u32 s64, s80, 10240
    buffer_load_dwordx4 v4, s[16:19], s64 offen lds
    s_add_u32 m0, s65, 133120
    s_add_u32 s64, s80, 20480
    buffer_load_dwordx4 v4, s[16:19], s64 offen lds
    s_add_u32 m0, s65, 134144
    s_add_u32 s64, s80, 30720
    buffer_load_dwordx4 v4, s[16:19], s64 offen lds
    s_add_u32 s78, s78, 1
    s_cmp_eq_u32 s78, 12
    s_cselect_b32 s78, 0, s78
    v_and_b32 v1, 15, v0
    v_lshrrev_b32 v16, 4, v0
    v_and_b32 v17, 1, v1
    v_lshlrev_b32 v17, 4, v17
    v_mov_b32 v18, 0x3f80
    v_lshlrev_b32 v18, v17, v18
    v_lshrrev_b32 v17, 1, v1
    v_lshlrev_b32 v19, 2, v16
    v_sub_u32 v17, v17, v19
    v_mov_b32 v19, 0
    v_cmp_eq_u32 vcc, 0, v17
    s_nop 1
    v_cndmask_b32 v44, v19, v18, vcc
    v_cmp_eq_u32 vcc, 1, v17
    s_nop 1
    v_cndmask_b32 v45, v19, v18, vcc
    v_cmp_eq_u32 vcc, 2, v17
    s_nop 1
    v_cndmask_b32 v46, v19, v18, vcc
    v_cmp_eq_u32 vcc, 3, v17
    s_nop 1
    v_cndmask_b32 v47, v19, v18, vcc
    v_cmp_eq_u32 vcc, -8, v17
    s_nop 1
    v_cndmask_b32 v48, v19, v18, vcc
    v_cmp_eq_u32 vcc, -7, v17
    s_nop 1
    v_cndmask_b32 v49, v19, v18, vcc
    v_cmp_eq_u32 vcc, -6, v17
    s_nop 1
    v_cndmask_b32 v50, v19, v18, vcc
    v_cmp_eq_u32 vcc, -5, v17
    s_nop 1
    v_cndmask_b32 v51, v19, v18, vcc
    v_lshrrev_b32 v17, 1, v16
    v_lshl_add_u32 v1, v17, 4, v1
    v_and_b32 v16, 1, v16
    v_lshlrev_b32 v16, 3, v16
    s_lshl_b32 s64, s63, 10
    s_add_u32 s64, s64, 158976
    v_lshl_add_u32 v1, v1, 4, s64
    v_add_u32 v43, v1, v16
    v_mov_b32 v16, 158724
    s_mov_b32 s67, 4194304
L_lw_57:
    ds_read_b32 v17, v16
    s_sub_u32 s67, s67, 1
    s_cbranch_scc1 L_lw_58
    s_waitcnt lgkmcnt(0)
    v_cmp_eq_u32 vcc, 4, v17
    s_sleep 1
    s_cbranch_vccz L_lw_57
L_lw_58:
    s_lshl_b32 s64, s55, 1
    s_add_u32 s64, s64, 0
    s_and_b32 s64, s64, 15
    s_mul_i32 s64, s64, 3456
    buffer_load_dwordx4 v[128:131], v15, s[24:27], s64 offen sc1
    s_lshl_b32 s64, s55, 1
    s_add_u32 s64, s64, 1
    s_and_b32 s64, s64, 15
    s_mul_i32 s64, s64, 3456
    buffer_load_dwordx4 v[132:135], v15, s[24:27], s64 offen sc1
    s_lshl_b32 s64, s55, 1
    s_add_u32 s64, s64, 2
    s_and_b32 s64, s64, 15
    s_mul_i32 s64, s64, 3456
    buffer_load_dwordx4 v[136:139], v15, s[24:27], s64 offen sc1
    s_lshl_b32 s64, s55, 1
    s_add_u32 s64, s64, 3
    s_and_b32 s64, s64, 15
    s_mul_i32 s64, s64, 3456
    buffer_load_dwordx4 v[140:143], v15, s[24:27], s64 offen sc1
    s_lshl_b32 s64, s55, 1
    s_add_u32 s64, s64, 4
    s_and_b32 s64, s64, 15
    s_mul_i32 s64, s64, 3456
    buffer_load_dwordx4 v[144:147], v15, s[24:27], s64 offen sc1
    s_lshl_b32 s64, s55, 1
    s_add_u32 s64, s64, 5
    s_and_b32 s64, s64, 15
    s_mul_i32 s64, s64, 3456
    buffer_load_dwordx4 v[148:151], v15, s[24:27], s64 offen sc1
    s_lshl_b32 s64, s55, 1
    s_add_u32 s64, s64, 6
    s_and_b32 s64, s64, 15
    s_mul_i32 s64, s64, 3456
    buffer_load_dwordx4 v[152:155], v15, s[24:27], s64 offen sc1
    s_lshl_b32 s64, s55, 1
    s_add_u32 s64, s64, 7
    s_and_b32 s64, s64, 15
    s_mul_i32 s64, s64, 3456
    buffer_load_dwordx4 v[156:159], v15, s[24:27], s64 offen sc1
    s_lshl_b32 s64, s55, 1
    s_add_u32 s64, s64, 8
    s_and_b32 s64, s64, 15
    s_mul_i32 s64, s64, 3456
    buffer_load_dwordx4 v[160:163], v15, s[24:27], s64 offen sc1
    s_lshl_b32 s64, s55, 1
    s_add_u32 s64, s64, 9
    s_and_b32 s64, s64, 15
    s_mul_i32 s64, s64, 3456
    buffer_load_dwordx4 v[164:167], v15, s[24:27], s64 offen sc1
    s_lshl_b32 s64, s55, 1
    s_add_u32 s64, s64, 10
    s_and_b32 s64, s64, 15
    s_mul_i32 s64, s64, 3456
    buffer_load_dwordx4 v[168:171], v15, s[24:27], s64 offen sc1
    s_lshl_b32 s64, s55, 1
    s_add_u32 s64, s64, 11
    s_and_b32 s64, s64, 15
    s_mul_i32 s64, s64, 3456
    buffer_load_dwordx4 v[172:175], v15, s[24:27], s64 offen sc1
    s_lshl_b32 s64, s55, 1
    s_add_u32 s64, s64, 12
    s_and_b32 s64, s64, 15
    s_mul_i32 s64, s64, 3456
    buffer_load_dwordx4 v[176:179], v15, s[24:27], s64 offen sc1
    s_lshl_b32 s64, s55, 1
    s_add_u32 s64, s64, 13
    s_and_b32 s64, s64, 15
    s_mul_i32 s64, s64, 3456
    buffer_load_dwordx4 v[180:183], v15, s[24:27], s64 offen sc1
    s_lshl_b32 s64, s55, 1
    s_add_u32 s64, s64, 14
    s_and_b32 s64, s64, 15
    s_mul_i32 s64, s64, 3456
    buffer_load_dwordx4 v[184:187], v15, s[24:27], s64 offen sc1
    s_lshl_b32 s64, s55, 1
    s_add_u32 s64, s64, 15
    s_and_b32 s64, s64, 15
    s_mul_i32 s64, s64, 3456
    buffer_load_dwordx4 v[188:191], v15, s[24:27], s64 offen sc1
    s_waitcnt vmcnt(28)
    s_barrier
    s_barrier
    s_setprio 3
    s_waitcnt vmcnt(0)
    s_mov_b32 s67, 65536
    s_mov_b32 s83, 1
L_kvlook:
    s_mov_b32 s66, 0
    v_cmp_eq_u32 vcc, -1, v128
    s_cbranch_vccz L_kv_59
    s_mov_b32 s66, 1
    s_lshl_b32 s64, s55, 1
    s_add_u32 s64, s64, 0
    s_and_b32 s64, s64, 15
    s_mul_i32 s64, s64, 3456
    buffer_load_dwordx4 v[128:131], v15, s[24:27], s64 offen sc1
L_kv_59:
    v_cmp_eq_u32 vcc, -1, v132
    s_cbranch_vccz L_kv_60
    s_mov_b32 s66, 1
    s_lshl_b32 s64, s55, 1
    s_add_u32 s64, s64, 1
    s_and_b32 s64, s64, 15
    s_mul_i32 s64, s64, 3456
    buffer_load_dwordx4 v[132:135], v15, s[24:27], s64 offen sc1
L_kv_60:
    v_cmp_eq_u32 vcc, -1, v136
    s_cbranch_vccz L_kv_61
    s_mov_b32 s66, 1
    s_lshl_b32 s64, s55, 1
    s_add_u32 s64, s64, 2
    s_and_b32 s64, s64, 15
    s_mul_i32 s64, s64, 3456
    buffer_load_dwordx4 v[136:139], v15, s[24:27], s64 offen sc1
L_kv_61:
    v_cmp_eq_u32 vcc, -1, v140
    s_cbranch_vccz L_kv_62
    s_mov_b32 s66, 1
    s_lshl_b32 s64, s55, 1
    s_add_u32 s64, s64, 3
    s_and_b32 s64, s64, 15
    s_mul_i32 s64, s64, 3456
    buffer_load_dwordx4 v[140:143], v15, s[24:27], s64 offen sc1
L_kv_62:
    v_cmp_eq_u32 vcc, -1, v144
    s_cbranch_vccz L_kv_63
    s_mov_b32 s66, 1
    s_lshl_b32 s64, s55, 1
    s_add_u32 s64, s64, 4
    s_and_b32 s64, s64, 15
    s_mul_i32 s64, s64, 3456
    buffer_load_dwordx4 v[144:147], v15, s[24:27], s64 offen sc1
L_kv_63:
    v_cmp_eq_u32 vcc, -1, v148
    s_cbranch_vccz L_kv_64
    s_mov_b32 s66, 1
    s_lshl_b32 s64, s55, 1
    s_add_u32 s64, s64, 5
    s_and_b32 s64, s64, 15
    s_mul_i32 s64, s64, 3456
    buffer_load_dwordx4 v[148:151], v15, s[24:27], s64 offen sc1
L_kv_64:
    v_cmp_eq_u32 vcc, -1, v152
    s_cbranch_vccz L_kv_65
    s_mov_b32 s66, 1
    s_lshl_b32 s64, s55, 1
    s_add_u32 s64, s64, 6
    s_and_b32 s64, s64, 15
    s_mul_i32 s64, s64, 3456
    buffer_load_dwordx4 v[152:155], v15, s[24:27], s64 offen sc1
L_kv_65:
    v_cmp_eq_u32 vcc, -1, v156
    s_cbranch_vccz L_kv_66
    s_mov_b32 s66, 1
    s_lshl_b32 s64, s55, 1
    s_add_u32 s64, s64, 7
    s_and_b32 s64, s64, 15
    s_mul_i32 s64, s64, 3456
    buffer_load_dwordx4 v[156:159], v15, s[24:27], s64 offen sc1
L_kv_66:
    v_cmp_eq_u32 vcc, -1, v160
    s_cbranch_vccz L_kv_67
    s_mov_b32 s66, 1
    s_lshl_b32 s64, s55, 1
    s_add_u32 s64, s64, 8
    s_and_b32 s64, s64, 15
    s_mul_i32 s64, s64, 3456
    buffer_load_dwordx4 v[160:163], v15, s[24:27], s64 offen sc1
L_kv_67:
    v_cmp_eq_u32 vcc, -1, v164
    s_cbranch_vccz L_kv_68
    s_mov_b32 s66, 1
    s_lshl_b32 s64, s55, 1
    s_add_u32 s64, s64, 9
    s_and_b32 s64, s64, 15
    s_mul_i32 s64, s64, 3456
    buffer_load_dwordx4 v[164:167], v15, s[24:27], s64 offen sc1
L_kv_68:
    v_cmp_eq_u32 vcc, -1, v168
    s_cbranch_vccz L_kv_69
    s_mov_b32 s66, 1
    s_lshl_b32 s64, s55, 1
    s_add_u32 s64, s64, 10
    s_and_b32 s64, s64, 15
    s_mul_i32 s64, s64, 3456
    buffer_load_dwordx4 v[168:171], v15, s[24:27], s64 offen sc1
L_kv_69:
    v_cmp_eq_u32 vcc, -1, v172
    s_cbranch_vccz L_kv_70
    s_mov_b32 s66, 1
    s_lshl_b32 s64, s55, 1
    s_add_u32 s64, s64, 11
    s_and_b32 s64, s64, 15
    s_mul_i32 s64, s64, 3456
    buffer_load_dwordx4 v[172:175], v15, s[24:27], s64 offen sc1
L_kv_70:
    v_cmp_eq_u32 vcc, -1, v176
    s_cbranch_vccz L_kv_71
    s_mov_b32 s66, 1
    s_lshl_b32 s64, s55, 1
    s_add_u32 s64, s64, 12
    s_and_b32 s64, s64, 15
    s_mul_i32 s64, s64, 3456
    buffer_load_dwordx4 v[176:179], v15, s[24:27], s64 offen sc1
L_kv_71:
    v_cmp_eq_u32 vcc, -1, v180
    s_cbranch_vccz L_kv_72
    s_mov_b32 s66, 1
    s_lshl_b32 s64, s55, 1
    s_add_u32 s64, s64, 13
    s_and_b32 s64, s64, 15
    s_mul_i32 s64, s64, 3456
    buffer_load_dwordx4 v[180:183], v15, s[24:27], s64 offen sc1
L_kv_72:
    v_cmp_eq_u32 vcc, -1, v184
    s_cbranch_vccz L_kv_73
    s_mov_b32 s66, 1
    s_lshl_b32 s64, s55, 1
    s_add_u32 s64, s64, 14
    s_and_b32 s64, s64, 15
    s_mul_i32 s64, s64, 3456
    buffer_load_dwordx4 v[184:187], v15, s[24:27], s64 offen sc1
L_kv_73:
    v_cmp_eq_u32 vcc, -1, v188
    s_cbranch_vccz L_kv_74
    s_mov_b32 s66, 1
    s_lshl_b32 s64, s55, 1
    s_add_u32 s64, s64, 15
    s_and_b32 s64, s64, 15
    s_mul_i32 s64, s64, 3456
    buffer_load_dwordx4 v[188:191], v15, s[24:27], s64 offen sc1
L_kv_74:
    s_cmp_eq_u32 s83, 0
    s_cbranch_scc1 L_kvnext
    s_mov_b32 s83, s66
    s_lshl_b32 s65, s63, 12
    s_lshl_b32 s66, s60, 7
    s_lshl_b32 s80, s78, 2
    s_add_u32 s80, s80, s63
    s_mul_i32 s80, s80, 40960
    s_add_u32 s80, s80, s66
    s_add_u32 m0, s65, 49152
    s_add_u32 s64, s80, 0
    buffer_load_dwordx4 v4, s[16:19], s64 offen lds
    s_add_u32 m0, s65, 50176
    s_add_u32 s64, s80, 10240
    buffer_load_dwordx4 v4, s[16:19], s64 offen lds
    s_add_u32 m0, s65, 51200
    s_add_u32 s64, s80, 20480
    buffer_load_dwordx4 v4, s[16:19], s64 offen lds
    s_add_u32 m0, s65, 52224
    s_add_u32 s64, s80, 30720
    buffer_load_dwordx4 v4, s[16:19], s64 offen lds
    s_add_u32 s78, s78, 1
    s_cmp_eq_u32 s78, 12
    s_cselect_b32 s78, 0, s78
    s_lshl_b32 s65, s63, 12
    s_lshl_b32 s66, s60, 7
    s_lshl_b32 s80, s78, 2
    s_add_u32 s80, s80, s63
    s_mul_i32 s80, s80, 40960
    s_add_u32 s80, s80, s66
    s_add_u32 m0, s65, 65536
    s_add_u32 s64, s80, 0
    buffer_load_dwordx4 v4, s[16:19], s64 offen lds
    s_add_u32 m0, s65, 66560
    s_add_u32 s64, s80, 10240
    buffer_load_dwordx4 v4, s[16:19], s64 offen lds
    s_add_u32 m0, s65, 67584
    s_add_u32 s64, s80, 20480
    buffer_load_dwordx4 v4, s[16:19], s64 offen lds
    s_add_u32 m0, s65, 68608
    s_add_u32 s64, s80, 30720
    buffer_load_dwordx4 v4, s[16:19], s64 offen lds
    s_add_u32 s78, s78, 1
    s_cmp_eq_u32 s78, 12
    s_cselect_b32 s78, 0, s78
    s_lshl_b32 s65, s63, 12
    s_lshl_b32 s66, s60, 7
    s_lshl_b32 s80, s78, 2
    s_add_u32 s80, s80, s63
    s_mul_i32 s80, s80, 40960
    s_add_u32 s80, s80, s66
    s_add_u32 m0, s65, 81920
    s_add_u32 s64, s80, 0
    buffer_load_dwordx4 v4, s[16:19], s64 offen lds
    s_add_u32 m0, s65, 82944
    s_add_u32 s64, s80, 10240
    buffer_load_dwordx4 v4, s[16:19], s64 offen lds
    s_add_u32 m0, s65, 83968
    s_add_u32 s64, s80, 20480
    buffer_load_dwordx4 v4, s[16:19], s64 offen lds
    s_add_u32 m0, s65, 84992
    s_add_u32 s64, s80, 30720
    buffer_load_dwordx4 v4, s[16:19], s64 offen lds
    s_add_u32 s78, s78, 1
    s_cmp_eq_u32 s78, 12
    s_cselect_b32 s78, 0, s78
    s_cmp_eq_u32 s83, 0
    s_mov_b32 s83, 0
    s_cbranch_scc1 L_kvsum
    s_waitcnt vmcnt(12)
    s_branch L_kvlook
L_kvnext:
    s_cmp_eq_u32 s66, 0
    s_cbranch_scc1 L_kvsum
    s_waitcnt vmcnt(0)
    s_sub_u32 s67, s67, 1
    s_cbranch_scc0 L_kvlook
L_kvsum:
    v_mfma_f32_16x16x32_bf16 v[52:55], v[44:47], v[128:131], 0
    v_mfma_f32_16x16x32_bf16 v[56:59], v[48:51], v[128:131], 0
    v_mfma_f32_16x16x32_bf16 v[52:55], v[44:47], v[132:135], v[52:55]
    v_mfma_f32_16x16x32_bf16 v[56:59], v[48:51], v[132:135], v[56:59]
    v_mfma_f32_16x16x32_bf16 v[52:55], v[44:47], v[136:139], v[52:55]
    v_mfma_f32_16x16x32_bf16 v[56:59], v[48:51], v[136:139], v[56:59]
    v_mfma_f32_16x16x32_bf16 v[52:55], v[44:47], v[140:143], v[52:55]
    v_mfma_f32_16x16x32_bf16 v[56:59], v[48:51], v[140:143], v[56:59]
    v_mfma_f32_16x16x32_bf16 v[52:55], v[44:47], v[144:147], v[52:55]
    v_mfma_f32_16x16x32_bf16 v[56:59], v[48:51], v[144:147], v[56:59]
    v_mfma_f32_16x16x32_bf16 v[52:55], v[44:47], v[148:151], v[52:55]
    v_mfma_f32_16x16x32_bf16 v[56:59], v[48:51], v[148:151], v[56:59]
    v_mfma_f32_16x16x32_bf16 v[52:55], v[44:47], v[152:155], v[52:55]
    v_mfma_f32_16x16x32_bf16 v[56:59], v[48:51], v[152:155], v[56:59]
    v_mfma_f32_16x16x32_bf16 v[52:55], v[44:47], v[156:159], v[52:55]
    v_mfma_f32_16x16x32_bf16 v[56:59], v[48:51], v[156:159], v[56:59]
    v_mfma_f32_16x16x32_bf16 v[52:55], v[44:47], v[160:163], v[52:55]
    v_mfma_f32_16x16x32_bf16 v[56:59], v[48:51], v[160:163], v[56:59]
    v_mfma_f32_16x16x32_bf16 v[52:55], v[44:47], v[164:167], v[52:55]
    v_mfma_f32_16x16x32_bf16 v[56:59], v[48:51], v[164:167], v[56:59]
    v_mfma_f32_16x16x32_bf16 v[52:55], v[44:47], v[168:171], v[52:55]
    v_mfma_f32_16x16x32_bf16 v[56:59], v[48:51], v[168:171], v[56:59]
    v_mfma_f32_16x16x32_bf16 v[52:55], v[44:47], v[172:175], v[52:55]
    v_mfma_f32_16x16x32_bf16 v[56:59], v[48:51], v[172:175], v[56:59]
    v_mfma_f32_16x16x32_bf16 v[52:55], v[44:47], v[176:179], v[52:55]
    v_mfma_f32_16x16x32_bf16 v[56:59], v[48:51], v[176:179], v[56:59]
    v_mfma_f32_16x16x32_bf16 v[52:55], v[44:47], v[180:183], v[52:55]
    v_mfma_f32_16x16x32_bf16 v[56:59], v[48:51], v[180:183], v[56:59]
    v_mfma_f32_16x16x32_bf16 v[52:55], v[44:47], v[184:187], v[52:55]
    v_mfma_f32_16x16x32_bf16 v[56:59], v[48:51], v[184:187], v[56:59]
    v_mfma_f32_16x16x32_bf16 v[52:55], v[44:47], v[188:191], v[52:55]
    v_mfma_f32_16x16x32_bf16 v[56:59], v[48:51], v[188:191], v[56:59]
    s_nop 7
    v_add_f32 v1, v52, v56
    v_cmp_u_f32 vcc, v1, v1
    s_cbranch_vccz L_kvok
    v_mov_b32 v1, 0
    v_max3_u32 v16, v129, v130, v131
    v_max_u32 v16, v16, v128
    v_cmp_eq_u32 vcc, -1, v16
    s_nop 1
    v_cndmask_b32 v128, v128, v16, vcc
    v_max_u32 v1, v1, v16
    v_max3_u32 v16, v133, v134, v135
    v_max_u32 v16, v16, v132
    v_cmp_eq_u32 vcc, -1, v16
    s_nop 1
    v_cndmask_b32 v132, v132, v16, vcc
    v_max_u32 v1, v1, v16
    v_max3_u32 v16, v137, v138, v139
    v_max_u32 v16, v16, v136
    v_cmp_eq_u32 vcc, -1, v16
    s_nop 1
    v_cndmask_b32 v136, v136, v16, vcc
    v_max_u32 v1, v1, v16
    v_max3_u32 v16, v141, v142, v143
    v_max_u32 v16, v16, v140
    v_cmp_eq_u32 vcc, -1, v16
    s_nop 1
    v_cndmask_b32 v140, v140, v16, vcc
    v_max_u32 v1, v1, v16
    v_max3_u32 v16, v145, v146, v147
    v_max_u32 v16, v16, v144
    v_cmp_eq_u32 vcc, -1, v16
    s_nop 1
    v_cndmask_b32 v144, v144, v16, vcc
    v_max_u32 v1, v1, v16
    v_max3_u32 v16, v149, v150, v151
    v_max_u32 v16, v16, v148
    v_cmp_eq_u32 vcc, -1, v16
    s_nop 1
    v_cndmask_b32 v148, v148, v16, vcc
    v_max_u32 v1, v1, v16
    v_max3_u32 v16, v153, v154, v155
    v_max_u32 v16, v16, v152
    v_cmp_eq_u32 vcc, -1, v16
    s_nop 1
    v_cndmask_b32 v152, v152, v16, vcc
    v_max_u32 v1, v1, v16
    v_max3_u32 v16, v157, v158, v159
    v_max_u32 v16, v16, v156
    v_cmp_eq_u32 vcc, -1, v16
    s_nop 1
    v_cndmask_b32 v156, v156, v16, vcc
    v_max_u32 v1, v1, v16
    v_max3_u32 v16, v161, v162, v163
    v_max_u32 v16, v16, v160
    v_cmp_eq_u32 vcc, -1, v16
    s_nop 1
    v_cndmask_b32 v160, v160, v16, vcc
    v_max_u32 v1, v1, v16
    v_max3_u32 v16, v165, v166, v167
    v_max_u32 v16, v16, v164
    v_cmp_eq_u32 vcc, -1, v16
    s_nop 1
    v_cndmask_b32 v164, v164, v16, vcc
    v_max_u32 v1, v1, v16
    v_max3_u32 v16, v169, v170, v171
    v_max_u32 v16, v16, v168
    v_cmp_eq_u32 vcc, -1, v16
    s_nop 1
    v_cndmask_b32 v168, v168, v16, vcc
    v_max_u32 v1, v1, v16
    v_max3_u32 v16, v173, v174, v175
    v_max_u32 v16, v16, v172
    v_cmp_eq_u32 vcc, -1, v16
    s_nop 1
    v_cndmask_b32 v172, v172, v16, vcc
    v_max_u32 v1, v1, v16
    v_max3_u32 v16, v177, v178, v179
    v_max_u32 v16, v16, v176
    v_cmp_eq_u32 vcc, -1, v16
    s_nop 1
    v_cndmask_b32 v176, v176, v16, vcc
    v_max_u32 v1, v1, v16
    v_max3_u32 v16, v181, v182, v183
    v_max_u32 v16, v16, v180
    v_cmp_eq_u32 vcc, -1, v16
    s_nop 1
    v_cndmask_b32 v180, v180, v16, vcc
    v_max_u32 v1, v1, v16
    v_max3_u32 v16, v185, v186, v187
    v_max_u32 v16, v16, v184
    v_cmp_eq_u32 vcc, -1, v16
    s_nop 1
    v_cndmask_b32 v184, v184, v16, vcc
    v_max_u32 v1, v1, v16
    v_max3_u32 v16, v189, v190, v191
    v_max_u32 v16, v16, v188
    v_cmp_eq_u32 vcc, -1, v16
    s_nop 1
    v_cndmask_b32 v188, v188, v16, vcc
    v_max_u32 v1, v1, v16
    v_cmp_eq_u32 vcc, -1, v1
    s_cbranch_vccz L_kvok
    s_sub_u32 s67, s67, 1
    s_cbranch_scc0 L_kvlook
L_kvok:
    s_nop 3
    v_cvt_pk_bf16_f32 v60, v52, v53
    s_nop 2
    v_cvt_pk_bf16_f32 v61, v54, v55
    s_nop 2
    v_cvt_pk_bf16_f32 v62, v56, v57
    s_nop 1
    v_cvt_pk_bf16_f32 v63, v58, v59
    ds_write_b64 v43, v[60:61]
    ds_write_b64 v43, v[62:63] offset:512
    s_waitcnt lgkmcnt(0)
    v_mov_b32 v1, 158744
    v_mov_b32 v16, 1
    s_mov_b64 exec, 1
    ds_add_u32 v1, v16
    s_mov_b64 exec, -1
    s_setprio 0
    s_load_dword s57, s[42:43], s38 offset:0x0
    s_load_dword s101, s[42:43], s39 offset:0x0
    s_waitcnt lgkmcnt(0)
    s_cmp_lt_u32 s101, 8
    s_cbranch_scc1 L_chk_75
    s_cmp_ge_u32 s57, 8
    s_cbranch_scc1 L_chk_79
L_chk_75:
    s_cmp_eq_u32 s63, 0
    s_cbranch_scc1 L_chk_78
    v_mov_b32 v16, 158720
    s_mov_b32 s67, 4194304
L_lw_81:
    ds_read_b32 v17, v16
    s_sub_u32 s67, s67, 1
    s_cbranch_scc1 L_lw_82
    s_waitcnt lgkmcnt(0)
    v_cmp_eq_u32 vcc, 1, v17
    s_sleep 1
    s_cbranch_vccz L_lw_81
L_lw_82:
    s_branch L_chk_77
L_chk_78:
    s_mov_b32 s67, 65536
    s_add_u32 s64, s38, 0x918000
    v_mov_b32 v16, s64
    s_add_u32 s64, s39, 0x918000
    v_mov_b32 v17, s64
    s_mov_b64 exec, 1
L_chk_76:
    buffer_load_dword v18, v16, s[24:27], 0 offen sc1
    buffer_load_dword v19, v17, s[24:27], 0 offen sc1
    s_waitcnt vmcnt(0)
    v_cmp_le_u32 vcc, 8, v18
    v_cmp_le_u32 s[64:65], 8, v19
    s_nop 0
    s_and_b64 vcc, vcc, s[64:65]
    s_cbranch_vccnz L_chk_80
    s_sleep 6
    s_sub_u32 s67, s67, 1
    s_cbranch_scc0 L_chk_76
L_chk_80:
    s_mov_b64 exec, -1
L_chk_79:
    v_mov_b32 v16, 158720
    v_mov_b32 v17, 1
    ds_write_b32 v16, v17
L_chk_77:
    s_mul_i32 s65, s63, 4096
    s_mul_i32 s66, s61, 69632
    s_lshl_b32 s79, s77, 2
    s_add_u32 s79, s79, s63
    s_lshl_b32 s79, s79, 10
    s_add_u32 s79, s79, s66
    s_add_u32 m0, s65, 0
    s_add_u32 s64, s79, 0
    buffer_load_dwordx4 v6, s[24:27], s64 offen sc1 lds
    s_add_u32 m0, s65, 1024
    s_add_u32 s64, s79, 69632
    buffer_load_dwordx4 v6, s[24:27], s64 offen sc1 lds
    s_add_u32 m0, s65, 2048
    s_add_u32 s64, s79, 139264
    buffer_load_dwordx4 v6, s[24:27], s64 offen sc1 lds
    s_add_u32 m0, s65, 3072
    s_add_u32 s64, s79, 208896
    buffer_load_dwordx4 v6, s[24:27], s64 offen sc1 lds
    s_add_u32 s77, s77, 1
    s_cmp_eq_u32 s77, 12
    s_cselect_b32 s77, 0, s77
    s_mul_i32 s65, s63, 4096
    s_mul_i32 s66, s61, 69632
    s_lshl_b32 s79, s77, 2
    s_add_u32 s79, s79, s63
    s_lshl_b32 s79, s79, 10
    s_add_u32 s79, s79, s66
    s_add_u32 m0, s65, 16384
    s_add_u32 s64, s79, 0
    buffer_load_dwordx4 v6, s[24:27], s64 offen sc1 lds
    s_add_u32 m0, s65, 17408
    s_add_u32 s64, s79, 69632
    buffer_load_dwordx4 v6, s[24:27], s64 offen sc1 lds
    s_add_u32 m0, s65, 18432
    s_add_u32 s64, s79, 139264
    buffer_load_dwordx4 v6, s[24:27], s64 offen sc1 lds
    s_add_u32 m0, s65, 19456
    s_add_u32 s64, s79, 208896
    buffer_load_dwordx4 v6, s[24:27], s64 offen sc1 lds
    s_add_u32 s77, s77, 1
    s_cmp_eq_u32 s77, 12
    s_cselect_b32 s77, 0, s77
    s_waitcnt vmcnt(4)
    s_barrier
    s_mul_i32 s65, s63, 4096
    s_mul_i32 s66, s61, 69632
    s_lshl_b32 s79, s77, 2
    s_add_u32 s79, s79, s63
    s_lshl_b32 s79, s79, 10
    s_add_u32 s79, s79, s66
    s_add_u32 m0, s65, 32768
    s_add_u32 s64, s79, 0
    buffer_load_dwordx4 v6, s[24:27], s64 offen sc1 lds
    s_add_u32 m0, s65, 33792
    s_add_u32 s64, s79, 69632
    buffer_load_dwordx4 v6, s[24:27], s64 offen sc1 lds
    s_add_u32 m0, s65, 34816
    s_add_u32 s64, s79, 139264
    buffer_load_dwordx4 v6, s[24:27], s64 offen sc1 lds
    s_add_u32 m0, s65, 35840
    s_add_u32 s64, s79, 208896
    buffer_load_dwordx4 v6, s[24:27], s64 offen sc1 lds
    s_add_u32 s77, s77, 1
    s_cmp_eq_u32 s77, 12
    s_cselect_b32 s77, 0, s77
    s_waitcnt vmcnt(4)
    s_barrier
    s_mul_i32 s65, s63, 4096
    s_mul_i32 s66, s61, 69632
    s_lshl_b32 s79, s77, 2
    s_add_u32 s79, s79, s63
    s_lshl_b32 s79, s79, 10
    s_add_u32 s79, s79, s66
    s_add_u32 m0, s65, 0
    s_add_u32 s64, s79, 0
    buffer_load_dwordx4 v6, s[24:27], s64 offen sc1 lds
    s_add_u32 m0, s65, 1024
    s_add_u32 s64, s79, 69632
    buffer_load_dwordx4 v6, s[24:27], s64 offen sc1 lds
    s_add_u32 m0, s65, 2048
    s_add_u32 s64, s79, 139264
    buffer_load_dwordx4 v6, s[24:27], s64 offen sc1 lds
    s_add_u32 m0, s65, 3072
    s_add_u32 s64, s79, 208896
    buffer_load_dwordx4 v6, s[24:27], s64 offen sc1 lds
    s_add_u32 s77, s77, 1
    s_cmp_eq_u32 s77, 12
    s_cselect_b32 s77, 0, s77
    s_waitcnt vmcnt(4)
    s_barrier
    s_mul_i32 s65, s63, 4096
    s_mul_i32 s66, s61, 69632
    s_lshl_b32 s79, s77, 2
    s_add_u32 s79, s79, s63
    s_lshl_b32 s79, s79, 10
    s_add_u32 s79, s79, s66
    s_add_u32 m0, s65, 16384
    s_add_u32 s64, s79, 0
    buffer_load_dwordx4 v6, s[24:27], s64 offen sc1 lds
    s_add_u32 m0, s65, 17408
    s_add_u32 s64, s79, 69632
    buffer_load_dwordx4 v6, s[24:27], s64 offen sc1 lds
    s_add_u32 m0, s65, 18432
    s_add_u32 s64, s79, 139264
    buffer_load_dwordx4 v6, s[24:27], s64 offen sc1 lds
    s_add_u32 m0, s65, 19456
    s_add_u32 s64, s79, 208896
    buffer_load_dwordx4 v6, s[24:27], s64 offen sc1 lds
    s_add_u32 s77, s77, 1
    s_cmp_eq_u32 s77, 12
    s_cselect_b32 s77, 0, s77
    s_waitcnt vmcnt(4)
    s_barrier
    s_mul_i32 s65, s63, 4096
    s_mul_i32 s66, s61, 69632
    s_lshl_b32 s79, s77, 2
    s_add_u32 s79, s79, s63
    s_lshl_b32 s79, s79, 10
    s_add_u32 s79, s79, s66
    s_add_u32 m0, s65, 32768
    s_add_u32 s64, s79, 0
    buffer_load_dwordx4 v6, s[24:27], s64 offen sc1 lds
    s_add_u32 m0, s65, 33792
    s_add_u32 s64, s79, 69632
    buffer_load_dwordx4 v6, s[24:27], s64 offen sc1 lds
    s_add_u32 m0, s65, 34816
    s_add_u32 s64, s79, 139264
    buffer_load_dwordx4 v6, s[24:27], s64 offen sc1 lds
    s_add_u32 m0, s65, 35840
    s_add_u32 s64, s79, 208896
    buffer_load_dwordx4 v6, s[24:27], s64 offen sc1 lds
    s_add_u32 s77, s77, 1
    s_cmp_eq_u32 s77, 12
    s_cselect_b32 s77, 0, s77
    s_waitcnt vmcnt(4)
    s_barrier
    s_mul_i32 s65, s63, 4096
    s_mul_i32 s66, s61, 69632
    s_lshl_b32 s79, s77, 2
    s_add_u32 s79, s79, s63
    s_lshl_b32 s79, s79, 10
    s_add_u32 s79, s79, s66
    s_add_u32 m0, s65, 0
    s_add_u32 s64, s79, 0
    buffer_load_dwordx4 v6, s[24:27], s64 offen sc1 lds
    s_add_u32 m0, s65, 1024
    s_add_u32 s64, s79, 69632
    buffer_load_dwordx4 v6, s[24:27], s64 offen sc1 lds
    s_add_u32 m0, s65, 2048
    s_add_u32 s64, s79, 139264
    buffer_load_dwordx4 v6, s[24:27], s64 offen sc1 lds
    s_add_u32 m0, s65, 3072
    s_add_u32 s64, s79, 208896
    buffer_load_dwordx4 v6, s[24:27], s64 offen sc1 lds
    s_add_u32 s77, s77, 1
    s_cmp_eq_u32 s77, 12
    s_cselect_b32 s77, 0, s77
    s_lshl_b32 s65, s63, 12
    s_lshl_b32 s66, s60, 7
    s_lshl_b32 s80, s78, 2
    s_add_u32 s80, s80, s63
    s_mul_i32 s80, s80, 40960
    s_add_u32 s80, s80, s66
    s_add_u32 m0, s65, 98304
    s_add_u32 s64, s80, 0
    buffer_load_dwordx4 v4, s[16:19], s64 offen lds
    s_add_u32 m0, s65, 99328
    s_add_u32 s64, s80, 10240
    buffer_load_dwordx4 v4, s[16:19], s64 offen lds
    s_add_u32 m0, s65, 100352
    s_add_u32 s64, s80, 20480
    buffer_load_dwordx4 v4, s[16:19], s64 offen lds
    s_add_u32 m0, s65, 101376
    s_add_u32 s64, s80, 30720
    buffer_load_dwordx4 v4, s[16:19], s64 offen lds
    s_add_u32 s78, s78, 1
    s_cmp_eq_u32 s78, 12
    s_cselect_b32 s78, 0, s78
    s_waitcnt vmcnt(8)
    s_barrier
    s_mul_i32 s65, s63, 4096
    s_mul_i32 s66, s61, 69632
    s_lshl_b32 s79, s77, 2
    s_add_u32 s79, s79, s63
    s_lshl_b32 s79, s79, 10
    s_add_u32 s79, s79, s66
    s_add_u32 m0, s65, 16384
    s_add_u32 s64, s79, 0
    buffer_load_dwordx4 v6, s[24:27], s64 offen sc1 lds
    s_add_u32 m0, s65, 17408
    s_add_u32 s64, s79, 69632
    buffer_load_dwordx4 v6, s[24:27], s64 offen sc1 lds
    s_add_u32 m0, s65, 18432
    s_add_u32 s64, s79, 139264
    buffer_load_dwordx4 v6, s[24:27], s64 offen sc1 lds
    s_add_u32 m0, s65, 19456
    s_add_u32 s64, s79, 208896
    buffer_load_dwordx4 v6, s[24:27], s64 offen sc1 lds
    s_add_u32 s77, s77, 1
    s_cmp_eq_u32 s77, 12
    s_cselect_b32 s77, 0, s77
    s_lshl_b32 s65, s63, 12
    s_lshl_b32 s66, s60, 7
    s_lshl_b32 s80, s78, 2
    s_add_u32 s80, s80, s63
    s_mul_i32 s80, s80, 40960
    s_add_u32 s80, s80, s66
    s_add_u32 m0, s65, 114688
    s_add_u32 s64, s80, 0
    buffer_load_dwordx4 v4, s[16:19], s64 offen lds
    s_add_u32 m0, s65, 115712
    s_add_u32 s64, s80, 10240
    buffer_load_dwordx4 v4, s[16:19], s64 offen lds
    s_add_u32 m0, s65, 116736
    s_add_u32 s64, s80, 20480
    buffer_load_dwordx4 v4, s[16:19], s64 offen lds
    s_add_u32 m0, s65, 117760
    s_add_u32 s64, s80, 30720
    buffer_load_dwordx4 v4, s[16:19], s64 offen lds
    s_add_u32 s78, s78, 1
    s_cmp_eq_u32 s78, 12
    s_cselect_b32 s78, 0, s78
    s_waitcnt vmcnt(12)
    s_barrier
    s_mul_i32 s65, s63, 4096
    s_mul_i32 s66, s61, 69632
    s_lshl_b32 s79, s77, 2
    s_add_u32 s79, s79, s63
    s_lshl_b32 s79, s79, 10
    s_add_u32 s79, s79, s66
    s_add_u32 m0, s65, 32768
    s_add_u32 s64, s79, 0
    buffer_load_dwordx4 v6, s[24:27], s64 offen sc1 lds
    s_add_u32 m0, s65, 33792
    s_add_u32 s64, s79, 69632
    buffer_load_dwordx4 v6, s[24:27], s64 offen sc1 lds
    s_add_u32 m0, s65, 34816
    s_add_u32 s64, s79, 139264
    buffer_load_dwordx4 v6, s[24:27], s64 offen sc1 lds
    s_add_u32 m0, s65, 35840
    s_add_u32 s64, s79, 208896
    buffer_load_dwordx4 v6, s[24:27], s64 offen sc1 lds
    s_add_u32 s77, s77, 1
    s_cmp_eq_u32 s77, 12
    s_cselect_b32 s77, 0, s77
    s_lshl_b32 s65, s63, 12
    s_lshl_b32 s66, s60, 7
    s_lshl_b32 s80, s78, 2
    s_add_u32 s80, s80, s63
    s_mul_i32 s80, s80, 40960
    s_add_u32 s80, s80, s66
    s_add_u32 m0, s65, 131072
    s_add_u32 s64, s80, 0
    buffer_load_dwordx4 v4, s[16:19], s64 offen lds
    s_add_u32 m0, s65, 132096
    s_add_u32 s64, s80, 10240
    buffer_load_dwordx4 v4, s[16:19], s64 offen lds
    s_add_u32 m0, s65, 133120
    s_add_u32 s64, s80, 20480
    buffer_load_dwordx4 v4, s[16:19], s64 offen lds
    s_add_u32 m0, s65, 134144
    s_add_u32 s64, s80, 30720
    buffer_load_dwordx4 v4, s[16:19], s64 offen lds
    s_mov_b32 s78, s72
    s_waitcnt vmcnt(12)
    s_barrier
    s_mul_i32 s65, s63, 4096
    s_mul_i32 s66, s61, 69632
    s_lshl_b32 s79, s77, 2
    s_add_u32 s79, s79, s63
    s_lshl_b32 s79, s79, 10
    s_add_u32 s79, s79, s66
    s_add_u32 m0, s65, 0
    s_add_u32 s64, s79, 0
    buffer_load_dwordx4 v6, s[24:27], s64 offen sc1 lds
    s_add_u32 m0, s65, 1024
    s_add_u32 s64, s79, 69632
    buffer_load_dwordx4 v6, s[24:27], s64 offen sc1 lds
    s_add_u32 m0, s65, 2048
    s_add_u32 s64, s79, 139264
    buffer_load_dwordx4 v6, s[24:27], s64 offen sc1 lds
    s_add_u32 m0, s65, 3072
    s_add_u32 s64, s79, 208896
    buffer_load_dwordx4 v6, s[24:27], s64 offen sc1 lds
    s_add_u32 s77, s77, 1
    s_cmp_eq_u32 s77, 12
    s_cselect_b32 s77, 0, s77
    s_lshl_b32 s65, s63, 12
    s_lshl_b32 s66, s60, 7
    s_mov_b32 s80, s63
    s_mul_i32 s80, s80, 204800
    s_add_u32 s80, s80, s66
    s_add_u32 m0, s65, 49152
    s_add_u32 s64, s80, 20480
    buffer_load_dwordx4 v5, s[20:23], s64 offen lds
    s_add_u32 m0, s65, 50176
    s_add_u32 s64, s80, 122880
    buffer_load_dwordx4 v5, s[20:23], s64 offen lds
    s_add_u32 m0, s65, 51200
    s_add_u32 s64, s80, 46080
    buffer_load_dwordx4 v5, s[20:23], s64 offen lds
    s_add_u32 m0, s65, 52224
    s_add_u32 s64, s80, 148480
    buffer_load_dwordx4 v5, s[20:23], s64 offen lds
    s_waitcnt vmcnt(12)
    s_barrier
    s_mul_i32 s65, s63, 4096
    s_mul_i32 s66, s61, 69632
    s_lshl_b32 s79, s77, 2
    s_add_u32 s79, s79, s63
    s_lshl_b32 s79, s79, 10
    s_add_u32 s79, s79, s66
    s_add_u32 m0, s65, 16384
    s_add_u32 s64, s79, 0
    buffer_load_dwordx4 v6, s[24:27], s64 offen sc1 lds
    s_add_u32 m0, s65, 17408
    s_add_u32 s64, s79, 69632
    buffer_load_dwordx4 v6, s[24:27], s64 offen sc1 lds
    s_add_u32 m0, s65, 18432
    s_add_u32 s64, s79, 139264
    buffer_load_dwordx4 v6, s[24:27], s64 offen sc1 lds
    s_add_u32 m0, s65, 19456
    s_add_u32 s64, s79, 208896
    buffer_load_dwordx4 v6, s[24:27], s64 offen sc1 lds
    s_add_u32 s77, s77, 1
    s_cmp_eq_u32 s77, 12
    s_cselect_b32 s77, 0, s77
    s_lshl_b32 s65, s63, 12
    s_lshl_b32 s66, s60, 7
    s_lshl_b32 s80, s78, 2
    s_add_u32 s80, s80, s63
    s_mul_i32 s80, s80, 51200
    s_add_u32 s80, s80, s66
    s_add_u32 m0, s65, 65536
    s_add_u32 s64, s80, 0
    buffer_load_dwordx4 v4, s[20:23], s64 offen lds
    s_add_u32 m0, s65, 66560
    s_add_u32 s64, s80, 10240
    buffer_load_dwordx4 v4, s[20:23], s64 offen lds
    s_add_u32 m0, s65, 67584
    s_add_u32 s64, s80, 25600
    buffer_load_dwordx4 v4, s[20:23], s64 offen lds
    s_add_u32 m0, s65, 68608
    s_add_u32 s64, s80, 35840
    buffer_load_dwordx4 v4, s[20:23], s64 offen lds
    s_add_u32 s78, s78, 1
    s_and_b32 s78, s78, 3
    s_waitcnt vmcnt(12)
    s_barrier
    s_load_dword s57, s[42:43], s38 offset:0x800
    s_load_dword s101, s[42:43], s39 offset:0x800
    s_mul_i32 s65, s63, 4096
    s_mul_i32 s66, s61, 69632
    s_lshl_b32 s79, s77, 2
    s_add_u32 s79, s79, s63
    s_lshl_b32 s79, s79, 10
    s_add_u32 s79, s79, s66
    s_add_u32 m0, s65, 32768
    s_add_u32 s64, s79, 0
    buffer_load_dwordx4 v6, s[24:27], s64 offen sc1 lds
    s_add_u32 m0, s65, 33792
    s_add_u32 s64, s79, 69632
    buffer_load_dwordx4 v6, s[24:27], s64 offen sc1 lds
    s_add_u32 m0, s65, 34816
    s_add_u32 s64, s79, 139264
    buffer_load_dwordx4 v6, s[24:27], s64 offen sc1 lds
    s_add_u32 m0, s65, 35840
    s_add_u32 s64, s79, 208896
    buffer_load_dwordx4 v6, s[24:27], s64 offen sc1 lds
    s_mov_b32 s77, s72
    s_lshl_b32 s65, s63, 12
    s_lshl_b32 s66, s60, 7
    s_lshl_b32 s80, s78, 2
    s_add_u32 s80, s80, s63
    s_mul_i32 s80, s80, 51200
    s_add_u32 s80, s80, s66
    s_add_u32 m0, s65, 81920
    s_add_u32 s64, s80, 0
    buffer_load_dwordx4 v4, s[20:23], s64 offen lds
    s_add_u32 m0, s65, 82944
    s_add_u32 s64, s80, 10240
    buffer_load_dwordx4 v4, s[20:23], s64 offen lds
    s_add_u32 m0, s65, 83968
    s_add_u32 s64, s80, 25600
    buffer_load_dwordx4 v4, s[20:23], s64 offen lds
    s_add_u32 m0, s65, 84992
    s_add_u32 s64, s80, 35840
    buffer_load_dwordx4 v4, s[20:23], s64 offen lds
    s_add_u32 s78, s78, 1
    s_and_b32 s78, s78, 3
    s_waitcnt vmcnt(12)
    s_barrier
    s_lshl_b32 s65, s63, 12
    s_lshl_b32 s66, s60, 7
    s_lshl_b32 s80, s78, 2
    s_add_u32 s80, s80, s63
    s_mul_i32 s80, s80, 51200
    s_add_u32 s80, s80, s66
    s_add_u32 m0, s65, 98304
    s_add_u32 s64, s80, 0
    buffer_load_dwordx4 v4, s[20:23], s64 offen lds
    s_add_u32 m0, s65, 99328
    s_add_u32 s64, s80, 10240
    buffer_load_dwordx4 v4, s[20:23], s64 offen lds
    s_add_u32 m0, s65, 100352
    s_add_u32 s64, s80, 25600
    buffer_load_dwordx4 v4, s[20:23], s64 offen lds
    s_add_u32 m0, s65, 101376
    s_add_u32 s64, s80, 35840
    buffer_load_dwordx4 v4, s[20:23], s64 offen lds
    s_add_u32 s78, s78, 1
    s_and_b32 s78, s78, 3
    s_waitcnt lgkmcnt(0)
    s_cmp_lt_u32 s101, 8
    s_cbranch_scc1 L_chk_83
    s_cmp_ge_u32 s57, 8
    s_cbranch_scc1 L_chk_87
L_chk_83:
    s_cmp_eq_u32 s63, 0
    s_cbranch_scc1 L_chk_86
    v_mov_b32 v16, 158732
    s_mov_b32 s67, 4194304
L_lw_89:
    ds_read_b32 v17, v16
    s_sub_u32 s67, s67, 1
    s_cbranch_scc1 L_lw_90
    s_waitcnt lgkmcnt(0)
    v_cmp_eq_u32 vcc, 1, v17
    s_sleep 1
    s_cbranch_vccz L_lw_89
L_lw_90:
    s_branch L_chk_85
L_chk_86:
    s_mov_b32 s67, 65536
    s_add_u32 s64, s38, 0x918800
    v_mov_b32 v16, s64
    s_add_u32 s64, s39, 0x918800
    v_mov_b32 v17, s64
    s_mov_b64 exec, 1
L_chk_84:
    buffer_load_dword v18, v16, s[24:27], 0 offen sc1
    buffer_load_dword v19, v17, s[24:27], 0 offen sc1
    s_waitcnt vmcnt(0)
    v_cmp_le_u32 vcc, 8, v18
    v_cmp_le_u32 s[64:65], 8, v19
    s_nop 0
    s_and_b64 vcc, vcc, s[64:65]
    s_cbranch_vccnz L_chk_88
    s_sleep 6
    s_sub_u32 s67, s67, 1
    s_cbranch_scc0 L_chk_84
L_chk_88:
    s_mov_b64 exec, -1
L_chk_87:
    v_mov_b32 v16, 158732
    v_mov_b32 v17, 1
    ds_write_b32 v16, v17
L_chk_85:
    s_mul_i32 s65, s63, 4096
    s_mul_i32 s66, s61, 69632
    s_mov_b32 s79, s63
    s_lshl_b32 s79, s79, 10
    s_add_u32 s79, s79, s66
    s_add_u32 m0, s65, 0
    s_add_u32 s64, s79, 65536
    buffer_load_dwordx4 v6, s[24:27], s64 offen sc1 lds
    s_add_u32 m0, s65, 1024
    s_add_u32 s64, s79, 135168
    buffer_load_dwordx4 v6, s[24:27], s64 offen sc1 lds
    s_add_u32 m0, s65, 2048
    s_add_u32 s64, s79, 204800
    buffer_load_dwordx4 v6, s[24:27], s64 offen sc1 lds
    s_add_u32 m0, s65, 3072
    s_add_u32 s64, s79, 274432
    buffer_load_dwordx4 v6, s[24:27], s64 offen sc1 lds
    s_waitcnt vmcnt(12)
    s_barrier
    s_mul_i32 s65, s63, 4096
    s_mul_i32 s66, s61, 69632
    s_lshl_b32 s79, s77, 2
    s_add_u32 s79, s79, s63
    s_lshl_b32 s79, s79, 10
    s_add_u32 s79, s79, s66
    s_add_u32 m0, s65, 16384
    s_add_u32 s64, s79, 49152
    buffer_load_dwordx4 v6, s[24:27], s64 offen sc1 lds
    s_add_u32 m0, s65, 17408
    s_add_u32 s64, s79, 118784
    buffer_load_dwordx4 v6, s[24:27], s64 offen sc1 lds
    s_add_u32 m0, s65, 18432
    s_add_u32 s64, s79, 188416
    buffer_load_dwordx4 v6, s[24:27], s64 offen sc1 lds
    s_add_u32 m0, s65, 19456
    s_add_u32 s64, s79, 258048
    buffer_load_dwordx4 v6, s[24:27], s64 offen sc1 lds
    s_add_u32 s77, s77, 1
    s_and_b32 s77, s77, 3
    s_lshl_b32 s65, s63, 12
    s_lshl_b32 s66, s60, 7
    s_lshl_b32 s80, s78, 2
    s_add_u32 s80, s80, s63
    s_mul_i32 s80, s80, 51200
    s_add_u32 s80, s80, s66
    s_add_u32 m0, s65, 114688
    s_add_u32 s64, s80, 0
    buffer_load_dwordx4 v4, s[20:23], s64 offen lds
    s_add_u32 m0, s65, 115712
    s_add_u32 s64, s80, 10240
    buffer_load_dwordx4 v4, s[20:23], s64 offen lds
    s_add_u32 m0, s65, 116736
    s_add_u32 s64, s80, 25600
    buffer_load_dwordx4 v4, s[20:23], s64 offen lds
    s_add_u32 m0, s65, 117760
    s_add_u32 s64, s80, 35840
    buffer_load_dwordx4 v4, s[20:23], s64 offen lds
    s_add_u32 s78, s78, 1
    s_and_b32 s78, s78, 3
    s_waitcnt vmcnt(8)
    s_barrier
    s_mul_i32 s65, s63, 4096
    s_mul_i32 s66, s61, 69632
    s_lshl_b32 s79, s77, 2
    s_add_u32 s79, s79, s63
    s_lshl_b32 s79, s79, 10
    s_add_u32 s79, s79, s66
    s_add_u32 m0, s65, 32768
    s_add_u32 s64, s79, 49152
    buffer_load_dwordx4 v6, s[24:27], s64 offen sc1 lds
    s_add_u32 m0, s65, 33792
    s_add_u32 s64, s79, 118784
    buffer_load_dwordx4 v6, s[24:27], s64 offen sc1 lds
    s_add_u32 m0, s65, 34816
    s_add_u32 s64, s79, 188416
    buffer_load_dwordx4 v6, s[24:27], s64 offen sc1 lds
    s_add_u32 m0, s65, 35840
    s_add_u32 s64, s79, 258048
    buffer_load_dwordx4 v6, s[24:27], s64 offen sc1 lds
    s_add_u32 s77, s77, 1
    s_and_b32 s77, s77, 3
    s_waitcnt vmcnt(8)
    s_barrier
    s_mul_i32 s65, s63, 4096
    s_mul_i32 s66, s61, 69632
    s_lshl_b32 s79, s77, 2
    s_add_u32 s79, s79, s63
    s_lshl_b32 s79, s79, 10
    s_add_u32 s79, s79, s66
    s_add_u32 m0, s65, 0
    s_add_u32 s64, s79, 49152
    buffer_load_dwordx4 v6, s[24:27], s64 offen sc1 lds
    s_add_u32 m0, s65, 1024
    s_add_u32 s64, s79, 118784
    buffer_load_dwordx4 v6, s[24:27], s64 offen sc1 lds
    s_add_u32 m0, s65, 2048
    s_add_u32 s64, s79, 188416
    buffer_load_dwordx4 v6, s[24:27], s64 offen sc1 lds
    s_add_u32 m0, s65, 3072
    s_add_u32 s64, s79, 258048
    buffer_load_dwordx4 v6, s[24:27], s64 offen sc1 lds
    s_add_u32 s77, s77, 1
    s_and_b32 s77, s77, 3
    s_mul_i32 s66, s61, 20480
    s_lshl_b32 s65, s60, 7
    s_add_u32 s66, s66, s65
    s_mul_i32 s65, s63, 10240
    s_add_u32 s66, s66, s65
    s_add_u32 m0, s75, 131072
    s_add_u32 s64, s66, 0
    buffer_load_dwordx4 v4, s[8:11], s64 offen lds
    s_add_u32 m0, s75, 135168
    s_add_u32 s64, s66, 40960
    buffer_load_dwordx4 v4, s[8:11], s64 offen lds
    s_waitcnt vmcnt(6)
    s_barrier
    s_mul_i32 s65, s63, 4096
    s_mul_i32 s66, s61, 69632
    s_lshl_b32 s79, s77, 2
    s_add_u32 s79, s79, s63
    s_lshl_b32 s79, s79, 10
    s_add_u32 s79, s79, s66
    s_add_u32 m0, s65, 16384
    s_add_u32 s64, s79, 49152
    buffer_load_dwordx4 v6, s[24:27], s64 offen sc1 lds
    s_add_u32 m0, s65, 17408
    s_add_u32 s64, s79, 118784
    buffer_load_dwordx4 v6, s[24:27], s64 offen sc1 lds
    s_add_u32 m0, s65, 18432
    s_add_u32 s64, s79, 188416
    buffer_load_dwordx4 v6, s[24:27], s64 offen sc1 lds
    s_add_u32 m0, s65, 19456
    s_add_u32 s64, s79, 258048
    buffer_load_dwordx4 v6, s[24:27], s64 offen sc1 lds
    s_add_u32 s77, s77, 1
    s_and_b32 s77, s77, 3
    s_waitcnt vmcnt(6)
    s_barrier
    s_waitcnt vmcnt(0)
    s_waitcnt vmcnt(0)
    s_barrier
    v_mov_b32 v7, v4
    s_branch L_final_Q
L_matrix:
    s_bitcmp1_b32 s3, 3
    s_cbranch_scc1 L_compute_Q
L_compute_F:
    s_lshr_b32 s73, s63, 1
    s_and_b32 s74, s63, 1
    v_lshrrev_b32 v30, 4, v0
    v_and_b32 v31, 15, v0
    s_cmp_lg_u32 s2, 0
    s_cbranch_scc1 L_not_leader
    s_waitcnt lgkmcnt(0)
    s_mov_b32 s24, s52
    s_mov_b32 s25, s53
    s_mov_b32 s26, 0xb00000
    s_mov_b32 s27, 0x20000
    s_mov_b32 s32, s50
    s_mov_b32 s33, s51
    s_mov_b32 s34, 0x100
    s_mov_b32 s35, 0x20000
    s_mul_i32 s64, s63, 2048
    s_add_u32 s64, s64, 0x918000
    v_lshlrev_b32 v1, 7, v0
    v_mov_b32 v4, 0
    s_mov_b64 exec, 0xffff
    buffer_store_dword v4, v1, s[24:27], s64 offen sc1
    v_mov_b32 v2, 1
    s_waitcnt vmcnt(0)
    s_mov_b64 exec, 1
    buffer_atomic_add v2, v4, s[32:35], 0 offen
    s_mov_b64 exec, -1
L_not_leader:
    s_waitcnt lgkmcnt(0)
    s_mov_b32 s24, s52
    s_mov_b32 s25, s53
    s_mov_b32 s26, 0xb00000
    s_mov_b32 s27, 0x20000
    s_mov_b32 s28, s48
    s_mov_b32 s29, s49
    s_mov_b32 s30, 0x280000
    s_mov_b32 s31, 0x20000
    s_lshr_b32 s64, s70, 2
    s_and_b32 s65, s70, 3
    s_sub_u32 s66, s70, 12
    s_lshr_b32 s67, s66, 1
    s_add_u32 s67, s67, 3
    s_and_b32 s66, s66, 1
    s_cmp_ge_u32 s70, 12
    s_cselect_b32 s64, s67, s64
    s_cselect_b32 s65, s66, s65
    s_mul_i32 s65, s65, 6
    s_mul_i32 s60, s59, 5
    s_add_u32 s60, s60, s64
    s_lshl_b32 s61, s58, 5
    s_add_u32 s61, s61, s65
    s_lshl_b32 s66, s64, 2
    s_lshr_b32 s67, 0xA2840, s66
    s_and_b32 s67, s67, 15
    s_add_u32 s71, s67, s59
    s_and_b32 s72, s60, 3
    v_mov_b32 v128, 0
    v_mov_b32 v129, 0
    v_mov_b32 v130, 0
    v_mov_b32 v131, 0
    v_mov_b32 v132, 0
    v_mov_b32 v133, 0
    v_mov_b32 v134, 0
    v_mov_b32 v135, 0
    v_mov_b32 v136, 0
    v_mov_b32 v137, 0
    v_mov_b32 v138, 0
    v_mov_b32 v139, 0
    v_mov_b32 v140, 0
    v_mov_b32 v141, 0
    v_mov_b32 v142, 0
    v_mov_b32 v143, 0
    v_mov_b32 v144, 0
    v_mov_b32 v145, 0
    v_mov_b32 v146, 0
    v_mov_b32 v147, 0
    v_mov_b32 v148, 0
    v_mov_b32 v149, 0
    v_mov_b32 v150, 0
    v_mov_b32 v151, 0
    v_mov_b32 v152, 0
    v_mov_b32 v153, 0
    v_mov_b32 v154, 0
    v_mov_b32 v155, 0
    v_mov_b32 v156, 0
    v_mov_b32 v157, 0
    v_mov_b32 v158, 0
    v_mov_b32 v159, 0
    v_mov_b32 v160, 0
    v_mov_b32 v161, 0
    v_mov_b32 v162, 0
    v_mov_b32 v163, 0
    v_mov_b32 v164, 0
    v_mov_b32 v165, 0
    v_mov_b32 v166, 0
    v_mov_b32 v167, 0
    v_mov_b32 v168, 0
    v_mov_b32 v169, 0
    v_mov_b32 v170, 0
    v_mov_b32 v171, 0
    v_mov_b32 v172, 0
    v_mov_b32 v173, 0
    v_mov_b32 v174, 0
    v_mov_b32 v175, 0
    v_mov_b32 v176, 0
    v_mov_b32 v177, 0
    v_mov_b32 v178, 0
    v_mov_b32 v179, 0
    v_mov_b32 v180, 0
    v_mov_b32 v181, 0
    v_mov_b32 v182, 0
    v_mov_b32 v183, 0
    v_mov_b32 v184, 0
    v_mov_b32 v185, 0
    v_mov_b32 v186, 0
    v_mov_b32 v187, 0
    v_mov_b32 v188, 0
    v_mov_b32 v189, 0
    v_mov_b32 v190, 0
    v_mov_b32 v191, 0
    v_mov_b32 v192, 0
    v_mov_b32 v193, 0
    v_mov_b32 v194, 0
    v_mov_b32 v195, 0
    v_mov_b32 v196, 0
    v_mov_b32 v197, 0
    v_mov_b32 v198, 0
    v_mov_b32 v199, 0
    v_mov_b32 v200, 0
    v_mov_b32 v201, 0
    v_mov_b32 v202, 0
    v_mov_b32 v203, 0
    v_mov_b32 v204, 0
    v_mov_b32 v205, 0
    v_mov_b32 v206, 0
    v_mov_b32 v207, 0
    v_mov_b32 v208, 0
    v_mov_b32 v209, 0
    v_mov_b32 v210, 0
    v_mov_b32 v211, 0
    v_mov_b32 v212, 0
    v_mov_b32 v213, 0
    v_mov_b32 v214, 0
    v_mov_b32 v215, 0
    v_mov_b32 v216, 0
    v_mov_b32 v217, 0
    v_mov_b32 v218, 0
    v_mov_b32 v219, 0
    v_mov_b32 v220, 0
    v_mov_b32 v221, 0
    v_mov_b32 v222, 0
    v_mov_b32 v223, 0
    v_lshrrev_b32 v1, 1, v31
    v_xor_b32 v1, v1, v30
    v_lshlrev_b32 v1, 4, v1
    v_lshl_add_u32 v1, v31, 7, v1
    s_lshl_b32 s64, s73, 13
    v_add_u32 v2, s64, v1
    v_xor_b32 v3, 64, v2
    v_lshrrev_b32 v10, 2, v31
    v_and_b32 v11, 3, v31
    v_mul_u32_u24 v1, 3072, v30
    v_lshl_add_u32 v1, v10, 7, v1
    v_lshl_add_u32 v1, v11, 3, v1
    v_add_u32 v1, 16384, v1
    v_and_b32 v10, 1, v30
    v_lshlrev_b32 v10, 1, v10
    v_bfe_u32 v11, v31, 3, 1
    v_or_b32 v10, v10, v11
    s_mul_i32 s64, s74, 6
    s_add_u32 s64, s64, 0
    s_and_b32 s65, s64, 3
    s_lshr_b32 s64, s64, 2
    s_lshl_b32 s64, s64, 10
    v_xor_b32 v11, s65, v10
    v_lshl_add_u32 v11, v11, 5, v1
    v_add_u32 v4, s64, v11
    s_mul_i32 s64, s74, 6
    s_add_u32 s64, s64, 1
    s_and_b32 s65, s64, 3
    s_lshr_b32 s64, s64, 2
    s_lshl_b32 s64, s64, 10
    v_xor_b32 v11, s65, v10
    v_lshl_add_u32 v11, v11, 5, v1
    v_add_u32 v5, s64, v11
    s_mul_i32 s64, s74, 6
    s_add_u32 s64, s64, 2
    s_and_b32 s65, s64, 3
    s_lshr_b32 s64, s64, 2
    s_lshl_b32 s64, s64, 10
    v_xor_b32 v11, s65, v10
    v_lshl_add_u32 v11, v11, 5, v1
    v_add_u32 v6, s64, v11
    s_mul_i32 s64, s74, 6
    s_add_u32 s64, s64, 3
    s_and_b32 s65, s64, 3
    s_lshr_b32 s64, s64, 2
    s_lshl_b32 s64, s64, 10
    v_xor_b32 v11, s65, v10
    v_lshl_add_u32 v11, v11, 5, v1
    v_add_u32 v7, s64, v11
    s_mul_i32 s64, s74, 6
    s_add_u32 s64, s64, 4
    s_and_b32 s65, s64, 3
    s_lshr_b32 s64, s64, 2
    s_lshl_b32 s64, s64, 10
    v_xor_b32 v11, s65, v10
    v_lshl_add_u32 v11, v11, 5, v1
    v_add_u32 v8, s64, v11
    s_mul_i32 s64, s74, 6
    s_add_u32 s64, s64, 5
    s_and_b32 s65, s64, 3
    s_lshr_b32 s64, s64, 2
    s_lshl_b32 s64, s64, 10
    v_xor_b32 v11, s65, v10
    v_lshl_add_u32 v11, v11, 5, v1
    v_add_u32 v9, s64, v11
    s_mov_b32 s75, 0
    s_mov_b32 s77, 10
    s_waitcnt vmcnt(0)
    s_setprio 3
    s_barrier
    ds_read_b128 v[96:99], v2 offset:0
    ds_read_b128 v[100:103], v2 offset:2048
    ds_read_b128 v[104:107], v2 offset:4096
    ds_read_b128 v[108:111], v2 offset:6144
    ds_read_b64_tr_b16 v[32:33], v4 offset:0
    ds_read_b64_tr_b16 v[34:35], v4 offset:512
    ds_read_b64_tr_b16 v[36:37], v5 offset:0
    ds_read_b64_tr_b16 v[38:39], v5 offset:512
    ds_read_b64_tr_b16 v[40:41], v6 offset:0
    ds_read_b64_tr_b16 v[42:43], v6 offset:512
    ds_read_b64_tr_b16 v[44:45], v7 offset:0
    ds_read_b64_tr_b16 v[46:47], v7 offset:512
    ds_read_b64_tr_b16 v[48:49], v8 offset:0
    ds_read_b64_tr_b16 v[50:51], v8 offset:512
    ds_read_b64_tr_b16 v[52:53], v9 offset:0
    ds_read_b64_tr_b16 v[54:55], v9 offset:512
L_k_F:
    s_waitcnt lgkmcnt(0)
    v_mfma_f32_16x16x32_bf16 v[128:131], v[32:35], v[96:99], v[128:131]
    ds_read_b128 v[112:115], v3 offset:0
    v_mfma_f32_16x16x32_bf16 v[132:135], v[32:35], v[100:103], v[132:135]
    ds_read_b128 v[116:119], v3 offset:2048
    v_mfma_f32_16x16x32_bf16 v[136:139], v[32:35], v[104:107], v[136:139]
    ds_read_b128 v[120:123], v3 offset:4096
    v_mfma_f32_16x16x32_bf16 v[140:143], v[32:35], v[108:111], v[140:143]
    ds_read_b128 v[124:127], v3 offset:6144
    v_mfma_f32_16x16x32_bf16 v[156:159], v[36:39], v[108:111], v[156:159]
    ds_read_b64_tr_b16 v[64:65], v4 offset:12288
    v_mfma_f32_16x16x32_bf16 v[152:155], v[36:39], v[104:107], v[152:155]
    ds_read_b64_tr_b16 v[66:67], v4 offset:12800
    v_mfma_f32_16x16x32_bf16 v[148:151], v[36:39], v[100:103], v[148:151]
    ds_read_b64_tr_b16 v[68:69], v5 offset:12288
    v_mfma_f32_16x16x32_bf16 v[144:147], v[36:39], v[96:99], v[144:147]
    ds_read_b64_tr_b16 v[70:71], v5 offset:12800
    v_mfma_f32_16x16x32_bf16 v[160:163], v[40:43], v[96:99], v[160:163]
    ds_read_b64_tr_b16 v[72:73], v6 offset:12288
    v_mfma_f32_16x16x32_bf16 v[164:167], v[40:43], v[100:103], v[164:167]
    ds_read_b64_tr_b16 v[74:75], v6 offset:12800
    v_mfma_f32_16x16x32_bf16 v[168:171], v[40:43], v[104:107], v[168:171]
    ds_read_b64_tr_b16 v[76:77], v7 offset:12288
    v_mfma_f32_16x16x32_bf16 v[172:175], v[40:43], v[108:111], v[172:175]
    ds_read_b64_tr_b16 v[78:79], v7 offset:12800
    v_mfma_f32_16x16x32_bf16 v[188:191], v[44:47], v[108:111], v[188:191]
    ds_read_b64_tr_b16 v[80:81], v8 offset:12288
    v_mfma_f32_16x16x32_bf16 v[184:187], v[44:47], v[104:107], v[184:187]
    ds_read_b64_tr_b16 v[82:83], v8 offset:12800
    v_mfma_f32_16x16x32_bf16 v[180:183], v[44:47], v[100:103], v[180:183]
    ds_read_b64_tr_b16 v[84:85], v9 offset:12288
    v_mfma_f32_16x16x32_bf16 v[176:179], v[44:47], v[96:99], v[176:179]
    ds_read_b64_tr_b16 v[86:87], v9 offset:12800
    v_mfma_f32_16x16x32_bf16 v[192:195], v[48:51], v[96:99], v[192:195]
    s_mov_b32 s76, 40960
    s_add_u32 s75, s75, 1
    v_mfma_f32_16x16x32_bf16 v[196:199], v[48:51], v[100:103], v[196:199]
    s_cmp_eq_u32 s75, 3
    s_cselect_b32 s76, 4294885376, s76
    v_mfma_f32_16x16x32_bf16 v[200:203], v[48:51], v[104:107], v[200:203]
    s_cselect_b32 s75, 0, s75
    s_sub_u32 s77, s77, 1
    v_mfma_f32_16x16x32_bf16 v[204:207], v[48:51], v[108:111], v[204:207]
    s_cmp_eq_u32 s77, 0
    v_mfma_f32_16x16x32_bf16 v[220:223], v[52:55], v[108:111], v[220:223]
    v_mfma_f32_16x16x32_bf16 v[216:219], v[52:55], v[104:107], v[216:219]
    v_mfma_f32_16x16x32_bf16 v[212:215], v[52:55], v[100:103], v[212:215]
    v_mfma_f32_16x16x32_bf16 v[208:211], v[52:55], v[96:99], v[208:211]
    s_waitcnt lgkmcnt(0)
    s_barrier
    s_cbranch_scc1 L_klast_F
    v_mfma_f32_16x16x32_bf16 v[128:131], v[64:67], v[112:115], v[128:131]
    v_add_u32 v2, s76, v2
    v_add_u32 v3, s76, v3
    v_add_u32 v4, s76, v4
    v_add_u32 v5, s76, v5
    v_mfma_f32_16x16x32_bf16 v[132:135], v[64:67], v[116:119], v[132:135]
    v_add_u32 v6, s76, v6
    v_add_u32 v7, s76, v7
    v_add_u32 v8, s76, v8
    v_add_u32 v9, s76, v9
    v_mfma_f32_16x16x32_bf16 v[136:139], v[64:67], v[120:123], v[136:139]
    ds_read_b128 v[96:99], v2 offset:0
    v_mfma_f32_16x16x32_bf16 v[140:143], v[64:67], v[124:127], v[140:143]
    ds_read_b128 v[100:103], v2 offset:2048
    v_mfma_f32_16x16x32_bf16 v[156:159], v[68:71], v[124:127], v[156:159]
    ds_read_b128 v[104:107], v2 offset:4096
    v_mfma_f32_16x16x32_bf16 v[152:155], v[68:71], v[120:123], v[152:155]
    ds_read_b128 v[108:111], v2 offset:6144
    v_mfma_f32_16x16x32_bf16 v[148:151], v[68:71], v[116:119], v[148:151]
    ds_read_b64_tr_b16 v[32:33], v4 offset:0
    v_mfma_f32_16x16x32_bf16 v[144:147], v[68:71], v[112:115], v[144:147]
    ds_read_b64_tr_b16 v[34:35], v4 offset:512
    v_mfma_f32_16x16x32_bf16 v[160:163], v[72:75], v[112:115], v[160:163]
    ds_read_b64_tr_b16 v[36:37], v5 offset:0
    v_mfma_f32_16x16x32_bf16 v[164:167], v[72:75], v[116:119], v[164:167]
    ds_read_b64_tr_b16 v[38:39], v5 offset:512
    v_mfma_f32_16x16x32_bf16 v[168:171], v[72:75], v[120:123], v[168:171]
    ds_read_b64_tr_b16 v[40:41], v6 offset:0
    v_mfma_f32_16x16x32_bf16 v[172:175], v[72:75], v[124:127], v[172:175]
    ds_read_b64_tr_b16 v[42:43], v6 offset:512
    v_mfma_f32_16x16x32_bf16 v[188:191], v[76:79], v[124:127], v[188:191]
    ds_read_b64_tr_b16 v[44:45], v7 offset:0
    v_mfma_f32_16x16x32_bf16 v[184:187], v[76:79], v[120:123], v[184:187]
    ds_read_b64_tr_b16 v[46:47], v7 offset:512
    v_mfma_f32_16x16x32_bf16 v[180:183], v[76:79], v[116:119], v[180:183]
    ds_read_b64_tr_b16 v[48:49], v8 offset:0
    v_mfma_f32_16x16x32_bf16 v[176:179], v[76:79], v[112:115], v[176:179]
    ds_read_b64_tr_b16 v[50:51], v8 offset:512
    v_mfma_f32_16x16x32_bf16 v[192:195], v[80:83], v[112:115], v[192:195]
    ds_read_b64_tr_b16 v[52:53], v9 offset:0
    v_mfma_f32_16x16x32_bf16 v[196:199], v[80:83], v[116:119], v[196:199]
    ds_read_b64_tr_b16 v[54:55], v9 offset:512
    v_mfma_f32_16x16x32_bf16 v[200:203], v[80:83], v[120:123], v[200:203]
    v_mfma_f32_16x16x32_bf16 v[204:207], v[80:83], v[124:127], v[204:207]
    v_mfma_f32_16x16x32_bf16 v[220:223], v[84:87], v[124:127], v[220:223]
    v_mfma_f32_16x16x32_bf16 v[216:219], v[84:87], v[120:123], v[216:219]
    v_mfma_f32_16x16x32_bf16 v[212:215], v[84:87], v[116:119], v[212:215]
    v_mfma_f32_16x16x32_bf16 v[208:211], v[84:87], v[112:115], v[208:211]
    s_branch L_k_F
L_klast_F:
    v_mfma_f32_16x16x32_bf16 v[128:131], v[64:67], v[112:115], v[128:131]
    s_lshl_b32 s64, s73, 10
    s_add_u32 s64, s64, 155648
    v_mfma_f32_16x16x32_bf16 v[132:135], v[64:67], v[116:119], v[132:135]
    v_lshrrev_b32 v1, 2, v31
    v_lshl_add_u32 v1, v1, 6, s64
    v_mfma_f32_16x16x32_bf16 v[136:139], v[64:67], v[120:123], v[136:139]
    v_and_b32 v2, 3, v31
    v_lshl_add_u32 v1, v2, 2, v1
    v_mfma_f32_16x16x32_bf16 v[140:143], v[64:67], v[124:127], v[140:143]
    ds_read2_b32 v[96:97], v1 offset0:0 offset1:4
    ds_read_b32 v98, v1 offset:32
    v_mfma_f32_16x16x32_bf16 v[156:159], v[68:71], v[124:127], v[156:159]
    ds_read2_b32 v[100:101], v1 offset0:64 offset1:68
    ds_read_b32 v102, v1 offset:288
    v_mfma_f32_16x16x32_bf16 v[152:155], v[68:71], v[120:123], v[152:155]
    ds_read2_b32 v[104:105], v1 offset0:128 offset1:132
    ds_read_b32 v106, v1 offset:544
    v_mfma_f32_16x16x32_bf16 v[148:151], v[68:71], v[116:119], v[148:151]
    ds_read2_b32 v[108:109], v1 offset0:192 offset1:196
    ds_read_b32 v110, v1 offset:800
    v_mfma_f32_16x16x32_bf16 v[144:147], v[68:71], v[112:115], v[144:147]
    s_mul_i32 s64, s74, 384
    s_add_u32 s64, s64, 157696
    v_mfma_f32_16x16x32_bf16 v[160:163], v[72:75], v[112:115], v[160:163]
    v_lshl_add_u32 v2, v30, 4, s64
    ds_read_b128 v[32:35], v2 offset:0
    v_mfma_f32_16x16x32_bf16 v[164:167], v[72:75], v[116:119], v[164:167]
    ds_read_b128 v[36:39], v2 offset:64
    ds_read_b128 v[40:43], v2 offset:128
    v_mfma_f32_16x16x32_bf16 v[168:171], v[72:75], v[120:123], v[168:171]
    ds_read_b128 v[44:47], v2 offset:192
    ds_read_b128 v[48:51], v2 offset:256
    v_mfma_f32_16x16x32_bf16 v[172:175], v[72:75], v[124:127], v[172:175]
    ds_read_b128 v[52:55], v2 offset:320
    s_lshl_b32 s64, s55, 3
    v_mfma_f32_16x16x32_bf16 v[188:191], v[76:79], v[124:127], v[188:191]
    s_lshl_b32 s65, s73, 2
    s_add_u32 s64, s64, s65
    v_mfma_f32_16x16x32_bf16 v[184:187], v[76:79], v[120:123], v[184:187]
    s_mul_i32 s66, s64, 69632
    s_mul_i32 s64, s56, 6
    v_mfma_f32_16x16x32_bf16 v[180:183], v[76:79], v[116:119], v[180:183]
    s_mul_i32 s65, s74, 3
    s_add_u32 s64, s64, s65
    v_mfma_f32_16x16x32_bf16 v[176:179], v[76:79], v[112:115], v[176:179]
    s_lshl_b32 s64, s64, 10
    s_add_u32 s66, s66, s64
    v_mfma_f32_16x16x32_bf16 v[192:195], v[80:83], v[112:115], v[192:195]
    v_lshlrev_b32 v3, 4, v0
    v_mfma_f32_16x16x32_bf16 v[196:199], v[80:83], v[116:119], v[196:199]
    v_mfma_f32_16x16x32_bf16 v[200:203], v[80:83], v[120:123], v[200:203]
    v_mfma_f32_16x16x32_bf16 v[204:207], v[80:83], v[124:127], v[204:207]
    v_mfma_f32_16x16x32_bf16 v[220:223], v[84:87], v[124:127], v[220:223]
    v_mfma_f32_16x16x32_bf16 v[216:219], v[84:87], v[120:123], v[216:219]
    v_mfma_f32_16x16x32_bf16 v[212:215], v[84:87], v[116:119], v[212:215]
    v_mfma_f32_16x16x32_bf16 v[208:211], v[84:87], v[112:115], v[208:211]
    s_waitcnt lgkmcnt(0)
    v_sub_f32 v96, 0, v96
    v_mul_f32 v97, 0xbfb8aa3b, v97
    v_sub_f32 v100, 0, v100
    v_mul_f32 v101, 0xbfb8aa3b, v101
    v_sub_f32 v104, 0, v104
    v_mul_f32 v105, 0xbfb8aa3b, v105
    v_sub_f32_e64 v108, 0, v108
    v_mul_f32 v109, 0xbfb8aa3b, v109
    v_pk_fma_f32 v[128:129], v[32:33], v[96:97], v[128:129] op_sel_hi:[1,0,1]
    v_pk_fma_f32 v[130:131], v[34:35], v[96:97], v[130:131] op_sel_hi:[1,0,1]
    v_pk_fma_f32 v[144:145], v[36:37], v[96:97], v[144:145] op_sel_hi:[1,0,1]
    v_pk_fma_f32 v[146:147], v[38:39], v[96:97], v[146:147] op_sel_hi:[1,0,1]
    v_pk_mul_f32 v[56:57], v[128:129], v[96:97] op_sel:[0,1] op_sel_hi:[1,1]
    v_pk_mul_f32 v[58:59], v[130:131], v[96:97] op_sel:[0,1] op_sel_hi:[1,1]
    v_pk_mul_f32 v[60:61], v[144:145], v[96:97] op_sel:[0,1] op_sel_hi:[1,1]
    v_pk_mul_f32 v[62:63], v[146:147], v[96:97] op_sel:[0,1] op_sel_hi:[1,1]
    v_exp_f32 v56, v56
    v_exp_f32 v57, v57
    v_exp_f32 v58, v58
    v_exp_f32 v59, v59
    v_exp_f32 v60, v60
    v_exp_f32 v61, v61
    v_exp_f32 v62, v62
    v_exp_f32 v63, v63
    v_pk_fma_f32 v[56:57], v[56:57], v[98:99], v[98:99] op_sel_hi:[1,0,0]
    v_pk_fma_f32 v[58:59], v[58:59], v[98:99], v[98:99] op_sel_hi:[1,0,0]
    v_pk_fma_f32 v[60:61], v[60:61], v[98:99], v[98:99] op_sel_hi:[1,0,0]
    v_pk_fma_f32 v[62:63], v[62:63], v[98:99], v[98:99] op_sel_hi:[1,0,0]
    v_rcp_f32 v56, v56
    v_rcp_f32 v57, v57
    v_rcp_f32 v58, v58
    v_rcp_f32 v59, v59
    v_rcp_f32 v60, v60
    v_rcp_f32 v61, v61
    v_rcp_f32 v62, v62
    v_rcp_f32 v63, v63
    v_pk_mul_f32 v[56:57], v[56:57], v[128:129]
    v_pk_mul_f32 v[58:59], v[58:59], v[130:131]
    v_pk_mul_f32 v[60:61], v[60:61], v[144:145]
    v_pk_mul_f32 v[62:63], v[62:63], v[146:147]
    v_cvt_pk_bf16_f32 v72, v56, v57
    v_cvt_pk_bf16_f32 v73, v58, v59
    v_cvt_pk_bf16_f32 v74, v60, v61
    v_cvt_pk_bf16_f32 v75, v62, v63
    buffer_store_dwordx4 v[72:75], v3, s[24:27], s66 offen offset:0 sc1
    v_pk_fma_f32 v[160:161], v[40:41], v[96:97], v[160:161] op_sel_hi:[1,0,1]
    v_pk_fma_f32 v[162:163], v[42:43], v[96:97], v[162:163] op_sel_hi:[1,0,1]
    v_pk_fma_f32 v[176:177], v[44:45], v[96:97], v[176:177] op_sel_hi:[1,0,1]
    v_pk_fma_f32 v[178:179], v[46:47], v[96:97], v[178:179] op_sel_hi:[1,0,1]
    v_pk_mul_f32 v[64:65], v[160:161], v[96:97] op_sel:[0,1] op_sel_hi:[1,1]
    v_pk_mul_f32 v[66:67], v[162:163], v[96:97] op_sel:[0,1] op_sel_hi:[1,1]
    v_pk_mul_f32 v[68:69], v[176:177], v[96:97] op_sel:[0,1] op_sel_hi:[1,1]
    v_pk_mul_f32 v[70:71], v[178:179], v[96:97] op_sel:[0,1] op_sel_hi:[1,1]
    v_exp_f32 v64, v64
    v_exp_f32 v65, v65
    v_exp_f32 v66, v66
    v_exp_f32 v67, v67
    v_exp_f32 v68, v68
    v_exp_f32 v69, v69
    v_exp_f32 v70, v70
    v_exp_f32 v71, v71
    v_pk_fma_f32 v[64:65], v[64:65], v[98:99], v[98:99] op_sel_hi:[1,0,0]
    v_pk_fma_f32 v[66:67], v[66:67], v[98:99], v[98:99] op_sel_hi:[1,0,0]
    v_pk_fma_f32 v[68:69], v[68:69], v[98:99], v[98:99] op_sel_hi:[1,0,0]
    v_pk_fma_f32 v[70:71], v[70:71], v[98:99], v[98:99] op_sel_hi:[1,0,0]
    v_rcp_f32 v64, v64
    v_rcp_f32 v65, v65
    v_rcp_f32 v66, v66
    v_rcp_f32 v67, v67
    v_rcp_f32 v68, v68
    v_rcp_f32 v69, v69
    v_rcp_f32 v70, v70
    v_rcp_f32 v71, v71
    v_pk_mul_f32 v[64:65], v[64:65], v[160:161]
    v_pk_mul_f32 v[66:67], v[66:67], v[162:163]
    v_pk_mul_f32 v[68:69], v[68:69], v[176:177]
    v_pk_mul_f32 v[70:71], v[70:71], v[178:179]
    v_cvt_pk_bf16_f32 v76, v64, v65
    v_cvt_pk_bf16_f32 v77, v66, v67
    v_cvt_pk_bf16_f32 v78, v68, v69
    v_cvt_pk_bf16_f32 v79, v70, v71
    buffer_store_dwordx4 v[76:79], v3, s[24:27], s66 offen offset:1024 sc1
    v_pk_fma_f32 v[192:193], v[48:49], v[96:97], v[192:193] op_sel_hi:[1,0,1]
    v_pk_fma_f32 v[194:195], v[50:51], v[96:97], v[194:195] op_sel_hi:[1,0,1]
    v_pk_fma_f32 v[208:209], v[52:53], v[96:97], v[208:209] op_sel_hi:[1,0,1]
    v_pk_fma_f32 v[210:211], v[54:55], v[96:97], v[210:211] op_sel_hi:[1,0,1]
    v_pk_mul_f32 v[56:57], v[192:193], v[96:97] op_sel:[0,1] op_sel_hi:[1,1]
    v_pk_mul_f32 v[58:59], v[194:195], v[96:97] op_sel:[0,1] op_sel_hi:[1,1]
    v_pk_mul_f32 v[60:61], v[208:209], v[96:97] op_sel:[0,1] op_sel_hi:[1,1]
    v_pk_mul_f32 v[62:63], v[210:211], v[96:97] op_sel:[0,1] op_sel_hi:[1,1]
    v_exp_f32 v56, v56
    v_exp_f32 v57, v57
    v_exp_f32 v58, v58
    v_exp_f32 v59, v59
    v_exp_f32 v60, v60
    v_exp_f32 v61, v61
    v_exp_f32 v62, v62
    v_exp_f32 v63, v63
    v_pk_fma_f32 v[56:57], v[56:57], v[98:99], v[98:99] op_sel_hi:[1,0,0]
    v_pk_fma_f32 v[58:59], v[58:59], v[98:99], v[98:99] op_sel_hi:[1,0,0]
    v_pk_fma_f32 v[60:61], v[60:61], v[98:99], v[98:99] op_sel_hi:[1,0,0]
    v_pk_fma_f32 v[62:63], v[62:63], v[98:99], v[98:99] op_sel_hi:[1,0,0]
    v_rcp_f32 v56, v56
    v_rcp_f32 v57, v57
    v_rcp_f32 v58, v58
    v_rcp_f32 v59, v59
    v_rcp_f32 v60, v60
    v_rcp_f32 v61, v61
    v_rcp_f32 v62, v62
    v_rcp_f32 v63, v63
    v_pk_mul_f32 v[56:57], v[56:57], v[192:193]
    v_pk_mul_f32 v[58:59], v[58:59], v[194:195]
    v_pk_mul_f32 v[60:61], v[60:61], v[208:209]
    v_pk_mul_f32 v[62:63], v[62:63], v[210:211]
    v_cvt_pk_bf16_f32 v80, v56, v57
    v_cvt_pk_bf16_f32 v81, v58, v59
    v_cvt_pk_bf16_f32 v82, v60, v61
    v_cvt_pk_bf16_f32 v83, v62, v63
    buffer_store_dwordx4 v[80:83], v3, s[24:27], s66 offen offset:2048 sc1
    s_add_u32 s66, s66, 69632
    v_pk_fma_f32 v[132:133], v[32:33], v[100:101], v[132:133] op_sel_hi:[1,0,1]
    v_pk_fma_f32 v[134:135], v[34:35], v[100:101], v[134:135] op_sel_hi:[1,0,1]
    v_pk_fma_f32 v[148:149], v[36:37], v[100:101], v[148:149] op_sel_hi:[1,0,1]
    v_pk_fma_f32 v[150:151], v[38:39], v[100:101], v[150:151] op_sel_hi:[1,0,1]
    v_pk_mul_f32 v[64:65], v[132:133], v[100:101] op_sel:[0,1] op_sel_hi:[1,1]
    v_pk_mul_f32 v[66:67], v[134:135], v[100:101] op_sel:[0,1] op_sel_hi:[1,1]
    v_pk_mul_f32 v[68:69], v[148:149], v[100:101] op_sel:[0,1] op_sel_hi:[1,1]
    v_pk_mul_f32 v[70:71], v[150:151], v[100:101] op_sel:[0,1] op_sel_hi:[1,1]
    v_exp_f32 v64, v64
    v_exp_f32 v65, v65
    v_exp_f32 v66, v66
    v_exp_f32 v67, v67
    v_exp_f32 v68, v68
    v_exp_f32 v69, v69
    v_exp_f32 v70, v70
    v_exp_f32 v71, v71
    v_pk_fma_f32 v[64:65], v[64:65], v[102:103], v[102:103] op_sel_hi:[1,0,0]
    v_pk_fma_f32 v[66:67], v[66:67], v[102:103], v[102:103] op_sel_hi:[1,0,0]
    v_pk_fma_f32 v[68:69], v[68:69], v[102:103], v[102:103] op_sel_hi:[1,0,0]
    v_pk_fma_f32 v[70:71], v[70:71], v[102:103], v[102:103] op_sel_hi:[1,0,0]
    v_rcp_f32 v64, v64
    v_rcp_f32 v65, v65
    v_rcp_f32 v66, v66
    v_rcp_f32 v67, v67
    v_rcp_f32 v68, v68
    v_rcp_f32 v69, v69
    v_rcp_f32 v70, v70
    v_rcp_f32 v71, v71
    v_pk_mul_f32 v[64:65], v[64:65], v[132:133]
    v_pk_mul_f32 v[66:67], v[66:67], v[134:135]
    v_pk_mul_f32 v[68:69], v[68:69], v[148:149]
    v_pk_mul_f32 v[70:71], v[70:71], v[150:151]
    v_cvt_pk_bf16_f32 v84, v64, v65
    v_cvt_pk_bf16_f32 v85, v66, v67
    v_cvt_pk_bf16_f32 v86, v68, v69
    v_cvt_pk_bf16_f32 v87, v70, v71
    buffer_store_dwordx4 v[84:87], v3, s[24:27], s66 offen offset:0 sc1
    v_pk_fma_f32 v[164:165], v[40:41], v[100:101], v[164:165] op_sel_hi:[1,0,1]
    v_pk_fma_f32 v[166:167], v[42:43], v[100:101], v[166:167] op_sel_hi:[1,0,1]
    v_pk_fma_f32 v[180:181], v[44:45], v[100:101], v[180:181] op_sel_hi:[1,0,1]
    v_pk_fma_f32 v[182:183], v[46:47], v[100:101], v[182:183] op_sel_hi:[1,0,1]
    v_pk_mul_f32 v[56:57], v[164:165], v[100:101] op_sel:[0,1] op_sel_hi:[1,1]
    v_pk_mul_f32 v[58:59], v[166:167], v[100:101] op_sel:[0,1] op_sel_hi:[1,1]
    v_pk_mul_f32 v[60:61], v[180:181], v[100:101] op_sel:[0,1] op_sel_hi:[1,1]
    v_pk_mul_f32 v[62:63], v[182:183], v[100:101] op_sel:[0,1] op_sel_hi:[1,1]
    v_exp_f32 v56, v56
    v_exp_f32 v57, v57
    v_exp_f32 v58, v58
    v_exp_f32 v59, v59
    v_exp_f32 v60, v60
    v_exp_f32 v61, v61
    v_exp_f32 v62, v62
    v_exp_f32 v63, v63
    v_pk_fma_f32 v[56:57], v[56:57], v[102:103], v[102:103] op_sel_hi:[1,0,0]
    v_pk_fma_f32 v[58:59], v[58:59], v[102:103], v[102:103] op_sel_hi:[1,0,0]
    v_pk_fma_f32 v[60:61], v[60:61], v[102:103], v[102:103] op_sel_hi:[1,0,0]
    v_pk_fma_f32 v[62:63], v[62:63], v[102:103], v[102:103] op_sel_hi:[1,0,0]
    v_rcp_f32 v56, v56
    v_rcp_f32 v57, v57
    v_rcp_f32 v58, v58
    v_rcp_f32 v59, v59
    v_rcp_f32 v60, v60
    v_rcp_f32 v61, v61
    v_rcp_f32 v62, v62
    v_rcp_f32 v63, v63
    v_pk_mul_f32 v[56:57], v[56:57], v[164:165]
    v_pk_mul_f32 v[58:59], v[58:59], v[166:167]
    v_pk_mul_f32 v[60:61], v[60:61], v[180:181]
    v_pk_mul_f32 v[62:63], v[62:63], v[182:183]
    v_cvt_pk_bf16_f32 v72, v56, v57
    v_cvt_pk_bf16_f32 v73, v58, v59
    v_cvt_pk_bf16_f32 v74, v60, v61
    v_cvt_pk_bf16_f32 v75, v62, v63
    buffer_store_dwordx4 v[72:75], v3, s[24:27], s66 offen offset:1024 sc1
    v_pk_fma_f32 v[196:197], v[48:49], v[100:101], v[196:197] op_sel_hi:[1,0,1]
    v_pk_fma_f32 v[198:199], v[50:51], v[100:101], v[198:199] op_sel_hi:[1,0,1]
    v_pk_fma_f32 v[212:213], v[52:53], v[100:101], v[212:213] op_sel_hi:[1,0,1]
    v_pk_fma_f32 v[214:215], v[54:55], v[100:101], v[214:215] op_sel_hi:[1,0,1]
    v_pk_mul_f32 v[64:65], v[196:197], v[100:101] op_sel:[0,1] op_sel_hi:[1,1]
    v_pk_mul_f32 v[66:67], v[198:199], v[100:101] op_sel:[0,1] op_sel_hi:[1,1]
    v_pk_mul_f32 v[68:69], v[212:213], v[100:101] op_sel:[0,1] op_sel_hi:[1,1]
    v_pk_mul_f32 v[70:71], v[214:215], v[100:101] op_sel:[0,1] op_sel_hi:[1,1]
    v_exp_f32 v64, v64
    v_exp_f32 v65, v65
    v_exp_f32 v66, v66
    v_exp_f32 v67, v67
    v_exp_f32 v68, v68
    v_exp_f32 v69, v69
    v_exp_f32 v70, v70
    v_exp_f32 v71, v71
    v_pk_fma_f32 v[64:65], v[64:65], v[102:103], v[102:103] op_sel_hi:[1,0,0]
    v_pk_fma_f32 v[66:67], v[66:67], v[102:103], v[102:103] op_sel_hi:[1,0,0]
    v_pk_fma_f32 v[68:69], v[68:69], v[102:103], v[102:103] op_sel_hi:[1,0,0]
    v_pk_fma_f32 v[70:71], v[70:71], v[102:103], v[102:103] op_sel_hi:[1,0,0]
    v_rcp_f32 v64, v64
    v_rcp_f32 v65, v65
    v_rcp_f32 v66, v66
    v_rcp_f32 v67, v67
    v_rcp_f32 v68, v68
    v_rcp_f32 v69, v69
    v_rcp_f32 v70, v70
    v_rcp_f32 v71, v71
    v_pk_mul_f32 v[64:65], v[64:65], v[196:197]
    v_pk_mul_f32 v[66:67], v[66:67], v[198:199]
    v_pk_mul_f32 v[68:69], v[68:69], v[212:213]
    v_pk_mul_f32 v[70:71], v[70:71], v[214:215]
    v_cvt_pk_bf16_f32 v76, v64, v65
    v_cvt_pk_bf16_f32 v77, v66, v67
    v_cvt_pk_bf16_f32 v78, v68, v69
    v_cvt_pk_bf16_f32 v79, v70, v71
    buffer_store_dwordx4 v[76:79], v3, s[24:27], s66 offen offset:2048 sc1
    s_add_u32 s66, s66, 69632
    v_pk_fma_f32 v[136:137], v[32:33], v[104:105], v[136:137] op_sel_hi:[1,0,1]
    v_pk_fma_f32 v[138:139], v[34:35], v[104:105], v[138:139] op_sel_hi:[1,0,1]
    v_pk_fma_f32 v[152:153], v[36:37], v[104:105], v[152:153] op_sel_hi:[1,0,1]
    v_pk_fma_f32 v[154:155], v[38:39], v[104:105], v[154:155] op_sel_hi:[1,0,1]
    v_pk_mul_f32 v[56:57], v[136:137], v[104:105] op_sel:[0,1] op_sel_hi:[1,1]
    v_pk_mul_f32 v[58:59], v[138:139], v[104:105] op_sel:[0,1] op_sel_hi:[1,1]
    v_pk_mul_f32 v[60:61], v[152:153], v[104:105] op_sel:[0,1] op_sel_hi:[1,1]
    v_pk_mul_f32 v[62:63], v[154:155], v[104:105] op_sel:[0,1] op_sel_hi:[1,1]
    v_exp_f32 v56, v56
    v_exp_f32 v57, v57
    v_exp_f32 v58, v58
    v_exp_f32 v59, v59
    v_exp_f32 v60, v60
    v_exp_f32 v61, v61
    v_exp_f32 v62, v62
    v_exp_f32 v63, v63
    v_pk_fma_f32 v[56:57], v[56:57], v[106:107], v[106:107] op_sel_hi:[1,0,0]
    v_pk_fma_f32 v[58:59], v[58:59], v[106:107], v[106:107] op_sel_hi:[1,0,0]
    v_pk_fma_f32 v[60:61], v[60:61], v[106:107], v[106:107] op_sel_hi:[1,0,0]
    v_pk_fma_f32 v[62:63], v[62:63], v[106:107], v[106:107] op_sel_hi:[1,0,0]
    v_rcp_f32 v56, v56
    v_rcp_f32 v57, v57
    v_rcp_f32 v58, v58
    v_rcp_f32 v59, v59
    v_rcp_f32 v60, v60
    v_rcp_f32 v61, v61
    v_rcp_f32 v62, v62
    v_rcp_f32 v63, v63
    v_pk_mul_f32 v[56:57], v[56:57], v[136:137]
    v_pk_mul_f32 v[58:59], v[58:59], v[138:139]
    v_pk_mul_f32 v[60:61], v[60:61], v[152:153]
    v_pk_mul_f32 v[62:63], v[62:63], v[154:155]
    v_cvt_pk_bf16_f32 v80, v56, v57
    v_cvt_pk_bf16_f32 v81, v58, v59
    v_cvt_pk_bf16_f32 v82, v60, v61
    v_cvt_pk_bf16_f32 v83, v62, v63
    buffer_store_dwordx4 v[80:83], v3, s[24:27], s66 offen offset:0 sc1
    v_pk_fma_f32 v[168:169], v[40:41], v[104:105], v[168:169] op_sel_hi:[1,0,1]
    v_pk_fma_f32 v[170:171], v[42:43], v[104:105], v[170:171] op_sel_hi:[1,0,1]
    v_pk_fma_f32 v[184:185], v[44:45], v[104:105], v[184:185] op_sel_hi:[1,0,1]
    v_pk_fma_f32 v[186:187], v[46:47], v[104:105], v[186:187] op_sel_hi:[1,0,1]
    v_pk_mul_f32 v[64:65], v[168:169], v[104:105] op_sel:[0,1] op_sel_hi:[1,1]
    v_pk_mul_f32 v[66:67], v[170:171], v[104:105] op_sel:[0,1] op_sel_hi:[1,1]
    v_pk_mul_f32 v[68:69], v[184:185], v[104:105] op_sel:[0,1] op_sel_hi:[1,1]
    v_pk_mul_f32 v[70:71], v[186:187], v[104:105] op_sel:[0,1] op_sel_hi:[1,1]
    v_exp_f32 v64, v64
    v_exp_f32 v65, v65
    v_exp_f32 v66, v66
    v_exp_f32 v67, v67
    v_exp_f32 v68, v68
    v_exp_f32 v69, v69
    v_exp_f32 v70, v70
    v_exp_f32 v71, v71
    v_pk_fma_f32 v[64:65], v[64:65], v[106:107], v[106:107] op_sel_hi:[1,0,0]
    v_pk_fma_f32 v[66:67], v[66:67], v[106:107], v[106:107] op_sel_hi:[1,0,0]
    v_pk_fma_f32 v[68:69], v[68:69], v[106:107], v[106:107] op_sel_hi:[1,0,0]
    v_pk_fma_f32 v[70:71], v[70:71], v[106:107], v[106:107] op_sel_hi:[1,0,0]
    v_rcp_f32 v64, v64
    v_rcp_f32 v65, v65
    v_rcp_f32 v66, v66
    v_rcp_f32 v67, v67
    v_rcp_f32 v68, v68
    v_rcp_f32 v69, v69
    v_rcp_f32 v70, v70
    v_rcp_f32 v71, v71
    v_pk_mul_f32 v[64:65], v[64:65], v[168:169]
    v_pk_mul_f32 v[66:67], v[66:67], v[170:171]
    v_pk_mul_f32 v[68:69], v[68:69], v[184:185]
    v_pk_mul_f32 v[70:71], v[70:71], v[186:187]
    v_cvt_pk_bf16_f32 v84, v64, v65
    v_cvt_pk_bf16_f32 v85, v66, v67
    v_cvt_pk_bf16_f32 v86, v68, v69
    v_cvt_pk_bf16_f32 v87, v70, v71
    buffer_store_dwordx4 v[84:87], v3, s[24:27], s66 offen offset:1024 sc1
    v_pk_fma_f32 v[200:201], v[48:49], v[104:105], v[200:201] op_sel_hi:[1,0,1]
    v_pk_fma_f32 v[202:203], v[50:51], v[104:105], v[202:203] op_sel_hi:[1,0,1]
    v_pk_fma_f32 v[216:217], v[52:53], v[104:105], v[216:217] op_sel_hi:[1,0,1]
    v_pk_fma_f32 v[218:219], v[54:55], v[104:105], v[218:219] op_sel_hi:[1,0,1]
    v_pk_mul_f32 v[56:57], v[200:201], v[104:105] op_sel:[0,1] op_sel_hi:[1,1]
    v_pk_mul_f32 v[58:59], v[202:203], v[104:105] op_sel:[0,1] op_sel_hi:[1,1]
    v_pk_mul_f32 v[60:61], v[216:217], v[104:105] op_sel:[0,1] op_sel_hi:[1,1]
    v_pk_mul_f32 v[62:63], v[218:219], v[104:105] op_sel:[0,1] op_sel_hi:[1,1]
    v_exp_f32 v56, v56
    v_exp_f32 v57, v57
    v_exp_f32 v58, v58
    v_exp_f32 v59, v59
    v_exp_f32 v60, v60
    v_exp_f32 v61, v61
    v_exp_f32 v62, v62
    v_exp_f32 v63, v63
    v_pk_fma_f32 v[56:57], v[56:57], v[106:107], v[106:107] op_sel_hi:[1,0,0]
    v_pk_fma_f32 v[58:59], v[58:59], v[106:107], v[106:107] op_sel_hi:[1,0,0]
    v_pk_fma_f32 v[60:61], v[60:61], v[106:107], v[106:107] op_sel_hi:[1,0,0]
    v_pk_fma_f32 v[62:63], v[62:63], v[106:107], v[106:107] op_sel_hi:[1,0,0]
    v_rcp_f32 v56, v56
    v_rcp_f32 v57, v57
    v_rcp_f32 v58, v58
    v_rcp_f32 v59, v59
    v_rcp_f32 v60, v60
    v_rcp_f32 v61, v61
    v_rcp_f32 v62, v62
    v_rcp_f32 v63, v63
    v_pk_mul_f32 v[56:57], v[56:57], v[200:201]
    v_pk_mul_f32 v[58:59], v[58:59], v[202:203]
    v_pk_mul_f32 v[60:61], v[60:61], v[216:217]
    v_pk_mul_f32 v[62:63], v[62:63], v[218:219]
    v_cvt_pk_bf16_f32 v72, v56, v57
    v_cvt_pk_bf16_f32 v73, v58, v59
    v_cvt_pk_bf16_f32 v74, v60, v61
    v_cvt_pk_bf16_f32 v75, v62, v63
    buffer_store_dwordx4 v[72:75], v3, s[24:27], s66 offen offset:2048 sc1
    s_add_u32 s66, s66, 69632
    v_pk_fma_f32 v[140:141], v[32:33], v[108:109], v[140:141] op_sel_hi:[1,0,1]
    v_pk_fma_f32 v[142:143], v[34:35], v[108:109], v[142:143] op_sel_hi:[1,0,1]
    v_pk_fma_f32 v[156:157], v[36:37], v[108:109], v[156:157] op_sel_hi:[1,0,1]
    v_pk_fma_f32 v[158:159], v[38:39], v[108:109], v[158:159] op_sel_hi:[1,0,1]
    v_pk_mul_f32 v[64:65], v[140:141], v[108:109] op_sel:[0,1] op_sel_hi:[1,1]
    v_pk_mul_f32 v[66:67], v[142:143], v[108:109] op_sel:[0,1] op_sel_hi:[1,1]
    v_pk_mul_f32 v[68:69], v[156:157], v[108:109] op_sel:[0,1] op_sel_hi:[1,1]
    v_pk_mul_f32 v[70:71], v[158:159], v[108:109] op_sel:[0,1] op_sel_hi:[1,1]
    v_exp_f32 v64, v64
    v_exp_f32 v65, v65
    v_exp_f32 v66, v66
    v_exp_f32 v67, v67
    v_exp_f32 v68, v68
    v_exp_f32 v69, v69
    v_exp_f32 v70, v70
    v_exp_f32 v71, v71
    v_pk_fma_f32 v[64:65], v[64:65], v[110:111], v[110:111] op_sel_hi:[1,0,0]
    v_pk_fma_f32 v[66:67], v[66:67], v[110:111], v[110:111] op_sel_hi:[1,0,0]
    v_pk_fma_f32 v[68:69], v[68:69], v[110:111], v[110:111] op_sel_hi:[1,0,0]
    v_pk_fma_f32 v[70:71], v[70:71], v[110:111], v[110:111] op_sel_hi:[1,0,0]
    v_rcp_f32 v64, v64
    v_rcp_f32 v65, v65
    v_rcp_f32 v66, v66
    v_rcp_f32 v67, v67
    v_rcp_f32 v68, v68
    v_rcp_f32 v69, v69
    v_rcp_f32 v70, v70
    v_rcp_f32 v71, v71
    v_pk_mul_f32 v[64:65], v[64:65], v[140:141]
    v_pk_mul_f32 v[66:67], v[66:67], v[142:143]
    v_pk_mul_f32 v[68:69], v[68:69], v[156:157]
    v_pk_mul_f32 v[70:71], v[70:71], v[158:159]
    v_cvt_pk_bf16_f32 v76, v64, v65
    v_cvt_pk_bf16_f32 v77, v66, v67
    v_cvt_pk_bf16_f32 v78, v68, v69
    v_cvt_pk_bf16_f32 v79, v70, v71
    buffer_store_dwordx4 v[76:79], v3, s[24:27], s66 offen offset:0 sc1
    v_pk_fma_f32 v[172:173], v[40:41], v[108:109], v[172:173] op_sel_hi:[1,0,1]
    v_pk_fma_f32 v[174:175], v[42:43], v[108:109], v[174:175] op_sel_hi:[1,0,1]
    v_pk_fma_f32 v[188:189], v[44:45], v[108:109], v[188:189] op_sel_hi:[1,0,1]
    v_pk_fma_f32 v[190:191], v[46:47], v[108:109], v[190:191] op_sel_hi:[1,0,1]
    v_pk_mul_f32 v[56:57], v[172:173], v[108:109] op_sel:[0,1] op_sel_hi:[1,1]
    v_pk_mul_f32 v[58:59], v[174:175], v[108:109] op_sel:[0,1] op_sel_hi:[1,1]
    v_pk_mul_f32 v[60:61], v[188:189], v[108:109] op_sel:[0,1] op_sel_hi:[1,1]
    v_pk_mul_f32 v[62:63], v[190:191], v[108:109] op_sel:[0,1] op_sel_hi:[1,1]
    v_exp_f32 v56, v56
    v_exp_f32 v57, v57
    v_exp_f32 v58, v58
    v_exp_f32 v59, v59
    v_exp_f32 v60, v60
    v_exp_f32 v61, v61
    v_exp_f32 v62, v62
    v_exp_f32 v63, v63
    v_pk_fma_f32 v[56:57], v[56:57], v[110:111], v[110:111] op_sel_hi:[1,0,0]
    v_pk_fma_f32 v[58:59], v[58:59], v[110:111], v[110:111] op_sel_hi:[1,0,0]
    v_pk_fma_f32 v[60:61], v[60:61], v[110:111], v[110:111] op_sel_hi:[1,0,0]
    v_pk_fma_f32 v[62:63], v[62:63], v[110:111], v[110:111] op_sel_hi:[1,0,0]
    v_rcp_f32 v56, v56
    v_rcp_f32 v57, v57
    v_rcp_f32 v58, v58
    v_rcp_f32 v59, v59
    v_rcp_f32 v60, v60
    v_rcp_f32 v61, v61
    v_rcp_f32 v62, v62
    v_rcp_f32 v63, v63
    v_pk_mul_f32 v[56:57], v[56:57], v[172:173]
    v_pk_mul_f32 v[58:59], v[58:59], v[174:175]
    v_pk_mul_f32 v[60:61], v[60:61], v[188:189]
    v_pk_mul_f32 v[62:63], v[62:63], v[190:191]
    v_cvt_pk_bf16_f32 v80, v56, v57
    v_cvt_pk_bf16_f32 v81, v58, v59
    v_cvt_pk_bf16_f32 v82, v60, v61
    v_cvt_pk_bf16_f32 v83, v62, v63
    buffer_store_dwordx4 v[80:83], v3, s[24:27], s66 offen offset:1024 sc1
    v_pk_fma_f32 v[204:205], v[48:49], v[108:109], v[204:205] op_sel_hi:[1,0,1]
    v_pk_fma_f32 v[206:207], v[50:51], v[108:109], v[206:207] op_sel_hi:[1,0,1]
    v_pk_fma_f32 v[220:221], v[52:53], v[108:109], v[220:221] op_sel_hi:[1,0,1]
    v_pk_fma_f32 v[222:223], v[54:55], v[108:109], v[222:223] op_sel_hi:[1,0,1]
    v_pk_mul_f32 v[64:65], v[204:205], v[108:109] op_sel:[0,1] op_sel_hi:[1,1]
    v_pk_mul_f32 v[66:67], v[206:207], v[108:109] op_sel:[0,1] op_sel_hi:[1,1]
    v_pk_mul_f32 v[68:69], v[220:221], v[108:109] op_sel:[0,1] op_sel_hi:[1,1]
    v_pk_mul_f32 v[70:71], v[222:223], v[108:109] op_sel:[0,1] op_sel_hi:[1,1]
    v_exp_f32 v64, v64
    v_exp_f32 v65, v65
    v_exp_f32 v66, v66
    v_exp_f32 v67, v67
    v_exp_f32 v68, v68
    v_exp_f32 v69, v69
    v_exp_f32 v70, v70
    v_exp_f32 v71, v71
    v_pk_fma_f32 v[64:65], v[64:65], v[110:111], v[110:111] op_sel_hi:[1,0,0]
    v_pk_fma_f32 v[66:67], v[66:67], v[110:111], v[110:111] op_sel_hi:[1,0,0]
    v_pk_fma_f32 v[68:69], v[68:69], v[110:111], v[110:111] op_sel_hi:[1,0,0]
    v_pk_fma_f32 v[70:71], v[70:71], v[110:111], v[110:111] op_sel_hi:[1,0,0]
    v_rcp_f32 v64, v64
    v_rcp_f32 v65, v65
    v_rcp_f32 v66, v66
    v_rcp_f32 v67, v67
    v_rcp_f32 v68, v68
    v_rcp_f32 v69, v69
    v_rcp_f32 v70, v70
    v_rcp_f32 v71, v71
    v_pk_mul_f32 v[64:65], v[64:65], v[204:205]
    v_pk_mul_f32 v[66:67], v[66:67], v[206:207]
    v_pk_mul_f32 v[68:69], v[68:69], v[220:221]
    v_pk_mul_f32 v[70:71], v[70:71], v[222:223]
    v_cvt_pk_bf16_f32 v84, v64, v65
    v_cvt_pk_bf16_f32 v85, v66, v67
    v_cvt_pk_bf16_f32 v86, v68, v69
    v_cvt_pk_bf16_f32 v87, v70, v71
    buffer_store_dwordx4 v[84:87], v3, s[24:27], s66 offen offset:2048 sc1
    s_lshl_b32 s64, s55, 7
    s_add_u32 s64, s64, 0x918000
    v_mov_b32 v252, 158724
    v_mov_b32 v253, 1
    v_mov_b32 v255, s64
    s_mov_b64 exec, 1
    s_waitcnt vmcnt(0)
    ds_add_rtn_u32 v254, v252, v253
    s_waitcnt lgkmcnt(0)
    v_cmp_eq_u32 vcc, 3, v254
    s_cbranch_vccz L_arr_91
    buffer_atomic_add v253, v255, s[24:27], 0 offen
L_arr_91:
    s_mov_b64 exec, -1
    v_lshrrev_b32 v152, 4, v0
    v_and_b32 v153, 15, v0
    s_mul_i32 s64, s73, 3072
    v_lshl_add_u32 v2, v0, 4, s64
    v_lshrrev_b32 v1, 2, v0
    v_lshrrev_b32 v3, 3, v0
    v_and_b32 v3, 3, v3
    s_lshl_b32 s64, s74, 1
    v_xor_b32 v3, s64, v3
    v_lshlrev_b32 v3, 5, v3
    v_lshl_add_u32 v3, v1, 7, v3
    v_and_b32 v1, 3, v0
    v_lshl_add_u32 v3, v1, 3, v3
    v_add_u32 v3, 73728, v3
    v_xor_b32 v4, 32, v3
    v_bfe_u32 v1, v153, 1, 2
    v_xor_b32 v1, s64, v1
    v_lshlrev_b32_e64 v1, 5, v1
    v_lshl_add_u32 v1, v153, 7, v1
    v_lshl_add_u32 v1, v152, 3, v1
    s_mul_i32 s64, s73, 6144
    s_add_u32 s64, s64, 106496
    v_add_u32 v5, s64, v1
    v_xor_b32 v6, 32, v5
    v_lshrrev_b32 v1, 4, v0
    v_lshlrev_b32 v1, 1, v1
    v_xor_b32 v1, v1, v0
    v_and_b32 v1, 7, v1
    v_lshlrev_b32 v1, 4, v1
    v_lshrrev_b32 v7, 3, v0
    v_mul_u32_u24 v7, 1280, v7
    v_add_u32 v7, v7, v1
    v_mov_b32 v128, 0
    v_mov_b32 v129, 0
    v_mov_b32 v130, 0
    v_mov_b32 v131, 0
    v_mov_b32 v132, 0
    v_mov_b32 v133, 0
    v_mov_b32 v134, 0
    v_mov_b32 v135, 0
    v_mov_b32 v136, 0
    v_mov_b32 v137, 0
    v_mov_b32 v138, 0
    v_mov_b32 v139, 0
    v_mov_b32 v140, 0
    v_mov_b32 v141, 0
    v_mov_b32 v142, 0
    v_mov_b32 v143, 0
    v_mov_b32 v144, 0
    v_mov_b32 v145, 0
    v_mov_b32 v146, 0
    v_mov_b32 v147, 0
    v_mov_b32 v148, 0
    v_mov_b32 v149, 0
    v_mov_b32 v150, 0
    v_mov_b32 v151, 0
    s_mov_b32 s77, 4
    s_mov_b32 s75, 1
    s_mov_b32 s76, 4
    s_barrier
    ds_read_b64_tr_b16 v[44:45], v3 offset:0
    ds_read_b64_tr_b16 v[46:47], v3 offset:2048
    ds_read_b64_tr_b16 v[48:49], v4 offset:0
    ds_read_b64_tr_b16 v[50:51], v4 offset:2048
    ds_read_b64_tr_b16 v[64:65], v3 offset:4096
    ds_read_b64_tr_b16 v[66:67], v3 offset:6144
    ds_read_b64_tr_b16 v[68:69], v4 offset:4096
    ds_read_b64_tr_b16 v[70:71], v4 offset:6144
    ds_read_b64_tr_b16 v[84:85], v3 offset:8192
    ds_read_b64_tr_b16 v[86:87], v3 offset:10240
    ds_read_b64_tr_b16 v[88:89], v4 offset:8192
    ds_read_b64_tr_b16 v[90:91], v4 offset:10240
    ds_read_b64_tr_b16 v[104:105], v3 offset:12288
    ds_read_b64_tr_b16 v[106:107], v3 offset:14336
    ds_read_b64_tr_b16 v[108:109], v4 offset:12288
    ds_read_b64_tr_b16 v[110:111], v4 offset:14336
    ds_read_b64_tr_b16 v[152:153], v3 offset:16384
    ds_read_b64_tr_b16 v[154:155], v3 offset:18432
    ds_read_b64_tr_b16 v[156:157], v4 offset:16384
    ds_read_b64_tr_b16 v[158:159], v4 offset:18432
    ds_read_b64_tr_b16 v[160:161], v3 offset:20480
    ds_read_b64_tr_b16 v[162:163], v3 offset:22528
    ds_read_b64_tr_b16 v[164:165], v4 offset:20480
    ds_read_b64_tr_b16 v[166:167], v4 offset:22528
    ds_read_b64_tr_b16 v[168:169], v3 offset:24576
    ds_read_b64_tr_b16 v[170:171], v3 offset:26624
    ds_read_b64_tr_b16 v[172:173], v4 offset:24576
    ds_read_b64_tr_b16 v[174:175], v4 offset:26624
    ds_read_b64_tr_b16 v[176:177], v3 offset:28672
    ds_read_b64_tr_b16 v[178:179], v3 offset:30720
    ds_read_b64_tr_b16 v[180:181], v4 offset:28672
    ds_read_b64_tr_b16 v[182:183], v4 offset:30720
    ds_read_b64_tr_b16 v[184:185], v3 offset:32768
    ds_read_b64_tr_b16 v[186:187], v3 offset:34816
    ds_read_b64_tr_b16 v[188:189], v4 offset:32768
    ds_read_b64_tr_b16 v[190:191], v4 offset:34816
    ds_read_b64_tr_b16 v[192:193], v3 offset:36864
    ds_read_b64_tr_b16 v[194:195], v3 offset:38912
    ds_read_b64_tr_b16 v[196:197], v4 offset:36864
    ds_read_b64_tr_b16 v[198:199], v4 offset:38912
    ds_read_b64_tr_b16 v[200:201], v3 offset:40960
    ds_read_b64_tr_b16 v[202:203], v3 offset:43008
    ds_read_b64_tr_b16 v[204:205], v4 offset:40960
    ds_read_b64_tr_b16 v[206:207], v4 offset:43008
    ds_read_b64_tr_b16 v[208:209], v3 offset:45056
    ds_read_b64_tr_b16 v[210:211], v3 offset:47104
    ds_read_b64_tr_b16 v[212:213], v4 offset:45056
    ds_read_b64_tr_b16 v[214:215], v4 offset:47104
    ds_read_b64_tr_b16 v[216:217], v3 offset:49152
    ds_read_b64_tr_b16 v[218:219], v3 offset:51200
    ds_read_b64_tr_b16 v[220:221], v4 offset:49152
    ds_read_b64_tr_b16 v[222:223], v4 offset:51200
    ds_read_b64_tr_b16 v[224:225], v3 offset:53248
    ds_read_b64_tr_b16 v[226:227], v3 offset:55296
    ds_read_b64_tr_b16 v[228:229], v4 offset:53248
    ds_read_b64_tr_b16 v[230:231], v4 offset:55296
    ds_read_b64_tr_b16 v[232:233], v3 offset:57344
    ds_read_b64_tr_b16 v[234:235], v3 offset:59392
    ds_read_b64_tr_b16 v[236:237], v4 offset:57344
    ds_read_b64_tr_b16 v[238:239], v4 offset:59392
    ds_read_b64_tr_b16 v[240:241], v3 offset:61440
    ds_read_b64_tr_b16 v[242:243], v3 offset:63488
    ds_read_b64_tr_b16 v[244:245], v4 offset:61440
    ds_read_b64_tr_b16 v[246:247], v4 offset:63488
    v_add_u32 v3, 65536, v3
    v_add_u32 v4, 65536, v4
    s_waitcnt lgkmcnt(0)
    s_barrier
    s_barrier
    ds_read_b128 v[32:35], v2 offset:0
    ds_read_b128 v[36:39], v2 offset:1024
    ds_read_b128 v[40:43], v2 offset:2048
    ds_read_b128 v[52:55], v2 offset:6144
    ds_read_b128 v[56:59], v2 offset:7168
    ds_read_b128 v[60:63], v2 offset:8192
    s_waitcnt lgkmcnt(3)
    v_mfma_f32_16x16x32_bf16 v[128:131], v[44:47], v[32:35], v[128:131]
    ds_read_b128 v[72:75], v2 offset:12288
    v_mfma_f32_16x16x32_bf16 v[132:135], v[48:51], v[32:35], v[132:135]
    ds_read_b128 v[76:79], v2 offset:13312
    v_mfma_f32_16x16x32_bf16 v[140:143], v[48:51], v[36:39], v[140:143]
    ds_read_b128 v[80:83], v2 offset:14336
    v_mfma_f32_16x16x32_bf16 v[136:139], v[44:47], v[36:39], v[136:139]
    v_mfma_f32_16x16x32_bf16 v[144:147], v[44:47], v[40:43], v[144:147]
    v_mfma_f32_16x16x32_bf16 v[148:151], v[48:51], v[40:43], v[148:151]
    s_waitcnt lgkmcnt(3)
    v_mfma_f32_16x16x32_bf16 v[128:131], v[64:67], v[52:55], v[128:131]
    ds_read_b128 v[92:95], v2 offset:18432
    v_mfma_f32_16x16x32_bf16 v[132:135], v[68:71], v[52:55], v[132:135]
    ds_read_b128 v[96:99], v2 offset:19456
    v_mfma_f32_16x16x32_bf16 v[140:143], v[68:71], v[56:59], v[140:143]
    ds_read_b128 v[100:103], v2 offset:20480
    v_mfma_f32_16x16x32_bf16 v[136:139], v[64:67], v[56:59], v[136:139]
    v_mfma_f32_16x16x32_bf16 v[144:147], v[64:67], v[60:63], v[144:147]
    v_mfma_f32_16x16x32_bf16 v[148:151], v[68:71], v[60:63], v[148:151]
    s_waitcnt lgkmcnt(3)
    v_mfma_f32_16x16x32_bf16 v[128:131], v[84:87], v[72:75], v[128:131]
    v_add_u32 v2, 0x6000, v2
    v_mfma_f32_16x16x32_bf16 v[132:135], v[88:91], v[72:75], v[132:135]
    v_mfma_f32_16x16x32_bf16 v[140:143], v[88:91], v[76:79], v[140:143]
    v_mfma_f32_16x16x32_bf16 v[136:139], v[84:87], v[76:79], v[136:139]
    v_mfma_f32_16x16x32_bf16 v[144:147], v[84:87], v[80:83], v[144:147]
    v_mfma_f32_16x16x32_bf16 v[148:151], v[88:91], v[80:83], v[148:151]
    s_waitcnt lgkmcnt(0)
    s_barrier
    v_mfma_f32_16x16x32_bf16 v[128:131], v[104:107], v[92:95], v[128:131]
    ds_read_b128 v[32:35], v2 offset:0
    ds_read_b128 v[36:39], v2 offset:1024
    ds_read_b128 v[40:43], v2 offset:2048
    v_mfma_f32_16x16x32_bf16 v[132:135], v[108:111], v[92:95], v[132:135]
    ds_read_b128 v[52:55], v2 offset:6144
    ds_read_b128 v[56:59], v2 offset:7168
    ds_read_b128 v[60:63], v2 offset:8192
    v_mfma_f32_16x16x32_bf16 v[140:143], v[108:111], v[96:99], v[140:143]
    v_mfma_f32_16x16x32_bf16 v[136:139], v[104:107], v[96:99], v[136:139]
    v_mfma_f32_16x16x32_bf16 v[144:147], v[104:107], v[100:103], v[144:147]
    v_mfma_f32_16x16x32_bf16 v[148:151], v[108:111], v[100:103], v[148:151]
    s_waitcnt lgkmcnt(3)
    v_mfma_f32_16x16x32_bf16 v[128:131], v[152:155], v[32:35], v[128:131]
    ds_read_b128 v[72:75], v2 offset:12288
    v_mfma_f32_16x16x32_bf16 v[132:135], v[156:159], v[32:35], v[132:135]
    ds_read_b128 v[76:79], v2 offset:13312
    v_mfma_f32_16x16x32_bf16 v[140:143], v[156:159], v[36:39], v[140:143]
    ds_read_b128 v[80:83], v2 offset:14336
    v_mfma_f32_16x16x32_bf16 v[136:139], v[152:155], v[36:39], v[136:139]
    v_mfma_f32_16x16x32_bf16 v[144:147], v[152:155], v[40:43], v[144:147]
    v_mfma_f32_16x16x32_bf16 v[148:151], v[156:159], v[40:43], v[148:151]
    s_waitcnt lgkmcnt(3)
    v_mfma_f32_16x16x32_bf16 v[128:131], v[160:163], v[52:55], v[128:131]
    ds_read_b128 v[92:95], v2 offset:18432
    v_mfma_f32_16x16x32_bf16 v[132:135], v[164:167], v[52:55], v[132:135]
    ds_read_b128 v[96:99], v2 offset:19456
    v_mfma_f32_16x16x32_bf16 v[140:143], v[164:167], v[56:59], v[140:143]
    ds_read_b128 v[100:103], v2 offset:20480
    v_mfma_f32_16x16x32_bf16 v[136:139], v[160:163], v[56:59], v[136:139]
    v_mfma_f32_16x16x32_bf16 v[144:147], v[160:163], v[60:63], v[144:147]
    v_mfma_f32_16x16x32_bf16 v[148:151], v[164:167], v[60:63], v[148:151]
    s_waitcnt lgkmcnt(3)
    v_mfma_f32_16x16x32_bf16 v[128:131], v[168:171], v[72:75], v[128:131]
    v_add_u32 v2, 0x6000, v2
    v_mfma_f32_16x16x32_bf16 v[132:135], v[172:175], v[72:75], v[132:135]
    v_mfma_f32_16x16x32_bf16 v[140:143], v[172:175], v[76:79], v[140:143]
    v_mfma_f32_16x16x32_bf16 v[136:139], v[168:171], v[76:79], v[136:139]
    v_mfma_f32_16x16x32_bf16 v[144:147], v[168:171], v[80:83], v[144:147]
    v_mfma_f32_16x16x32_bf16 v[148:151], v[172:175], v[80:83], v[148:151]
    s_waitcnt lgkmcnt(0)
    s_barrier
    v_mfma_f32_16x16x32_bf16 v[128:131], v[176:179], v[92:95], v[128:131]
    ds_read_b128 v[32:35], v2 offset:0
    ds_read_b128 v[36:39], v2 offset:1024
    ds_read_b128 v[40:43], v2 offset:2048
    v_mfma_f32_16x16x32_bf16 v[132:135], v[180:183], v[92:95], v[132:135]
    ds_read_b128 v[52:55], v2 offset:6144
    ds_read_b128 v[56:59], v2 offset:7168
    ds_read_b128 v[60:63], v2 offset:8192
    v_mfma_f32_16x16x32_bf16 v[140:143], v[180:183], v[96:99], v[140:143]
    v_mfma_f32_16x16x32_bf16 v[136:139], v[176:179], v[96:99], v[136:139]
    v_mfma_f32_16x16x32_bf16 v[144:147], v[176:179], v[100:103], v[144:147]
    v_mfma_f32_16x16x32_bf16 v[148:151], v[180:183], v[100:103], v[148:151]
    s_waitcnt lgkmcnt(3)
    v_mfma_f32_16x16x32_bf16 v[128:131], v[184:187], v[32:35], v[128:131]
    ds_read_b128 v[72:75], v2 offset:12288
    v_mfma_f32_16x16x32_bf16 v[132:135], v[188:191], v[32:35], v[132:135]
    ds_read_b128 v[76:79], v2 offset:13312
    v_mfma_f32_16x16x32_bf16 v[140:143], v[188:191], v[36:39], v[140:143]
    ds_read_b128 v[80:83], v2 offset:14336
    v_mfma_f32_16x16x32_bf16 v[136:139], v[184:187], v[36:39], v[136:139]
    v_mfma_f32_16x16x32_bf16 v[144:147], v[184:187], v[40:43], v[144:147]
    v_mfma_f32_16x16x32_bf16 v[148:151], v[188:191], v[40:43], v[148:151]
    s_waitcnt lgkmcnt(3)
    v_mfma_f32_16x16x32_bf16 v[128:131], v[192:195], v[52:55], v[128:131]
    ds_read_b128 v[92:95], v2 offset:18432
    v_mfma_f32_16x16x32_bf16 v[132:135], v[196:199], v[52:55], v[132:135]
    ds_read_b128 v[96:99], v2 offset:19456
    v_mfma_f32_16x16x32_bf16 v[140:143], v[196:199], v[56:59], v[140:143]
    ds_read_b128 v[100:103], v2 offset:20480
    v_mfma_f32_16x16x32_bf16 v[136:139], v[192:195], v[56:59], v[136:139]
    v_mfma_f32_16x16x32_bf16 v[144:147], v[192:195], v[60:63], v[144:147]
    v_mfma_f32_16x16x32_bf16 v[148:151], v[196:199], v[60:63], v[148:151]
    s_waitcnt lgkmcnt(3)
    v_mfma_f32_16x16x32_bf16 v[128:131], v[200:203], v[72:75], v[128:131]
    v_add_u32 v2, 0xffff4000, v2
    v_mfma_f32_16x16x32_bf16 v[132:135], v[204:207], v[72:75], v[132:135]
    v_mfma_f32_16x16x32_bf16 v[140:143], v[204:207], v[76:79], v[140:143]
    v_mfma_f32_16x16x32_bf16 v[136:139], v[200:203], v[76:79], v[136:139]
    v_mfma_f32_16x16x32_bf16 v[144:147], v[200:203], v[80:83], v[144:147]
    v_mfma_f32_16x16x32_bf16 v[148:151], v[204:207], v[80:83], v[148:151]
    s_waitcnt lgkmcnt(0)
    s_barrier
    v_mfma_f32_16x16x32_bf16 v[128:131], v[208:211], v[92:95], v[128:131]
    ds_read_b128 v[32:35], v2 offset:0
    ds_read_b128 v[36:39], v2 offset:1024
    ds_read_b128 v[40:43], v2 offset:2048
    v_mfma_f32_16x16x32_bf16 v[132:135], v[212:215], v[92:95], v[132:135]
    ds_read_b128 v[52:55], v2 offset:6144
    ds_read_b128 v[56:59], v2 offset:7168
    ds_read_b128 v[60:63], v2 offset:8192
    v_mfma_f32_16x16x32_bf16 v[140:143], v[212:215], v[96:99], v[140:143]
    v_mfma_f32_16x16x32_bf16 v[136:139], v[208:211], v[96:99], v[136:139]
    v_mfma_f32_16x16x32_bf16 v[144:147], v[208:211], v[100:103], v[144:147]
    v_mfma_f32_16x16x32_bf16 v[148:151], v[212:215], v[100:103], v[148:151]
    s_waitcnt lgkmcnt(3)
    v_mfma_f32_16x16x32_bf16 v[128:131], v[216:219], v[32:35], v[128:131]
    ds_read_b128 v[72:75], v2 offset:12288
    v_mfma_f32_16x16x32_bf16 v[132:135], v[220:223], v[32:35], v[132:135]
    ds_read_b128 v[76:79], v2 offset:13312
    v_mfma_f32_16x16x32_bf16 v[140:143], v[220:223], v[36:39], v[140:143]
    ds_read_b128 v[80:83], v2 offset:14336
    v_mfma_f32_16x16x32_bf16 v[136:139], v[216:219], v[36:39], v[136:139]
    v_mfma_f32_16x16x32_bf16 v[144:147], v[216:219], v[40:43], v[144:147]
    v_mfma_f32_16x16x32_bf16 v[148:151], v[220:223], v[40:43], v[148:151]
    s_waitcnt lgkmcnt(3)
    v_mfma_f32_16x16x32_bf16 v[128:131], v[224:227], v[52:55], v[128:131]
    ds_read_b128 v[92:95], v2 offset:18432
    v_mfma_f32_16x16x32_bf16 v[132:135], v[228:231], v[52:55], v[132:135]
    ds_read_b128 v[96:99], v2 offset:19456
    v_mfma_f32_16x16x32_bf16 v[140:143], v[228:231], v[56:59], v[140:143]
    ds_read_b128 v[100:103], v2 offset:20480
    v_mfma_f32_16x16x32_bf16 v[136:139], v[224:227], v[56:59], v[136:139]
    v_mfma_f32_16x16x32_bf16 v[144:147], v[224:227], v[60:63], v[144:147]
    v_mfma_f32_16x16x32_bf16 v[148:151], v[228:231], v[60:63], v[148:151]
    s_waitcnt lgkmcnt(3)
    v_mfma_f32_16x16x32_bf16 v[128:131], v[232:235], v[72:75], v[128:131]
    v_add_u32 v2, 0x6000, v2
    v_mfma_f32_16x16x32_bf16 v[132:135], v[236:239], v[72:75], v[132:135]
    v_mfma_f32_16x16x32_bf16 v[140:143], v[236:239], v[76:79], v[140:143]
    v_mfma_f32_16x16x32_bf16 v[136:139], v[232:235], v[76:79], v[136:139]
    v_mfma_f32_16x16x32_bf16 v[144:147], v[232:235], v[80:83], v[144:147]
    v_mfma_f32_16x16x32_bf16 v[148:151], v[236:239], v[80:83], v[148:151]
    s_waitcnt lgkmcnt(0)
    s_barrier
    v_mfma_f32_16x16x32_bf16 v[128:131], v[240:243], v[92:95], v[128:131]
    ds_read_b128 v[32:35], v2 offset:0
    ds_read_b128 v[36:39], v2 offset:1024
    ds_read_b128 v[40:43], v2 offset:2048
    v_mfma_f32_16x16x32_bf16 v[132:135], v[244:247], v[92:95], v[132:135]
    ds_read_b64_tr_b16 v[44:45], v3 offset:0
    ds_read_b64_tr_b16 v[46:47], v3 offset:2048
    ds_read_b64_tr_b16 v[48:49], v4 offset:0
    v_mfma_f32_16x16x32_bf16 v[140:143], v[244:247], v[96:99], v[140:143]
    ds_read_b64_tr_b16 v[50:51], v4 offset:2048
    ds_read_b128 v[52:55], v2 offset:6144
    ds_read_b128 v[56:59], v2 offset:7168
    v_mfma_f32_16x16x32_bf16 v[136:139], v[240:243], v[96:99], v[136:139]
    ds_read_b128 v[60:63], v2 offset:8192
    ds_read_b64_tr_b16 v[64:65], v3 offset:4096
    ds_read_b64_tr_b16 v[66:67], v3 offset:6144
    v_mfma_f32_16x16x32_bf16 v[144:147], v[240:243], v[100:103], v[144:147]
    ds_read_b64_tr_b16 v[68:69], v4 offset:4096
    ds_read_b64_tr_b16 v[70:71], v4 offset:6144
    v_mfma_f32_16x16x32_bf16 v[148:151], v[244:247], v[100:103], v[148:151]
L_p2_F:
L_p2b_F:
    s_waitcnt lgkmcnt(7)
    v_mfma_f32_16x16x32_bf16 v[128:131], v[44:47], v[32:35], v[128:131]
    ds_read_b128 v[72:75], v2 offset:12288
    ds_read_b128 v[76:79], v2 offset:13312
    v_mfma_f32_16x16x32_bf16 v[132:135], v[48:51], v[32:35], v[132:135]
    ds_read_b128 v[80:83], v2 offset:14336
    ds_read_b64_tr_b16 v[84:85], v3 offset:8192
    v_mfma_f32_16x16x32_bf16 v[140:143], v[48:51], v[36:39], v[140:143]
    ds_read_b64_tr_b16 v[86:87], v3 offset:10240
    ds_read_b64_tr_b16 v[88:89], v4 offset:8192
    v_mfma_f32_16x16x32_bf16 v[136:139], v[44:47], v[36:39], v[136:139]
    ds_read_b64_tr_b16 v[90:91], v4 offset:10240
    v_mfma_f32_16x16x32_bf16 v[144:147], v[44:47], v[40:43], v[144:147]
    v_mfma_f32_16x16x32_bf16 v[148:151], v[48:51], v[40:43], v[148:151]
    s_waitcnt lgkmcnt(7)
    v_mfma_f32_16x16x32_bf16 v[128:131], v[64:67], v[52:55], v[128:131]
    ds_read_b128 v[92:95], v2 offset:18432
    ds_read_b128 v[96:99], v2 offset:19456
    v_mfma_f32_16x16x32_bf16 v[132:135], v[68:71], v[52:55], v[132:135]
    ds_read_b128 v[100:103], v2 offset:20480
    ds_read_b64_tr_b16 v[104:105], v3 offset:12288
    v_mfma_f32_16x16x32_bf16 v[140:143], v[68:71], v[56:59], v[140:143]
    ds_read_b64_tr_b16 v[106:107], v3 offset:14336
    ds_read_b64_tr_b16 v[108:109], v4 offset:12288
    v_mfma_f32_16x16x32_bf16 v[136:139], v[64:67], v[56:59], v[136:139]
    ds_read_b64_tr_b16 v[110:111], v4 offset:14336
    v_mfma_f32_16x16x32_bf16 v[144:147], v[64:67], v[60:63], v[144:147]
    v_mfma_f32_16x16x32_bf16 v[148:151], v[68:71], v[60:63], v[148:151]
    s_waitcnt lgkmcnt(7)
    v_mfma_f32_16x16x32_bf16 v[128:131], v[84:87], v[72:75], v[128:131]
    s_mov_b32 s78, 24576
    s_add_u32 s75, s75, 1
    s_cmp_eq_u32 s75, 3
    s_cselect_b32 s78, 4294918144, s78
    s_cselect_b32 s75, 0, s75
    v_mfma_f32_16x16x32_bf16 v[132:135], v[88:91], v[72:75], v[132:135]
    s_mov_b32 s79, 16384
    s_add_u32 s76, s76, 1
    s_cmp_eq_u32 s76, 5
    s_cselect_b32 s79, 4294901760, s79
    s_cselect_b32 s76, 0, s76
    v_mfma_f32_16x16x32_bf16 v[140:143], v[88:91], v[76:79], v[140:143]
    v_add_u32 v2, s78, v2
    v_add_u32 v3, s79, v3
    v_add_u32 v4, s79, v4
    s_add_u32 s77, s77, 1
    s_cmp_eq_u32 s77, 17
    v_mfma_f32_16x16x32_bf16 v[136:139], v[84:87], v[76:79], v[136:139]
    v_mfma_f32_16x16x32_bf16 v[144:147], v[84:87], v[80:83], v[144:147]
    v_mfma_f32_16x16x32_bf16 v[148:151], v[88:91], v[80:83], v[148:151]
    s_cbranch_scc1 L_p2l_F
    s_waitcnt lgkmcnt(0)
    s_barrier
    v_mfma_f32_16x16x32_bf16 v[128:131], v[104:107], v[92:95], v[128:131]
    ds_read_b128 v[32:35], v2 offset:0
    ds_read_b128 v[36:39], v2 offset:1024
    ds_read_b128 v[40:43], v2 offset:2048
    v_mfma_f32_16x16x32_bf16 v[132:135], v[108:111], v[92:95], v[132:135]
    ds_read_b64_tr_b16 v[44:45], v3 offset:0
    ds_read_b64_tr_b16 v[46:47], v3 offset:2048
    ds_read_b64_tr_b16 v[48:49], v4 offset:0
    v_mfma_f32_16x16x32_bf16 v[140:143], v[108:111], v[96:99], v[140:143]
    ds_read_b64_tr_b16 v[50:51], v4 offset:2048
    ds_read_b128 v[52:55], v2 offset:6144
    ds_read_b128 v[56:59], v2 offset:7168
    v_mfma_f32_16x16x32_bf16 v[136:139], v[104:107], v[96:99], v[136:139]
    ds_read_b128 v[60:63], v2 offset:8192
    ds_read_b64_tr_b16 v[64:65], v3 offset:4096
    ds_read_b64_tr_b16 v[66:67], v3 offset:6144
    v_mfma_f32_16x16x32_bf16 v[144:147], v[104:107], v[100:103], v[144:147]
    ds_read_b64_tr_b16 v[68:69], v4 offset:4096
    ds_read_b64_tr_b16 v[70:71], v4 offset:6144
    v_mfma_f32_16x16x32_bf16 v[148:151], v[108:111], v[100:103], v[148:151]
    s_branch L_p2_F
L_p2l_F:
    ds_read_b64 v[112:113], v5 offset:0
    ds_read_b64 v[114:115], v6 offset:0
    ds_read_b64 v[116:117], v5 offset:2048
    ds_read_b64 v[118:119], v6 offset:2048
    ds_read_b64 v[120:121], v5 offset:4096
    ds_read_b64 v[122:123], v6 offset:4096
    s_waitcnt lgkmcnt(6)
    v_mfma_f32_16x16x32_bf16 v[128:131], v[104:107], v[92:95], v[128:131]
    v_mfma_f32_16x16x32_bf16 v[132:135], v[108:111], v[92:95], v[132:135]
    v_mfma_f32_16x16x32_bf16 v[140:143], v[108:111], v[96:99], v[140:143]
    v_mfma_f32_16x16x32_bf16 v[136:139], v[104:107], v[96:99], v[136:139]
    v_mfma_f32_16x16x32_bf16 v[144:147], v[104:107], v[100:103], v[144:147]
    v_mfma_f32_16x16x32_bf16 v[148:151], v[108:111], v[100:103], v[148:151]
    s_waitcnt lgkmcnt(0)
    v_lshlrev_b32 v32, 16, v112
    v_and_b32 v33, 0xffff0000, v112
    v_lshlrev_b32 v34, 16, v113
    v_and_b32 v35, 0xffff0000, v113
    v_lshlrev_b32 v36, 16, v114
    v_and_b32 v37, 0xffff0000, v114
    v_lshlrev_b32 v38, 16, v115
    v_and_b32 v39, 0xffff0000, v115
    v_lshlrev_b32 v40, 16, v116
    v_and_b32 v41, 0xffff0000, v116
    v_lshlrev_b32 v42, 16, v117
    v_and_b32 v43, 0xffff0000, v117
    v_lshlrev_b32 v44, 16, v118
    v_and_b32 v45, 0xffff0000, v118
    v_lshlrev_b32 v46, 16, v119
    v_and_b32 v47, 0xffff0000, v119
    v_lshlrev_b32 v48, 16, v120
    v_and_b32 v49, 0xffff0000, v120
    v_lshlrev_b32 v50, 16, v121
    v_and_b32 v51, 0xffff0000, v121
    v_lshlrev_b32 v52, 16, v122
    v_and_b32 v53, 0xffff0000, v122
    v_lshlrev_b32 v54, 16, v123
    v_and_b32 v55, 0xffff0000, v123
    v_pk_add_f32 v[128:129], v[128:129], v[32:33]
    v_pk_add_f32 v[130:131], v[130:131], v[34:35]
    v_cvt_pk_bf16_f32 v112, v128, v129
    v_cvt_pk_bf16_f32 v113, v130, v131
    ds_write_b64 v5, v[112:113] offset:0
    v_pk_add_f32 v[132:133], v[132:133], v[36:37]
    v_pk_add_f32 v[134:135], v[134:135], v[38:39]
    v_cvt_pk_bf16_f32 v114, v132, v133
    v_cvt_pk_bf16_f32 v115, v134, v135
    ds_write_b64 v6, v[114:115] offset:0
    v_pk_add_f32 v[136:137], v[136:137], v[40:41]
    v_pk_add_f32 v[138:139], v[138:139], v[42:43]
    v_cvt_pk_bf16_f32 v116, v136, v137
    v_cvt_pk_bf16_f32 v117, v138, v139
    ds_write_b64 v5, v[116:117] offset:2048
    v_pk_add_f32 v[140:141], v[140:141], v[44:45]
    v_pk_add_f32 v[142:143], v[142:143], v[46:47]
    v_cvt_pk_bf16_f32 v118, v140, v141
    v_cvt_pk_bf16_f32 v119, v142, v143
    ds_write_b64 v6, v[118:119] offset:2048
    v_pk_add_f32 v[144:145], v[144:145], v[48:49]
    v_pk_add_f32 v[146:147], v[146:147], v[50:51]
    v_cvt_pk_bf16_f32 v120, v144, v145
    v_cvt_pk_bf16_f32 v121, v146, v147
    ds_write_b64 v5, v[120:121] offset:4096
    v_pk_add_f32 v[148:149], v[148:149], v[52:53]
    v_pk_add_f32 v[150:151], v[150:151], v[54:55]
    v_cvt_pk_bf16_f32 v122, v148, v149
    v_cvt_pk_bf16_f32 v123, v150, v151
    ds_write_b64 v6, v[122:123] offset:4096
    s_waitcnt lgkmcnt(0)
L_final_F:
    s_barrier
    s_lshl_b32 s64, s54, 10
    s_add_u32 s64, s64, 106496
    v_lshl_add_u32 v1, v0, 4, s64
    ds_read_b128 v[8:11], v1
    ds_read_b128 v[12:15], v1 offset:8192
    s_mul_i32 s66, s61, 20480
    s_lshl_b32 s65, s60, 7
    s_add_u32 s66, s66, s65
    s_mul_i32 s65, s54, 10240
    s_add_u32 s66, s66, s65
    s_waitcnt lgkmcnt(0)
    buffer_store_dwordx4 v[8:11], v7, s[28:31], s66 offen sc1
    s_cmp_ge_u32 s54, 4
    s_cbranch_scc1 L_done_6
    s_add_u32 s66, s66, 81920
    buffer_store_dwordx4 v[12:15], v7, s[28:31], s66 offen sc1
L_done_6:
    s_endpgm
L_compute_Q:
    s_lshr_b32 s73, s63, 1
    s_and_b32 s74, s63, 1
    v_lshrrev_b32 v30, 4, v0
    v_and_b32 v31, 15, v0
    s_waitcnt lgkmcnt(0)
    s_mov_b32 s24, s52
    s_mov_b32 s25, s53
    s_mov_b32 s26, 0xb00000
    s_mov_b32 s27, 0x20000
    s_mov_b32 s28, s48
    s_mov_b32 s29, s49
    s_mov_b32 s30, 0x280000
    s_mov_b32 s31, 0x20000
    s_lshr_b32 s64, s70, 1
    s_and_b32 s65, s70, 1
    s_add_u32 s65, s65, 6
    s_sub_u32 s66, s70, 3
    s_sub_u32 s67, s70, 8
    s_cmp_ge_u32 s70, 11
    s_cselect_b32 s66, s67, s66
    s_cselect_b32 s67, 4, 3
    s_cmp_ge_u32 s70, 6
    s_cselect_b32 s64, s67, s64
    s_cselect_b32 s65, s66, s65
    s_lshl_b32 s65, s65, 2
    s_mul_i32 s60, s59, 5
    s_add_u32 s60, s60, s64
    s_lshl_b32 s61, s58, 5
    s_add_u32 s61, s61, s65
    s_lshl_b32 s66, s64, 2
    s_lshr_b32 s67, 0xA2840, s66
    s_and_b32 s67, s67, 15
    s_add_u32 s71, s67, s59
    s_and_b32 s72, s60, 3
    v_mov_b32 v128, 0
    v_mov_b32 v129, 0
    v_mov_b32 v130, 0
    v_mov_b32 v131, 0
    v_mov_b32 v132, 0
    v_mov_b32 v133, 0
    v_mov_b32 v134, 0
    v_mov_b32 v135, 0
    v_mov_b32 v136, 0
    v_mov_b32 v137, 0
    v_mov_b32 v138, 0
    v_mov_b32 v139, 0
    v_mov_b32 v140, 0
    v_mov_b32 v141, 0
    v_mov_b32 v142, 0
    v_mov_b32 v143, 0
    v_mov_b32 v144, 0
    v_mov_b32 v145, 0
    v_mov_b32 v146, 0
    v_mov_b32 v147, 0
    v_mov_b32 v148, 0
    v_mov_b32 v149, 0
    v_mov_b32 v150, 0
    v_mov_b32 v151, 0
    v_mov_b32 v152, 0
    v_mov_b32 v153, 0
    v_mov_b32 v154, 0
    v_mov_b32 v155, 0
    v_mov_b32 v156, 0
    v_mov_b32 v157, 0
    v_mov_b32 v158, 0
    v_mov_b32 v159, 0
    v_mov_b32 v160, 0
    v_mov_b32 v161, 0
    v_mov_b32 v162, 0
    v_mov_b32 v163, 0
    v_mov_b32 v164, 0
    v_mov_b32 v165, 0
    v_mov_b32 v166, 0
    v_mov_b32 v167, 0
    v_mov_b32 v168, 0
    v_mov_b32 v169, 0
    v_mov_b32 v170, 0
    v_mov_b32 v171, 0
    v_mov_b32 v172, 0
    v_mov_b32 v173, 0
    v_mov_b32 v174, 0
    v_mov_b32 v175, 0
    v_mov_b32 v176, 0
    v_mov_b32 v177, 0
    v_mov_b32 v178, 0
    v_mov_b32 v179, 0
    v_mov_b32 v180, 0
    v_mov_b32 v181, 0
    v_mov_b32 v182, 0
    v_mov_b32 v183, 0
    v_mov_b32 v184, 0
    v_mov_b32 v185, 0
    v_mov_b32 v186, 0
    v_mov_b32 v187, 0
    v_mov_b32 v188, 0
    v_mov_b32 v189, 0
    v_mov_b32 v190, 0
    v_mov_b32 v191, 0
    v_mov_b32 v192, 0
    v_mov_b32 v193, 0
    v_mov_b32 v194, 0
    v_mov_b32 v195, 0
    v_mov_b32 v196, 0
    v_mov_b32 v197, 0
    v_mov_b32 v198, 0
    v_mov_b32 v199, 0
    v_mov_b32 v200, 0
    v_mov_b32 v201, 0
    v_mov_b32 v202, 0
    v_mov_b32 v203, 0
    v_mov_b32 v204, 0
    v_mov_b32 v205, 0
    v_mov_b32 v206, 0
    v_mov_b32 v207, 0
    v_mov_b32 v208, 0
    v_mov_b32 v209, 0
    v_mov_b32 v210, 0
    v_mov_b32 v211, 0
    v_mov_b32 v212, 0
    v_mov_b32 v213, 0
    v_mov_b32 v214, 0
    v_mov_b32 v215, 0
    v_mov_b32 v216, 0
    v_mov_b32 v217, 0
    v_mov_b32 v218, 0
    v_mov_b32 v219, 0
    v_mov_b32 v220, 0
    v_mov_b32 v221, 0
    v_mov_b32 v222, 0
    v_mov_b32 v223, 0
    v_mov_b32 v224, 0
    v_mov_b32 v225, 0
    v_mov_b32 v226, 0
    v_mov_b32 v227, 0
    v_mov_b32 v228, 0
    v_mov_b32 v229, 0
    v_mov_b32 v230, 0
    v_mov_b32 v231, 0
    v_mov_b32 v232, 0
    v_mov_b32 v233, 0
    v_mov_b32 v234, 0
    v_mov_b32 v235, 0
    v_mov_b32 v236, 0
    v_mov_b32 v237, 0
    v_mov_b32 v238, 0
    v_mov_b32 v239, 0
    v_mov_b32 v240, 0
    v_mov_b32 v241, 0
    v_mov_b32 v242, 0
    v_mov_b32 v243, 0
    v_mov_b32 v244, 0
    v_mov_b32 v245, 0
    v_mov_b32 v246, 0
    v_mov_b32 v247, 0
    v_mov_b32 v248, 0
    v_mov_b32 v249, 0
    v_mov_b32 v250, 0
    v_mov_b32 v251, 0
    v_mov_b32 v252, 0
    v_mov_b32 v253, 0
    v_mov_b32 v254, 0
    v_mov_b32 v255, 0
    v_lshrrev_b32 v1, 1, v31
    v_xor_b32 v1, v1, v30
    v_lshlrev_b32 v1, 4, v1
    v_lshl_add_u32 v1, v31, 7, v1
    s_lshl_b32 s64, s73, 13
    v_add_u32 v2, s64, v1
    v_xor_b32 v3, 64, v2
    v_lshrrev_b32 v10, 2, v31
    v_and_b32 v11, 3, v31
    v_and_b32 v1, 1, v30
    v_lshlrev_b32_e64 v1, 7, v1
    v_lshl_add_u32 v1, v30, 12, v1
    v_mul_u32_u24 v14, 480, v10
    s_mul_i32 s64, s74, 80
    s_add_u32 s64, s64, 16384
    v_add3_u32 v1, v1, v14, s64
    v_lshl_add_u32 v4, v11, 3, v1
    v_and_b32 v14, 1, v11
    v_mul_u32_u24 v14, 40, v14
    v_add3_u32 v5, v1, v14, 32
    v_lshrrev_b32 v14, 1, v11
    v_mul_u32_u24 v14, 160, v14
    v_add_u32 v5, v5, v14
    v_add_u32 v5, 160, v5
    s_mul_i32 s64, s74, 80
    v_subrev_u32 v1, s64, v1
    v_mul_u32_u24 v14, 40, v11
    v_add3_u32 v6, v1, v14, 32
    s_lshl_b32 s64, s74, 12
    v_add_u32 v2, s64, v2
    v_add_u32_e64 v3, s64, v3
    v_xor_b32 v7, 0x1000, v2
    v_xor_b32 v8, 0x1000, v3
    s_mov_b32 s75, 0
    s_mov_b32 s77, 10
    s_waitcnt vmcnt(0)
    s_setprio 3
    s_barrier
    ds_read_b128 v[96:99], v2 offset:0
    ds_read_b128 v[100:103], v2 offset:2048
    ds_read_b128 v[104:107], v7 offset:0
    ds_read_b128 v[108:111], v7 offset:2048
    ds_read_b64_tr_b16 v[32:33], v4 offset:0
    ds_read_b64_tr_b16 v[34:35], v4 offset:1920
    ds_read_b64_tr_b16 v[36:37], v4 offset:40
    ds_read_b64_tr_b16 v[38:39], v4 offset:1960
    ds_read_b64_tr_b16 v[40:41], v6 offset:0
    ds_read_b64_tr_b16 v[42:43], v6 offset:1920
    ds_read_b64_tr_b16 v[44:45], v4 offset:160
    ds_read_b64_tr_b16 v[46:47], v4 offset:2080
    ds_read_b64_tr_b16 v[48:49], v4 offset:200
    ds_read_b64_tr_b16 v[50:51], v4 offset:2120
    ds_read_b64_tr_b16 v[52:53], v5 offset:0
    ds_read_b64_tr_b16 v[54:55], v5 offset:1920
    ds_read_b64_tr_b16 v[56:57], v4 offset:320
    ds_read_b64_tr_b16 v[58:59], v4 offset:2240
    ds_read_b64_tr_b16 v[60:61], v4 offset:360
    ds_read_b64_tr_b16 v[62:63], v4 offset:2280
L_k_Q:
    s_waitcnt lgkmcnt(0)
    v_mfma_f32_16x16x32_bf16 v[128:131], v[32:35], v[96:99], v[128:131]
    ds_read_b128 v[112:115], v3 offset:0
    v_mfma_f32_16x16x32_bf16 v[132:135], v[32:35], v[100:103], v[132:135]
    ds_read_b128 v[116:119], v3 offset:2048
    v_mfma_f32_16x16x32_bf16 v[136:139], v[32:35], v[104:107], v[136:139]
    ds_read_b128 v[120:123], v8 offset:0
    v_mfma_f32_16x16x32_bf16 v[140:143], v[32:35], v[108:111], v[140:143]
    ds_read_b128 v[124:127], v8 offset:2048
    v_mfma_f32_16x16x32_bf16 v[156:159], v[36:39], v[108:111], v[156:159]
    ds_read_b64_tr_b16 v[64:65], v4 offset:16384
    v_mfma_f32_16x16x32_bf16 v[152:155], v[36:39], v[104:107], v[152:155]
    ds_read_b64_tr_b16 v[66:67], v4 offset:18304
    v_mfma_f32_16x16x32_bf16 v[148:151], v[36:39], v[100:103], v[148:151]
    ds_read_b64_tr_b16 v[68:69], v4 offset:16424
    v_mfma_f32_16x16x32_bf16 v[144:147], v[36:39], v[96:99], v[144:147]
    ds_read_b64_tr_b16 v[70:71], v4 offset:18344
    v_mfma_f32_16x16x32_bf16 v[176:179], v[96:99], v[44:47], v[176:179]
    ds_read_b64_tr_b16 v[72:73], v6 offset:16384
    v_mfma_f32_16x16x32_bf16 v[180:183], v[100:103], v[44:47], v[180:183]
    ds_read_b64_tr_b16 v[74:75], v6 offset:18304
    v_mfma_f32_16x16x32_bf16 v[184:187], v[104:107], v[44:47], v[184:187]
    ds_read_b64_tr_b16 v[76:77], v4 offset:16544
    v_mfma_f32_16x16x32_bf16 v[188:191], v[108:111], v[44:47], v[188:191]
    ds_read_b64_tr_b16 v[78:79], v4 offset:18464
    v_mfma_f32_16x16x32_bf16 v[204:207], v[108:111], v[48:51], v[204:207]
    ds_read_b64_tr_b16 v[80:81], v4 offset:16584
    v_mfma_f32_16x16x32_bf16 v[200:203], v[104:107], v[48:51], v[200:203]
    ds_read_b64_tr_b16 v[82:83], v4 offset:18504
    v_mfma_f32_16x16x32_bf16 v[196:199], v[100:103], v[48:51], v[196:199]
    ds_read_b64_tr_b16 v[84:85], v5 offset:16384
    v_mfma_f32_16x16x32_bf16 v[192:195], v[96:99], v[48:51], v[192:195]
    ds_read_b64_tr_b16 v[86:87], v5 offset:18304
    v_mfma_f32_16x16x32_bf16 v[208:211], v[96:99], v[52:55], v[208:211]
    ds_read_b64_tr_b16 v[88:89], v4 offset:16704
    v_mfma_f32_16x16x32_bf16 v[212:215], v[100:103], v[52:55], v[212:215]
    ds_read_b64_tr_b16 v[90:91], v4 offset:18624
    v_mfma_f32_16x16x32_bf16 v[216:219], v[104:107], v[52:55], v[216:219]
    ds_read_b64_tr_b16 v[92:93], v4 offset:16744
    v_mfma_f32_16x16x32_bf16 v[220:223], v[108:111], v[52:55], v[220:223]
    ds_read_b64_tr_b16 v[94:95], v4 offset:18664
    v_mfma_f32_16x16x32_bf16 v[236:239], v[108:111], v[56:59], v[236:239]
    s_mov_b32 s76, 49152
    s_add_u32 s75, s75, 1
    v_mfma_f32_16x16x32_bf16 v[232:235], v[104:107], v[56:59], v[232:235]
    s_cmp_eq_u32 s75, 3
    s_cselect_b32 s76, 4294868992, s76
    v_mfma_f32_16x16x32_bf16 v[228:231], v[100:103], v[56:59], v[228:231]
    s_cselect_b32 s75, 0, s75
    s_sub_u32 s77, s77, 1
    v_mfma_f32_16x16x32_bf16 v[224:227], v[96:99], v[56:59], v[224:227]
    s_cmp_eq_u32 s77, 0
    v_mfma_f32_16x16x32_bf16 v[160:163], v[40:43], v[96:99], v[160:163]
    v_mfma_f32_16x16x32_bf16 v[164:167], v[40:43], v[100:103], v[164:167]
    v_mfma_f32_16x16x32_bf16 v[244:247], v[100:103], v[60:63], v[244:247]
    v_mfma_f32_16x16x32_bf16 v[240:243], v[96:99], v[60:63], v[240:243]
    v_mfma_f32_16x16x32_bf16 v[248:251], v[104:107], v[60:63], v[248:251]
    v_mfma_f32_16x16x32_bf16 v[252:255], v[108:111], v[60:63], v[252:255]
    s_waitcnt lgkmcnt(0)
    s_barrier
    s_cbranch_scc1 L_klast_Q
    v_mfma_f32_16x16x32_bf16 v[128:131], v[64:67], v[112:115], v[128:131]
    v_add_u32 v2, s76, v2
    v_add_u32 v3, s76, v3
    v_add_u32 v7, s76, v7
    v_add_u32 v8, s76, v8
    v_mfma_f32_16x16x32_bf16 v[132:135], v[64:67], v[116:119], v[132:135]
    v_add_u32 v4, s76, v4
    v_add_u32 v5, s76, v5
    v_add_u32 v6, s76, v6
    v_mfma_f32_16x16x32_bf16 v[136:139], v[64:67], v[120:123], v[136:139]
    ds_read_b128 v[96:99], v2 offset:0
    v_mfma_f32_16x16x32_bf16 v[140:143], v[64:67], v[124:127], v[140:143]
    ds_read_b128 v[100:103], v2 offset:2048
    v_mfma_f32_16x16x32_bf16 v[156:159], v[68:71], v[124:127], v[156:159]
    ds_read_b128 v[104:107], v7 offset:0
    v_mfma_f32_16x16x32_bf16 v[152:155], v[68:71], v[120:123], v[152:155]
    ds_read_b128 v[108:111], v7 offset:2048
    v_mfma_f32_16x16x32_bf16 v[148:151], v[68:71], v[116:119], v[148:151]
    ds_read_b64_tr_b16 v[32:33], v4 offset:0
    v_mfma_f32_16x16x32_bf16 v[144:147], v[68:71], v[112:115], v[144:147]
    ds_read_b64_tr_b16 v[34:35], v4 offset:1920
    v_mfma_f32_16x16x32_bf16 v[176:179], v[112:115], v[76:79], v[176:179]
    ds_read_b64_tr_b16 v[36:37], v4 offset:40
    v_mfma_f32_16x16x32_bf16 v[180:183], v[116:119], v[76:79], v[180:183]
    ds_read_b64_tr_b16 v[38:39], v4 offset:1960
    v_mfma_f32_16x16x32_bf16 v[184:187], v[120:123], v[76:79], v[184:187]
    ds_read_b64_tr_b16 v[40:41], v6 offset:0
    v_mfma_f32_16x16x32_bf16 v[188:191], v[124:127], v[76:79], v[188:191]
    ds_read_b64_tr_b16 v[42:43], v6 offset:1920
    v_mfma_f32_16x16x32_bf16 v[204:207], v[124:127], v[80:83], v[204:207]
    ds_read_b64_tr_b16 v[44:45], v4 offset:160
    v_mfma_f32_16x16x32_bf16 v[200:203], v[120:123], v[80:83], v[200:203]
    ds_read_b64_tr_b16 v[46:47], v4 offset:2080
    v_mfma_f32_16x16x32_bf16 v[196:199], v[116:119], v[80:83], v[196:199]
    ds_read_b64_tr_b16 v[48:49], v4 offset:200
    v_mfma_f32_16x16x32_bf16 v[192:195], v[112:115], v[80:83], v[192:195]
    ds_read_b64_tr_b16 v[50:51], v4 offset:2120
    v_mfma_f32_16x16x32_bf16 v[208:211], v[112:115], v[84:87], v[208:211]
    ds_read_b64_tr_b16 v[52:53], v5 offset:0
    v_mfma_f32_16x16x32_bf16 v[212:215], v[116:119], v[84:87], v[212:215]
    ds_read_b64_tr_b16 v[54:55], v5 offset:1920
    v_mfma_f32_16x16x32_bf16 v[216:219], v[120:123], v[84:87], v[216:219]
    ds_read_b64_tr_b16 v[56:57], v4 offset:320
    v_mfma_f32_16x16x32_bf16 v[220:223], v[124:127], v[84:87], v[220:223]
    ds_read_b64_tr_b16 v[58:59], v4 offset:2240
    v_mfma_f32_16x16x32_bf16 v[236:239], v[124:127], v[88:91], v[236:239]
    ds_read_b64_tr_b16 v[60:61], v4 offset:360
    v_mfma_f32_16x16x32_bf16 v[232:235], v[120:123], v[88:91], v[232:235]
    ds_read_b64_tr_b16 v[62:63], v4 offset:2280
    v_mfma_f32_16x16x32_bf16 v[228:231], v[116:119], v[88:91], v[228:231]
    v_mfma_f32_16x16x32_bf16 v[224:227], v[112:115], v[88:91], v[224:227]
    v_mfma_f32_16x16x32_bf16 v[160:163], v[72:75], v[112:115], v[160:163]
    v_mfma_f32_16x16x32_bf16 v[164:167], v[72:75], v[116:119], v[164:167]
    v_mfma_f32_16x16x32_bf16 v[244:247], v[116:119], v[92:95], v[244:247]
    v_mfma_f32_16x16x32_bf16 v[240:243], v[112:115], v[92:95], v[240:243]
    v_mfma_f32_16x16x32_bf16 v[248:251], v[120:123], v[92:95], v[248:251]
    v_mfma_f32_16x16x32_bf16 v[252:255], v[124:127], v[92:95], v[252:255]
    s_branch L_k_Q
L_klast_Q:
    v_mfma_f32_16x16x32_bf16 v[128:131], v[64:67], v[112:115], v[128:131]
    s_mov_b32 s78, 0x3fb8aa3b
    s_mov_b32 s79, 0x3fb8aa3b
    s_mov_b32 s80, 0x358637bd
    v_mfma_f32_16x16x32_bf16 v[132:135], v[64:67], v[116:119], v[132:135]
    s_mov_b32 s81, 0x358637bd
    s_lshl_b32 s64, s73, 1
    s_add_u32 s64, s64, s74
    v_mfma_f32_16x16x32_bf16 v[136:139], v[64:67], v[120:123], v[136:139]
    s_lshl_b32 s64, s64, 9
    s_add_u32 s64, s64, 155648
    v_lshl_add_u32 v1, v30, 6, s64
    v_mfma_f32_16x16x32_bf16 v[140:143], v[64:67], v[124:127], v[140:143]
    v_xor_b32 v7, 0x200, v1
    ds_read_b128 v[32:35], v1 offset:0
    ds_read_b128 v[36:39], v1 offset:16
    v_mfma_f32_16x16x32_bf16 v[156:159], v[68:71], v[124:127], v[156:159]
    ds_read_b128 v[40:43], v1 offset:256
    ds_read_b128 v[44:47], v1 offset:272
    ds_read_b128 v[48:51], v7 offset:0
    v_mfma_f32_16x16x32_bf16 v[152:155], v[68:71], v[120:123], v[152:155]
    ds_read_b128 v[52:55], v7 offset:16
    ds_read_b128 v[56:59], v7 offset:256
    ds_read_b128 v[60:63], v7 offset:272
    v_mfma_f32_16x16x32_bf16 v[148:151], v[68:71], v[116:119], v[148:151]
    s_mul_i32 s64, s74, 160
    s_add_u32 s64, s64, 157696
    v_lshl_add_u32 v2, v31, 2, s64
    v_mfma_f32_16x16x32_bf16 v[144:147], v[68:71], v[112:115], v[144:147]
    ds_read2_b32 v[8:9], v2 offset0:80 offset1:100
    ds_read2_b32 v[10:11], v2 offset0:160 offset1:180
    v_lshrrev_b32 v3, 3, v31
    v_mfma_f32_16x16x32_bf16 v[176:179], v[112:115], v[76:79], v[176:179]
    v_mul_u32_u24 v3, 320, v3
    v_bfe_u32 v4, v31, 2, 1
    v_mul_u32_u24 v4, 80, v4
    v_mfma_f32_16x16x32_bf16 v[180:183], v[116:119], v[76:79], v[180:183]
    v_add_u32 v3, v3, v4
    v_and_b32 v4, 3, v31
    v_lshl_add_u32 v3, v4, 2, v3
    v_mfma_f32_16x16x32_bf16 v[184:187], v[120:123], v[76:79], v[184:187]
    v_add_u32 v3, s64, v3
    ds_read_b32 v12, v3 offset:384
    v_cmp_gt_u32 s[82:83], 8, v31
    v_mfma_f32_16x16x32_bf16 v[188:191], v[124:127], v[76:79], v[188:191]
    v_mov_b32 v4, 0
    v_mov_b32 v5, s80
    v_cndmask_b32 v13, v4, v5, s[82:83]
    v_mfma_f32_16x16x32_bf16 v[204:207], v[124:127], v[80:83], v[204:207]
    v_mov_b32 v6, 0x3f803f80
    s_mul_i32 s64, s73, 6720
    s_mul_i32 s65, s74, 3360
    v_mfma_f32_16x16x32_bf16 v[200:203], v[120:123], v[80:83], v[200:203]
    s_add_u32 s64, s64, s65
    s_add_u32 s64, s64, 32768
    v_mul_u32_u24 v14, 80, v31
    v_mfma_f32_16x16x32_bf16 v[196:199], v[116:119], v[80:83], v[196:199]
    v_add_u32 v14, s64, v14
    v_lshl_add_u32 v15, v30, 4, v14
    v_and_b32 v16, 3, v31
    v_mfma_f32_16x16x32_bf16 v[192:195], v[112:115], v[80:83], v[192:195]
    v_mul_u32_u24 v16, 80, v16
    v_add_u32 v16, 1280, v16
    v_mov_b32 v17, 1600
    v_mfma_f32_16x16x32_bf16 v[208:211], v[112:115], v[84:87], v[208:211]
    v_cmp_eq_u32 vcc, 0, v31
    s_nop 1
    v_cndmask_b32 v16, v16, v17, vcc
    v_add_u32 v16, s64, v16
    v_mfma_f32_16x16x32_bf16 v[212:215], v[116:119], v[84:87], v[212:215]
    v_lshl_add_u32 v17, v30, 4, v16
    v_mul_u32_u24 v18, 1680, v30
    v_add_u32 v14, v14, v18
    v_mfma_f32_16x16x32_bf16 v[216:219], v[120:123], v[84:87], v[216:219]
    v_add_u32 v16, v16, v18
    s_lshl_b32 s64, s74, 2
    s_add_u32 s64, s64, 158736
    v_mfma_f32_16x16x32_bf16 v[220:223], v[124:127], v[84:87], v[220:223]
    v_mov_b32 v18, s64
    s_lshl_b32 s64, s73, 6
    v_add_u32 v22, s64, v0
    v_mfma_f32_16x16x32_bf16 v[236:239], v[124:127], v[88:91], v[236:239]
    s_mul_i32 s65, s74, 3360
    s_add_u32 s65, s65, 32768
    v_lshl_add_u32 v20, v22, 5, s65
    v_mfma_f32_16x16x32_bf16 v[232:235], v[120:123], v[88:91], v[232:235]
    s_mul_i32 s64, s56, 55296
    s_mul_i32 s65, s55, 3456
    s_add_u32 s64, s64, s65
    v_mfma_f32_16x16x32_bf16 v[228:231], v[116:119], v[88:91], v[228:231]
    s_mul_i32 s65, s74, 1680
    s_add_u32 s64, s64, s65
    s_add_u32 s64, s64, 0x8a8000
    v_mfma_f32_16x16x32_bf16 v[224:227], v[112:115], v[88:91], v[224:227]
    v_lshl_add_u32 v21, v22, 4, s64
    v_mov_b32 v23, 0x40000000
    v_cmp_gt_u32 vcc, 105, v22
    v_mfma_f32_16x16x32_bf16 v[160:163], v[72:75], v[112:115], v[160:163]
    s_nop 0
    v_cndmask_b32 v21, v23, v21, vcc
    v_mov_b32 v24, 1
    v_mfma_f32_16x16x32_bf16 v[164:167], v[72:75], v[116:119], v[164:167]
    v_mfma_f32_16x16x32_bf16 v[244:247], v[116:119], v[92:95], v[244:247]
    v_mfma_f32_16x16x32_bf16 v[240:243], v[112:115], v[92:95], v[240:243]
    v_mfma_f32_16x16x32_bf16 v[248:251], v[120:123], v[92:95], v[248:251]
    v_mfma_f32_16x16x32_bf16 v[252:255], v[124:127], v[92:95], v[252:255]
    s_waitcnt lgkmcnt(0)
    s_nop 0
    v_pk_mul_f32 v[32:33], v[32:33], v[36:37] neg_lo:[1,0] neg_hi:[1,0]
    v_pk_mul_f32 v[34:35], v[34:35], v[38:39] neg_lo:[1,0] neg_hi:[1,0]
    v_pk_mul_f32 v[40:41], v[40:41], v[44:45] neg_lo:[1,0] neg_hi:[1,0]
    v_pk_mul_f32 v[42:43], v[42:43], v[46:47] neg_lo:[1,0] neg_hi:[1,0]
    v_pk_mul_f32 v[48:49], v[48:49], v[52:53] neg_lo:[1,0] neg_hi:[1,0]
    v_pk_mul_f32 v[50:51], v[50:51], v[54:55] neg_lo:[1,0] neg_hi:[1,0]
    v_pk_mul_f32 v[56:57], v[56:57], v[60:61] neg_lo:[1,0] neg_hi:[1,0]
    v_pk_mul_f32 v[58:59], v[58:59], v[62:63] neg_lo:[1,0] neg_hi:[1,0]
    v_pk_mul_f32 v[86:87], v[32:33], v[10:11] op_sel:[0,0] op_sel_hi:[1,0]
    v_pk_mul_f32 v[88:89], v[34:35], v[10:11] op_sel:[0,0] op_sel_hi:[1,0]
    v_pk_fma_f32 v[224:225], v[224:225], v[36:37], v[86:87]
    v_pk_fma_f32 v[226:227], v[226:227], v[38:39], v[88:89]
    v_cvt_pk_bf16_f32 v224, v224, v225
    v_cvt_pk_bf16_f32 v225, v226, v227
    v_pk_mul_f32 v[86:87], v[32:33], v[10:11] op_sel:[0,1] op_sel_hi:[1,1]
    v_pk_mul_f32 v[88:89], v[34:35], v[10:11] op_sel:[0,1] op_sel_hi:[1,1]
    v_pk_fma_f32 v[240:241], v[240:241], v[36:37], v[86:87]
    v_pk_fma_f32 v[242:243], v[242:243], v[38:39], v[88:89]
    v_cvt_pk_bf16_f32 v240, v240, v241
    v_cvt_pk_bf16_f32 v241, v242, v243
    v_pk_fma_f32 v[86:87], v[32:33], v[8:9], s[80:81] op_sel:[0,0,0] op_sel_hi:[1,0,1]
    v_pk_fma_f32 v[88:89], v[34:35], v[8:9], s[80:81] op_sel:[0,0,0] op_sel_hi:[1,0,1]
    v_pk_fma_f32 v[176:177], v[176:177], v[36:37], v[86:87]
    v_pk_fma_f32 v[178:179], v[178:179], v[38:39], v[88:89]
    v_pk_fma_f32 v[86:87], v[32:33], v[8:9], s[80:81] op_sel:[0,1,0] op_sel_hi:[1,1,1]
    v_pk_fma_f32 v[88:89], v[34:35], v[8:9], s[80:81] op_sel:[0,1,0] op_sel_hi:[1,1,1]
    v_pk_fma_f32 v[192:193], v[192:193], v[36:37], v[86:87]
    v_pk_fma_f32 v[194:195], v[194:195], v[38:39], v[88:89]
    v_pk_mul_f32 v[70:71], v[176:177], s[78:79]
    v_pk_mul_f32 v[72:73], v[178:179], s[78:79]
    v_pk_mul_f32 v[74:75], v[192:193], s[78:79]
    v_pk_mul_f32 v[76:77], v[194:195], s[78:79]
    v_exp_f32_e64 v70, v70 clamp
    v_exp_f32_e64 v71, v71 clamp
    v_exp_f32_e64 v72, v72 clamp
    v_exp_f32_e64 v73, v73 clamp
    v_exp_f32_e64 v74, v74 clamp
    v_exp_f32_e64 v75, v75 clamp
    v_exp_f32_e64 v76, v76 clamp
    v_exp_f32_e64 v77, v77 clamp
    v_max_f32 v78, s80, v176
    v_max_f32 v79, s80, v177
    v_max_f32 v80, s80, v178
    v_max_f32 v81, s80, v179
    v_max_f32 v82, s80, v192
    v_max_f32 v83, s80, v193
    v_max_f32 v84, s80, v194
    v_max_f32 v85, s80, v195
    v_pk_add_f32 v[70:71], v[70:71], v[78:79]
    v_pk_add_f32 v[72:73], v[72:73], v[80:81]
    v_pk_add_f32 v[74:75], v[74:75], v[82:83]
    v_pk_add_f32 v[76:77], v[76:77], v[84:85]
    v_cvt_pk_bf16_f32 v176, v70, v71
    v_cvt_pk_bf16_f32 v177, v72, v73
    v_cvt_pk_bf16_f32 v192, v74, v75
    v_cvt_pk_bf16_f32 v193, v76, v77
    v_pk_fma_f32 v[86:87], v[32:33], v[12:13], v[12:13] op_sel:[0,0,1] op_sel_hi:[1,0,1]
    v_pk_fma_f32 v[88:89], v[34:35], v[12:13], v[12:13] op_sel:[0,0,1] op_sel_hi:[1,0,1]
    v_pk_fma_f32 v[208:209], v[208:209], v[36:37], v[86:87]
    v_pk_fma_f32 v[210:211], v[210:211], v[38:39], v[88:89]
    v_cvt_pk_bf16_f32 v88, v208, v209
    v_cvt_pk_bf16_f32 v89, v210, v211
    v_cndmask_b32 v92, v88, v6, s[82:83]
    v_cndmask_b32 v93, v89, v6, s[82:83]
    v_pk_mul_f32 v[70:71], v[208:209], s[78:79]
    v_pk_mul_f32 v[72:73], v[210:211], s[78:79]
    v_exp_f32_e64 v70, v70 clamp
    v_exp_f32_e64 v71, v71 clamp
    v_exp_f32_e64 v72, v72 clamp
    v_exp_f32_e64 v73, v73 clamp
    v_max_f32 v78, s80, v208
    v_max_f32 v79, s80, v209
    v_max_f32 v80, s80, v210
    v_max_f32 v81, s80, v211
    v_pk_add_f32 v[70:71], v[70:71], v[78:79]
    v_pk_add_f32 v[72:73], v[72:73], v[80:81]
    v_cvt_pk_bf16_f32 v208, v70, v71
    v_cvt_pk_bf16_f32 v209, v72, v73
    v_pk_mul_f32 v[86:87], v[40:41], v[10:11] op_sel:[0,0] op_sel_hi:[1,0]
    v_pk_mul_f32 v[88:89], v[42:43], v[10:11] op_sel:[0,0] op_sel_hi:[1,0]
    v_pk_fma_f32 v[228:229], v[228:229], v[44:45], v[86:87]
    v_pk_fma_f32 v[230:231], v[230:231], v[46:47], v[88:89]
    v_cvt_pk_bf16_f32 v226, v228, v229
    v_cvt_pk_bf16_f32 v227, v230, v231
    v_pk_mul_f32 v[86:87], v[40:41], v[10:11] op_sel:[0,1] op_sel_hi:[1,1]
    v_pk_mul_f32 v[88:89], v[42:43], v[10:11] op_sel:[0,1] op_sel_hi:[1,1]
    v_pk_fma_f32 v[244:245], v[244:245], v[44:45], v[86:87]
    v_pk_fma_f32 v[246:247], v[246:247], v[46:47], v[88:89]
    v_cvt_pk_bf16_f32 v242, v244, v245
    v_cvt_pk_bf16_f32 v243, v246, v247
    v_pk_fma_f32 v[86:87], v[40:41], v[8:9], s[80:81] op_sel:[0,0,0] op_sel_hi:[1,0,1]
    v_pk_fma_f32 v[88:89], v[42:43], v[8:9], s[80:81] op_sel:[0,0,0] op_sel_hi:[1,0,1]
    v_pk_fma_f32 v[180:181], v[180:181], v[44:45], v[86:87]
    v_pk_fma_f32 v[182:183], v[182:183], v[46:47], v[88:89]
    v_pk_fma_f32 v[86:87], v[40:41], v[8:9], s[80:81] op_sel:[0,1,0] op_sel_hi:[1,1,1]
    v_pk_fma_f32 v[88:89], v[42:43], v[8:9], s[80:81] op_sel:[0,1,0] op_sel_hi:[1,1,1]
    v_pk_fma_f32 v[196:197], v[196:197], v[44:45], v[86:87]
    v_pk_fma_f32 v[198:199], v[198:199], v[46:47], v[88:89]
    v_pk_mul_f32 v[70:71], v[180:181], s[78:79]
    v_pk_mul_f32 v[72:73], v[182:183], s[78:79]
    v_pk_mul_f32 v[74:75], v[196:197], s[78:79]
    v_pk_mul_f32 v[76:77], v[198:199], s[78:79]
    v_exp_f32_e64 v70, v70 clamp
    v_exp_f32_e64 v71, v71 clamp
    v_exp_f32_e64 v72, v72 clamp
    v_exp_f32_e64 v73, v73 clamp
    v_exp_f32_e64 v74, v74 clamp
    v_exp_f32_e64 v75, v75 clamp
    v_exp_f32_e64 v76, v76 clamp
    v_exp_f32_e64 v77, v77 clamp
    v_max_f32 v78, s80, v180
    v_max_f32 v79, s80, v181
    v_max_f32 v80, s80, v182
    v_max_f32 v81, s80, v183
    v_max_f32 v82, s80, v196
    v_max_f32 v83, s80, v197
    v_max_f32 v84, s80, v198
    v_max_f32 v85, s80, v199
    v_pk_add_f32 v[70:71], v[70:71], v[78:79]
    v_pk_add_f32 v[72:73], v[72:73], v[80:81]
    v_pk_add_f32 v[74:75], v[74:75], v[82:83]
    v_pk_add_f32 v[76:77], v[76:77], v[84:85]
    v_cvt_pk_bf16_f32 v178, v70, v71
    v_cvt_pk_bf16_f32 v179, v72, v73
    v_cvt_pk_bf16_f32 v194, v74, v75
    v_cvt_pk_bf16_f32 v195, v76, v77
    v_pk_fma_f32 v[86:87], v[40:41], v[12:13], v[12:13] op_sel:[0,0,1] op_sel_hi:[1,0,1]
    v_pk_fma_f32 v[88:89], v[42:43], v[12:13], v[12:13] op_sel:[0,0,1] op_sel_hi:[1,0,1]
    v_pk_fma_f32 v[212:213], v[212:213], v[44:45], v[86:87]
    v_pk_fma_f32 v[214:215], v[214:215], v[46:47], v[88:89]
    v_cvt_pk_bf16_f32 v88, v212, v213
    v_cvt_pk_bf16_f32 v89, v214, v215
    v_cndmask_b32 v94, v88, v6, s[82:83]
    v_cndmask_b32 v95, v89, v6, s[82:83]
    v_pk_mul_f32 v[70:71], v[212:213], s[78:79]
    v_pk_mul_f32 v[72:73], v[214:215], s[78:79]
    v_exp_f32_e64 v70, v70 clamp
    v_exp_f32_e64 v71, v71 clamp
    v_exp_f32_e64 v72, v72 clamp
    v_exp_f32_e64 v73, v73 clamp
    v_max_f32 v78, s80, v212
    v_max_f32 v79, s80, v213
    v_max_f32 v80, s80, v214
    v_max_f32 v81, s80, v215
    v_pk_add_f32 v[70:71], v[70:71], v[78:79]
    v_pk_add_f32 v[72:73], v[72:73], v[80:81]
    v_cvt_pk_bf16_f32 v210, v70, v71
    v_cvt_pk_bf16_f32 v211, v72, v73
    v_mfma_f32_16x16x32_bf16 v[100:103], v[176:179], v[224:227], 0
    v_mfma_f32_16x16x32_bf16 v[104:107], v[176:179], v[92:95], 0
    v_mfma_f32_16x16x32_bf16 v[108:111], v[208:211], v[224:227], 0
    v_mfma_f32_16x16x32_bf16 v[112:115], v[192:195], v[240:243], 0
    v_mfma_f32_16x16x32_bf16 v[116:119], v[192:195], v[92:95], 0
    v_mfma_f32_16x16x32_bf16 v[120:123], v[208:211], v[240:243], 0
    v_mfma_f32_16x16x32_bf16 v[124:127], v[208:211], v[92:95], 0
    v_pk_mul_f32 v[86:87], v[48:49], v[10:11] op_sel:[0,0] op_sel_hi:[1,0]
    v_pk_mul_f32 v[88:89], v[50:51], v[10:11] op_sel:[0,0] op_sel_hi:[1,0]
    v_pk_fma_f32 v[232:233], v[232:233], v[52:53], v[86:87]
    v_pk_fma_f32 v[234:235], v[234:235], v[54:55], v[88:89]
    v_cvt_pk_bf16_f32 v232, v232, v233
    v_cvt_pk_bf16_f32 v233, v234, v235
    v_pk_mul_f32 v[86:87], v[48:49], v[10:11] op_sel:[0,1] op_sel_hi:[1,1]
    v_pk_mul_f32 v[88:89], v[50:51], v[10:11] op_sel:[0,1] op_sel_hi:[1,1]
    v_pk_fma_f32 v[248:249], v[248:249], v[52:53], v[86:87]
    v_pk_fma_f32 v[250:251], v[250:251], v[54:55], v[88:89]
    v_cvt_pk_bf16_f32 v248, v248, v249
    v_cvt_pk_bf16_f32 v249, v250, v251
    v_pk_fma_f32 v[86:87], v[48:49], v[8:9], s[80:81] op_sel:[0,0,0] op_sel_hi:[1,0,1]
    v_pk_fma_f32 v[88:89], v[50:51], v[8:9], s[80:81] op_sel:[0,0,0] op_sel_hi:[1,0,1]
    v_pk_fma_f32 v[184:185], v[184:185], v[52:53], v[86:87]
    v_pk_fma_f32 v[186:187], v[186:187], v[54:55], v[88:89]
    v_pk_fma_f32 v[86:87], v[48:49], v[8:9], s[80:81] op_sel:[0,1,0] op_sel_hi:[1,1,1]
    v_pk_fma_f32 v[88:89], v[50:51], v[8:9], s[80:81] op_sel:[0,1,0] op_sel_hi:[1,1,1]
    v_pk_fma_f32 v[200:201], v[200:201], v[52:53], v[86:87]
    v_pk_fma_f32 v[202:203], v[202:203], v[54:55], v[88:89]
    v_pk_mul_f32 v[70:71], v[184:185], s[78:79]
    v_pk_mul_f32 v[72:73], v[186:187], s[78:79]
    v_pk_mul_f32 v[74:75], v[200:201], s[78:79]
    v_pk_mul_f32 v[76:77], v[202:203], s[78:79]
    v_exp_f32_e64 v70, v70 clamp
    v_exp_f32_e64 v71, v71 clamp
    v_exp_f32_e64 v72, v72 clamp
    v_exp_f32_e64 v73, v73 clamp
    v_exp_f32_e64 v74, v74 clamp
    v_exp_f32_e64 v75, v75 clamp
    v_exp_f32_e64 v76, v76 clamp
    v_exp_f32_e64 v77, v77 clamp
    v_max_f32 v78, s80, v184
    v_max_f32 v79, s80, v185
    v_max_f32 v80, s80, v186
    v_max_f32 v81, s80, v187
    v_max_f32 v82, s80, v200
    v_max_f32 v83, s80, v201
    v_max_f32 v84, s80, v202
    v_max_f32 v85, s80, v203
    v_pk_add_f32 v[70:71], v[70:71], v[78:79]
    v_pk_add_f32 v[72:73], v[72:73], v[80:81]
    v_pk_add_f32 v[74:75], v[74:75], v[82:83]
    v_pk_add_f32 v[76:77], v[76:77], v[84:85]
    v_cvt_pk_bf16_f32 v184, v70, v71
    v_cvt_pk_bf16_f32 v185, v72, v73
    v_cvt_pk_bf16_f32 v200, v74, v75
    v_cvt_pk_bf16_f32 v201, v76, v77
    v_pk_fma_f32 v[86:87], v[48:49], v[12:13], v[12:13] op_sel:[0,0,1] op_sel_hi:[1,0,1]
    v_pk_fma_f32 v[88:89], v[50:51], v[12:13], v[12:13] op_sel:[0,0,1] op_sel_hi:[1,0,1]
    v_pk_fma_f32 v[216:217], v[216:217], v[52:53], v[86:87]
    v_pk_fma_f32 v[218:219], v[218:219], v[54:55], v[88:89]
    v_cvt_pk_bf16_f32 v88, v216, v217
    v_cvt_pk_bf16_f32 v89, v218, v219
    v_cndmask_b32 v96, v88, v6, s[82:83]
    v_cndmask_b32 v97, v89, v6, s[82:83]
    v_pk_mul_f32 v[70:71], v[216:217], s[78:79]
    v_pk_mul_f32 v[72:73], v[218:219], s[78:79]
    v_exp_f32_e64 v70, v70 clamp
    v_exp_f32_e64 v71, v71 clamp
    v_exp_f32_e64 v72, v72 clamp
    v_exp_f32_e64 v73, v73 clamp
    v_max_f32 v78, s80, v216
    v_max_f32 v79, s80, v217
    v_max_f32 v80, s80, v218
    v_max_f32 v81, s80, v219
    v_pk_add_f32 v[70:71], v[70:71], v[78:79]
    v_pk_add_f32 v[72:73], v[72:73], v[80:81]
    v_cvt_pk_bf16_f32 v216, v70, v71
    v_cvt_pk_bf16_f32 v217, v72, v73
    v_pk_mul_f32 v[86:87], v[56:57], v[10:11] op_sel:[0,0] op_sel_hi:[1,0]
    v_pk_mul_f32 v[88:89], v[58:59], v[10:11] op_sel:[0,0] op_sel_hi:[1,0]
    v_pk_fma_f32 v[236:237], v[236:237], v[60:61], v[86:87]
    v_pk_fma_f32 v[238:239], v[238:239], v[62:63], v[88:89]
    v_cvt_pk_bf16_f32 v234, v236, v237
    v_cvt_pk_bf16_f32 v235, v238, v239
    v_pk_mul_f32 v[86:87], v[56:57], v[10:11] op_sel:[0,1] op_sel_hi:[1,1]
    v_pk_mul_f32 v[88:89], v[58:59], v[10:11] op_sel:[0,1] op_sel_hi:[1,1]
    v_pk_fma_f32 v[252:253], v[252:253], v[60:61], v[86:87]
    v_pk_fma_f32 v[254:255], v[254:255], v[62:63], v[88:89]
    v_cvt_pk_bf16_f32 v250, v252, v253
    v_cvt_pk_bf16_f32 v251, v254, v255
    v_pk_fma_f32 v[86:87], v[56:57], v[8:9], s[80:81] op_sel:[0,0,0] op_sel_hi:[1,0,1]
    v_pk_fma_f32 v[88:89], v[58:59], v[8:9], s[80:81] op_sel:[0,0,0] op_sel_hi:[1,0,1]
    v_pk_fma_f32 v[188:189], v[188:189], v[60:61], v[86:87]
    v_pk_fma_f32 v[190:191], v[190:191], v[62:63], v[88:89]
    v_pk_fma_f32 v[86:87], v[56:57], v[8:9], s[80:81] op_sel:[0,1,0] op_sel_hi:[1,1,1]
    v_pk_fma_f32 v[88:89], v[58:59], v[8:9], s[80:81] op_sel:[0,1,0] op_sel_hi:[1,1,1]
    v_pk_fma_f32 v[204:205], v[204:205], v[60:61], v[86:87]
    v_pk_fma_f32 v[206:207], v[206:207], v[62:63], v[88:89]
    v_pk_mul_f32 v[70:71], v[188:189], s[78:79]
    v_pk_mul_f32 v[72:73], v[190:191], s[78:79]
    v_pk_mul_f32 v[74:75], v[204:205], s[78:79]
    v_pk_mul_f32 v[76:77], v[206:207], s[78:79]
    v_exp_f32_e64 v70, v70 clamp
    v_exp_f32_e64 v71, v71 clamp
    v_exp_f32_e64 v72, v72 clamp
    v_exp_f32_e64 v73, v73 clamp
    v_exp_f32_e64 v74, v74 clamp
    v_exp_f32_e64 v75, v75 clamp
    v_exp_f32_e64 v76, v76 clamp
    v_exp_f32_e64 v77, v77 clamp
    v_max_f32 v78, s80, v188
    v_max_f32 v79, s80, v189
    v_max_f32 v80, s80, v190
    v_max_f32 v81, s80, v191
    v_max_f32 v82, s80, v204
    v_max_f32 v83, s80, v205
    v_max_f32 v84, s80, v206
    v_max_f32 v85, s80, v207
    v_pk_add_f32 v[70:71], v[70:71], v[78:79]
    v_pk_add_f32 v[72:73], v[72:73], v[80:81]
    v_pk_add_f32 v[74:75], v[74:75], v[82:83]
    v_pk_add_f32 v[76:77], v[76:77], v[84:85]
    v_cvt_pk_bf16_f32 v186, v70, v71
    v_cvt_pk_bf16_f32 v187, v72, v73
    v_cvt_pk_bf16_f32 v202, v74, v75
    v_cvt_pk_bf16_f32 v203, v76, v77
    v_pk_fma_f32 v[86:87], v[56:57], v[12:13], v[12:13] op_sel:[0,0,1] op_sel_hi:[1,0,1]
    v_pk_fma_f32 v[88:89], v[58:59], v[12:13], v[12:13] op_sel:[0,0,1] op_sel_hi:[1,0,1]
    v_pk_fma_f32 v[220:221], v[220:221], v[60:61], v[86:87]
    v_pk_fma_f32 v[222:223], v[222:223], v[62:63], v[88:89]
    v_cvt_pk_bf16_f32 v88, v220, v221
    v_cvt_pk_bf16_f32 v89, v222, v223
    v_cndmask_b32 v98, v88, v6, s[82:83]
    v_cndmask_b32 v99, v89, v6, s[82:83]
    v_pk_mul_f32 v[70:71], v[220:221], s[78:79]
    v_pk_mul_f32 v[72:73], v[222:223], s[78:79]
    v_exp_f32_e64 v70, v70 clamp
    v_exp_f32_e64 v71, v71 clamp
    v_exp_f32_e64 v72, v72 clamp
    v_exp_f32_e64 v73, v73 clamp
    v_max_f32 v78, s80, v220
    v_max_f32 v79, s80, v221
    v_max_f32 v80, s80, v222
    v_max_f32 v81, s80, v223
    v_pk_add_f32 v[70:71], v[70:71], v[78:79]
    v_pk_add_f32 v[72:73], v[72:73], v[80:81]
    v_cvt_pk_bf16_f32 v218, v70, v71
    v_cvt_pk_bf16_f32 v219, v72, v73
    v_mfma_f32_16x16x32_bf16 v[100:103], v[184:187], v[232:235], v[100:103]
    v_mfma_f32_16x16x32_bf16 v[104:107], v[184:187], v[96:99], v[104:107]
    v_mfma_f32_16x16x32_bf16 v[108:111], v[216:219], v[232:235], v[108:111]
    v_mfma_f32_16x16x32_bf16 v[112:115], v[200:203], v[248:251], v[112:115]
    v_mfma_f32_16x16x32_bf16 v[116:119], v[200:203], v[96:99], v[116:119]
    v_mfma_f32_16x16x32_bf16 v[120:123], v[216:219], v[248:251], v[120:123]
    v_mfma_f32_16x16x32_bf16 v[124:127], v[216:219], v[96:99], v[124:127]
    s_nop 1
    ds_write_b128 v15, v[100:103]
    s_nop 3
    ds_write_b128 v15, v[112:115] offset:1680
    s_mov_b32 exec_lo, 0xf010f01
    s_mov_b32 exec_hi, 0xf010f01
    ds_write_b128 v17, v[104:107]
    s_mov_b32 exec_lo, 0xffff
    s_mov_b32 exec_hi, 0x0
    ds_write_b128 v14, v[108:111] offset:64
    s_mov_b32 exec_lo, 0xf001f001
    s_mov_b32 exec_hi, 0xf001f001
    ds_write_b128 v17, v[116:119] offset:1680
    s_mov_b32 exec_lo, 0xffff0000
    s_mov_b32 exec_hi, 0x0
    ds_write_b128 v14, v[120:123] offset:64
    s_mov_b32 exec_lo, 0xf0010f01
    s_mov_b32 exec_hi, 0x0
    ds_write_b128 v16, v[124:127] offset:64
    s_mov_b64 exec, 1
    s_waitcnt lgkmcnt(0)
    ds_add_u32 v18, v24
    s_mov_b64 exec, -1
    s_mov_b32 s67, 4194304
L_lw_92:
    ds_read_b32 v19, v18
    s_sub_u32 s67, s67, 1
    s_cbranch_scc1 L_lw_93
    s_waitcnt lgkmcnt(0)
    v_cmp_eq_u32 vcc, 2, v19
    s_cbranch_vccz L_lw_92
L_lw_93:
    ds_read_b128 v[52:55], v20
    ds_read_b128 v[56:59], v20 offset:16
    ds_read_b128 v[60:63], v20 offset:6720
    ds_read_b128 v[64:67], v20 offset:6736
    s_lshl_b32 s64, s73, 1
    s_add_u32 s64, s64, s74
    s_lshl_b32 s64, s64, 9
    s_add_u32 s64, s64, 155648
    v_lshrrev_b32 v1, 2, v31
    v_lshl_add_u32 v1, v1, 6, s64
    v_and_b32 v2, 3, v31
    v_lshl_add_u32 v1, v2, 2, v1
    v_xor_b32 v7, 0x200, v1
    ds_read2_b32 v[32:33], v1 offset0:0 offset1:4
    ds_read2_b32 v[34:35], v1 offset0:64 offset1:68
    ds_read2_b32 v[36:37], v7 offset0:0 offset1:4
    ds_read2_b32 v[38:39], v7 offset0:64 offset1:68
    s_mul_i32 s64, s74, 160
    s_add_u32 s64, s64, 157696
    v_lshl_add_u32 v2, v30, 4, s64
    ds_read_b128 v[40:43], v2
    ds_read_b128 v[44:47], v2 offset:80
    v_mul_u32_u24 v2, 80, v30
    v_add_u32 v2, 157696, v2
    ds_read_b128 v[48:51], v2 offset:64
    s_waitcnt lgkmcnt(7)
    s_nop 0
    v_pk_add_f32 v[52:53], v[52:53], v[60:61]
    v_pk_add_f32 v[54:55], v[54:55], v[62:63]
    v_pk_add_f32 v[56:57], v[56:57], v[64:65]
    v_pk_add_f32 v[58:59], v[58:59], v[66:67]
    v_cvt_pk_bf16_f32 v92, v52, v53
    v_cvt_pk_bf16_f32 v93, v54, v55
    v_cvt_pk_bf16_f32 v94, v56, v57
    v_cvt_pk_bf16_f32 v95, v58, v59
    buffer_store_dwordx4 v[92:95], v21, s[24:27], 0 offen sc1
    v_mov_b32 v1, 158724
    v_mov_b32 v2, 1
    s_mov_b64 exec, 1
    ds_add_u32 v1, v2
    s_mov_b64 exec, -1
    s_waitcnt lgkmcnt(0)
    v_mul_f32_e64 v32, -v32, v33
    v_mul_f32_e64 v34, -v34, v35
    v_mul_f32_e64 v36, -v36, v37
    v_mul_f32_e64 v38, -v38, v39
    v_pk_fma_f32 v[86:87], v[40:41], v[32:33], s[80:81] op_sel_hi:[1,0,1]
    v_pk_fma_f32 v[88:89], v[42:43], v[32:33], s[80:81] op_sel_hi:[1,0,1]
    v_pk_fma_f32 v[128:129], v[128:129], v[32:33], v[86:87] op_sel:[0,1,0] op_sel_hi:[1,1,1]
    v_pk_fma_f32 v[130:131], v[130:131], v[32:33], v[88:89] op_sel:[0,1,0] op_sel_hi:[1,1,1]
    v_pk_fma_f32 v[86:87], v[48:49], v[32:33], s[80:81] op_sel_hi:[1,0,1]
    v_pk_fma_f32 v[88:89], v[50:51], v[32:33], s[80:81] op_sel_hi:[1,0,1]
    v_pk_fma_f32 v[160:161], v[160:161], v[32:33], v[86:87] op_sel:[0,1,0] op_sel_hi:[1,1,1]
    v_pk_fma_f32 v[162:163], v[162:163], v[32:33], v[88:89] op_sel:[0,1,0] op_sel_hi:[1,1,1]
    v_pk_mul_f32 v[70:71], v[128:129], s[78:79]
    v_pk_mul_f32 v[72:73], v[130:131], s[78:79]
    v_pk_mul_f32 v[74:75], v[160:161], s[78:79]
    v_pk_mul_f32 v[76:77], v[162:163], s[78:79]
    v_exp_f32_e64 v70, v70 clamp
    v_exp_f32_e64 v71, v71 clamp
    v_exp_f32_e64 v72, v72 clamp
    v_exp_f32_e64 v73, v73 clamp
    v_exp_f32_e64 v74, v74 clamp
    v_exp_f32_e64 v75, v75 clamp
    v_exp_f32_e64 v76, v76 clamp
    v_exp_f32_e64 v77, v77 clamp
    v_max_f32 v78, s80, v128
    v_max_f32 v79, s80, v129
    v_max_f32 v80, s80, v130
    v_max_f32 v81, s80, v131
    v_max_f32 v82, s80, v160
    v_max_f32 v83, s80, v161
    v_max_f32 v84, s80, v162
    v_max_f32 v85, s80, v163
    v_pk_add_f32 v[70:71], v[70:71], v[78:79]
    v_pk_add_f32 v[72:73], v[72:73], v[80:81]
    v_pk_add_f32 v[74:75], v[74:75], v[82:83]
    v_pk_add_f32 v[76:77], v[76:77], v[84:85]
    v_cvt_pk_bf16_f32 v8, v70, v71
    v_cvt_pk_bf16_f32 v9, v72, v73
    v_cvt_pk_bf16_f32 v10, v74, v75
    v_cvt_pk_bf16_f32 v11, v76, v77
    v_pk_fma_f32 v[86:87], v[44:45], v[32:33], s[80:81] op_sel_hi:[1,0,1]
    v_pk_fma_f32 v[88:89], v[46:47], v[32:33], s[80:81] op_sel_hi:[1,0,1]
    v_pk_fma_f32 v[144:145], v[144:145], v[32:33], v[86:87] op_sel:[0,1,0] op_sel_hi:[1,1,1]
    v_pk_fma_f32 v[146:147], v[146:147], v[32:33], v[88:89] op_sel:[0,1,0] op_sel_hi:[1,1,1]
    v_pk_mul_f32 v[70:71], v[144:145], s[78:79]
    v_pk_mul_f32 v[72:73], v[146:147], s[78:79]
    v_exp_f32_e64 v70, v70 clamp
    v_exp_f32_e64 v71, v71 clamp
    v_exp_f32_e64 v72, v72 clamp
    v_exp_f32_e64 v73, v73 clamp
    v_max_f32 v78, s80, v144
    v_max_f32 v79, s80, v145
    v_max_f32 v80, s80, v146
    v_max_f32 v81, s80, v147
    v_pk_add_f32 v[70:71], v[70:71], v[78:79]
    v_pk_add_f32 v[72:73], v[72:73], v[80:81]
    v_cvt_pk_bf16_f32 v12, v70, v71
    v_cvt_pk_bf16_f32 v13, v72, v73
    v_pk_fma_f32 v[86:87], v[40:41], v[34:35], s[80:81] op_sel_hi:[1,0,1]
    v_pk_fma_f32 v[88:89], v[42:43], v[34:35], s[80:81] op_sel_hi:[1,0,1]
    v_pk_fma_f32 v[132:133], v[132:133], v[34:35], v[86:87] op_sel:[0,1,0] op_sel_hi:[1,1,1]
    v_pk_fma_f32 v[134:135], v[134:135], v[34:35], v[88:89] op_sel:[0,1,0] op_sel_hi:[1,1,1]
    v_pk_fma_f32 v[86:87], v[48:49], v[34:35], s[80:81] op_sel_hi:[1,0,1]
    v_pk_fma_f32 v[88:89], v[50:51], v[34:35], s[80:81] op_sel_hi:[1,0,1]
    v_pk_fma_f32 v[164:165], v[164:165], v[34:35], v[86:87] op_sel:[0,1,0] op_sel_hi:[1,1,1]
    v_pk_fma_f32 v[166:167], v[166:167], v[34:35], v[88:89] op_sel:[0,1,0] op_sel_hi:[1,1,1]
    v_pk_mul_f32 v[70:71], v[132:133], s[78:79]
    v_pk_mul_f32 v[72:73], v[134:135], s[78:79]
    v_pk_mul_f32 v[74:75], v[164:165], s[78:79]
    v_pk_mul_f32 v[76:77], v[166:167], s[78:79]
    v_exp_f32_e64 v70, v70 clamp
    v_exp_f32_e64 v71, v71 clamp
    v_exp_f32_e64 v72, v72 clamp
    v_exp_f32_e64 v73, v73 clamp
    v_exp_f32_e64 v74, v74 clamp
    v_exp_f32_e64 v75, v75 clamp
    v_exp_f32_e64 v76, v76 clamp
    v_exp_f32_e64 v77, v77 clamp
    v_max_f32 v78, s80, v132
    v_max_f32 v79, s80, v133
    v_max_f32 v80, s80, v134
    v_max_f32 v81, s80, v135
    v_max_f32 v82, s80, v164
    v_max_f32 v83, s80, v165
    v_max_f32 v84, s80, v166
    v_max_f32 v85, s80, v167
    v_pk_add_f32 v[70:71], v[70:71], v[78:79]
    v_pk_add_f32 v[72:73], v[72:73], v[80:81]
    v_pk_add_f32 v[74:75], v[74:75], v[82:83]
    v_pk_add_f32 v[76:77], v[76:77], v[84:85]
    v_cvt_pk_bf16_f32 v14, v70, v71
    v_cvt_pk_bf16_f32 v15, v72, v73
    v_cvt_pk_bf16_f32 v16, v74, v75
    v_cvt_pk_bf16_f32 v17, v76, v77
    v_pk_fma_f32 v[86:87], v[44:45], v[34:35], s[80:81] op_sel_hi:[1,0,1]
    v_pk_fma_f32 v[88:89], v[46:47], v[34:35], s[80:81] op_sel_hi:[1,0,1]
    v_pk_fma_f32 v[148:149], v[148:149], v[34:35], v[86:87] op_sel:[0,1,0] op_sel_hi:[1,1,1]
    v_pk_fma_f32 v[150:151], v[150:151], v[34:35], v[88:89] op_sel:[0,1,0] op_sel_hi:[1,1,1]
    v_pk_mul_f32 v[70:71], v[148:149], s[78:79]
    v_pk_mul_f32 v[72:73], v[150:151], s[78:79]
    v_exp_f32_e64 v70, v70 clamp
    v_exp_f32_e64 v71, v71 clamp
    v_exp_f32_e64 v72, v72 clamp
    v_exp_f32_e64 v73, v73 clamp
    v_max_f32 v78, s80, v148
    v_max_f32 v79, s80, v149
    v_max_f32 v80, s80, v150
    v_max_f32 v81, s80, v151
    v_pk_add_f32 v[70:71], v[70:71], v[78:79]
    v_pk_add_f32 v[72:73], v[72:73], v[80:81]
    v_cvt_pk_bf16_f32 v18, v70, v71
    v_cvt_pk_bf16_f32 v19, v72, v73
    s_lshl_b32 s64, s63, 10
    v_lshl_add_u32 v1, v0, 3, s64
    ds_write_b64 v1, v[10:11]
    ds_write_b64 v1, v[16:17] offset:512
    s_nop 0
    v_pk_fma_f32 v[86:87], v[40:41], v[36:37], s[80:81] op_sel_hi:[1,0,1]
    v_pk_fma_f32 v[88:89], v[42:43], v[36:37], s[80:81] op_sel_hi:[1,0,1]
    v_pk_fma_f32 v[136:137], v[136:137], v[36:37], v[86:87] op_sel:[0,1,0] op_sel_hi:[1,1,1]
    v_pk_fma_f32 v[138:139], v[138:139], v[36:37], v[88:89] op_sel:[0,1,0] op_sel_hi:[1,1,1]
    v_pk_fma_f32 v[86:87], v[44:45], v[36:37], s[80:81] op_sel_hi:[1,0,1]
    v_pk_fma_f32 v[88:89], v[46:47], v[36:37], s[80:81] op_sel_hi:[1,0,1]
    v_pk_fma_f32 v[152:153], v[152:153], v[36:37], v[86:87] op_sel:[0,1,0] op_sel_hi:[1,1,1]
    v_pk_fma_f32 v[154:155], v[154:155], v[36:37], v[88:89] op_sel:[0,1,0] op_sel_hi:[1,1,1]
    v_pk_mul_f32 v[70:71], v[136:137], s[78:79]
    v_pk_mul_f32 v[72:73], v[138:139], s[78:79]
    v_pk_mul_f32 v[74:75], v[152:153], s[78:79]
    v_pk_mul_f32 v[76:77], v[154:155], s[78:79]
    v_exp_f32_e64 v70, v70 clamp
    v_exp_f32_e64 v71, v71 clamp
    v_exp_f32_e64 v72, v72 clamp
    v_exp_f32_e64 v73, v73 clamp
    v_exp_f32_e64 v74, v74 clamp
    v_exp_f32_e64 v75, v75 clamp
    v_exp_f32_e64 v76, v76 clamp
    v_exp_f32_e64 v77, v77 clamp
    v_max_f32 v78, s80, v136
    v_max_f32 v79, s80, v137
    v_max_f32 v80, s80, v138
    v_max_f32 v81, s80, v139
    v_max_f32 v82, s80, v152
    v_max_f32 v83, s80, v153
    v_max_f32 v84, s80, v154
    v_max_f32 v85, s80, v155
    v_pk_add_f32 v[70:71], v[70:71], v[78:79]
    v_pk_add_f32 v[72:73], v[72:73], v[80:81]
    v_pk_add_f32 v[74:75], v[74:75], v[82:83]
    v_pk_add_f32 v[76:77], v[76:77], v[84:85]
    v_cvt_pk_bf16_f32 v20, v70, v71
    v_cvt_pk_bf16_f32 v21, v72, v73
    v_cvt_pk_bf16_f32 v24, v74, v75
    v_cvt_pk_bf16_f32 v25, v76, v77
    v_pk_fma_f32 v[86:87], v[40:41], v[38:39], s[80:81] op_sel_hi:[1,0,1]
    v_pk_fma_f32 v[88:89], v[42:43], v[38:39], s[80:81] op_sel_hi:[1,0,1]
    v_pk_fma_f32 v[140:141], v[140:141], v[38:39], v[86:87] op_sel:[0,1,0] op_sel_hi:[1,1,1]
    v_pk_fma_f32 v[142:143], v[142:143], v[38:39], v[88:89] op_sel:[0,1,0] op_sel_hi:[1,1,1]
    v_pk_fma_f32 v[86:87], v[44:45], v[38:39], s[80:81] op_sel_hi:[1,0,1]
    v_pk_fma_f32 v[88:89], v[46:47], v[38:39], s[80:81] op_sel_hi:[1,0,1]
    v_pk_fma_f32 v[156:157], v[156:157], v[38:39], v[86:87] op_sel:[0,1,0] op_sel_hi:[1,1,1]
    v_pk_fma_f32 v[158:159], v[158:159], v[38:39], v[88:89] op_sel:[0,1,0] op_sel_hi:[1,1,1]
    v_pk_mul_f32 v[70:71], v[140:141], s[78:79]
    v_pk_mul_f32 v[72:73], v[142:143], s[78:79]
    v_pk_mul_f32 v[74:75], v[156:157], s[78:79]
    v_pk_mul_f32 v[76:77], v[158:159], s[78:79]
    v_exp_f32_e64 v70, v70 clamp
    v_exp_f32_e64 v71, v71 clamp
    v_exp_f32_e64 v72, v72 clamp
    v_exp_f32_e64 v73, v73 clamp
    v_exp_f32_e64 v74, v74 clamp
    v_exp_f32_e64 v75, v75 clamp
    v_exp_f32_e64 v76, v76 clamp
    v_exp_f32_e64 v77, v77 clamp
    v_max_f32 v78, s80, v140
    v_max_f32 v79, s80, v141
    v_max_f32 v80, s80, v142
    v_max_f32 v81, s80, v143
    v_max_f32 v82, s80, v156
    v_max_f32 v83, s80, v157
    v_max_f32 v84, s80, v158
    v_max_f32 v85, s80, v159
    v_pk_add_f32 v[70:71], v[70:71], v[78:79]
    v_pk_add_f32 v[72:73], v[72:73], v[80:81]
    v_pk_add_f32 v[74:75], v[74:75], v[82:83]
    v_pk_add_f32 v[76:77], v[76:77], v[84:85]
    v_cvt_pk_bf16_f32 v26, v70, v71
    v_cvt_pk_bf16_f32 v27, v72, v73
    v_cvt_pk_bf16_f32 v30, v74, v75
    v_cvt_pk_bf16_f32 v31, v76, v77
    v_lshrrev_b32 v152, 4, v0
    v_and_b32 v153, 15, v0
    s_mul_i32 s64, s73, 2048
    v_lshl_add_u32 v2, v0, 4, s64
    v_lshrrev_b32 v1, 2, v0
    v_lshrrev_b32 v3, 3, v0
    v_and_b32 v3, 3, v3
    s_lshl_b32 s64, s74, 1
    v_xor_b32 v3, s64, v3
    v_lshlrev_b32 v3, 5, v3
    v_lshl_add_u32 v3, v1, 7, v3
    v_and_b32_e64 v1, 3, v0
    v_lshl_add_u32 v3, v1, 3, v3
    v_add_u32 v3, 49152, v3
    v_xor_b32 v4, 32, v3
    v_bfe_u32 v1, v153, 1, 2
    v_xor_b32 v1, s64, v1
    v_lshlrev_b32_e64 v1, 5, v1
    v_lshl_add_u32 v1, v153, 7, v1
    v_lshl_add_u32 v1, v152, 3, v1
    s_mul_i32 s64, s73, 4096
    s_add_u32 s64, s64, 131072
    v_add_u32 v5, s64, v1
    v_xor_b32 v6, 32, v5
    v_lshrrev_b32 v1, 4, v0
    v_lshlrev_b32 v1, 1, v1
    v_xor_b32 v1, v1, v0
    v_and_b32 v1, 7, v1
    v_lshlrev_b32 v1, 4, v1
    v_lshrrev_b32 v7, 3, v0
    v_mul_u32_u24 v7, 1280, v7
    v_add_u32 v7, v7, v1
    s_mul_i32 s64, s74, 1680
    s_add_u32 s64, s64, 158976
    v_mul_u32_u24 v248, 40, v153
    v_add_u32 v248, s64, v248
    v_and_b32 v1, 3, v153
    v_mul_u32_u24 v1, 40, v1
    s_add_u32 s65, s64, 640
    v_add_u32 v249, s65, v1
    s_add_u32 s65, s64, 800
    v_mov_b32 v250, s65
    v_lshlrev_b32 v251, 3, v152
    s_lshl_b32 s64, s55, 2
    s_lshl_b32 s65, s73, 1
    s_add_u32 s64, s64, s65
    s_add_u32 s64, s64, s74
    s_mul_i32 s82, s64, 139264
    s_mul_i32 s81, s74, 278528
    s_sub_u32 s81, 69632, s81
    s_lshl_b32 s72, s74, 5
    s_lshl_b32 s64, s56, 1
    s_add_u32 s64, s64, s74
    s_lshl_b32 s65, s64, 10
    s_add_u32 s83, s82, s65
    s_add_u32 s83, s83, 49152
    s_lshr_b32 s65, s64, 2
    s_lshl_b32 s65, s65, 10
    s_and_b32 s64, s64, 3
    s_lshl_b32 s64, s64, 8
    s_add_u32 s82, s82, s65
    s_add_u32 s82, s82, s64
    s_add_u32 s82, s82, 65536
    v_mov_b32 v226, 0
    v_mov_b32 v227, 0
    v_mov_b32 v230, 0
    v_mov_b32 v231, 0
    v_mov_b32 v234, 0
    v_mov_b32 v235, 0
    v_mov_b32 v236, 0
    v_mov_b32 v237, 0
    v_mov_b32 v240, 0
    v_mov_b32 v241, 0
    v_mov_b32 v244, 0
    v_mov_b32 v245, 0
    v_mov_b32 v128, 0
    v_mov_b32 v129, 0
    v_mov_b32 v130, 0
    v_mov_b32 v131, 0
    v_mov_b32 v132, 0
    v_mov_b32 v133, 0
    v_mov_b32 v134, 0
    v_mov_b32 v135, 0
    v_mov_b32 v136, 0
    v_mov_b32 v137, 0
    v_mov_b32 v138, 0
    v_mov_b32 v139, 0
    v_mov_b32 v140, 0
    v_mov_b32 v141, 0
    v_mov_b32 v142, 0
    v_mov_b32 v143, 0
    s_mov_b32 s77, 3
    s_mov_b32 s75, 0
    s_mov_b32 s76, 3
    s_xor_b32 s64, s63, 1
    s_lshl_b32 s64, s64, 10
    v_lshl_add_u32 v1, v0, 3, s64
    s_waitcnt lgkmcnt(0)
    s_barrier
    ds_read_b64 v[22:23], v1
    ds_read_b64 v[28:29], v1 offset:512
    ds_read_b64_tr_b16 v[40:41], v3 offset:0
    ds_read_b64_tr_b16 v[42:43], v3 offset:2048
    ds_read_b64_tr_b16 v[44:45], v4 offset:0
    ds_read_b64_tr_b16 v[46:47], v4 offset:2048
    ds_read_b64_tr_b16 v[56:57], v3 offset:4096
    ds_read_b64_tr_b16 v[58:59], v3 offset:6144
    ds_read_b64_tr_b16 v[60:61], v4 offset:4096
    ds_read_b64_tr_b16 v[62:63], v4 offset:6144
    ds_read_b64_tr_b16 v[72:73], v3 offset:8192
    ds_read_b64_tr_b16 v[74:75], v3 offset:10240
    ds_read_b64_tr_b16 v[76:77], v4 offset:8192
    ds_read_b64_tr_b16 v[78:79], v4 offset:10240
    ds_read_b64_tr_b16 v[88:89], v3 offset:12288
    ds_read_b64_tr_b16 v[90:91], v3 offset:14336
    ds_read_b64_tr_b16 v[92:93], v4 offset:12288
    ds_read_b64_tr_b16 v[94:95], v4 offset:14336
    ds_read_b64_tr_b16 v[168:169], v3 offset:16384
    ds_read_b64_tr_b16 v[170:171], v3 offset:18432
    ds_read_b64_tr_b16 v[172:173], v4 offset:16384
    ds_read_b64_tr_b16 v[174:175], v4 offset:18432
    ds_read_b64_tr_b16 v[176:177], v3 offset:20480
    ds_read_b64_tr_b16 v[178:179], v3 offset:22528
    ds_read_b64_tr_b16 v[180:181], v4 offset:20480
    ds_read_b64_tr_b16 v[182:183], v4 offset:22528
    ds_read_b64_tr_b16 v[184:185], v3 offset:24576
    ds_read_b64_tr_b16 v[186:187], v3 offset:26624
    ds_read_b64_tr_b16 v[188:189], v4 offset:24576
    ds_read_b64_tr_b16 v[190:191], v4 offset:26624
    ds_read_b64_tr_b16 v[192:193], v3 offset:28672
    ds_read_b64_tr_b16 v[194:195], v3 offset:30720
    ds_read_b64_tr_b16 v[196:197], v4 offset:28672
    ds_read_b64_tr_b16 v[198:199], v4 offset:30720
    ds_read_b64_tr_b16 v[200:201], v3 offset:32768
    ds_read_b64_tr_b16 v[202:203], v3 offset:34816
    ds_read_b64_tr_b16 v[204:205], v4 offset:32768
    ds_read_b64_tr_b16 v[206:207], v4 offset:34816
    ds_read_b64_tr_b16 v[208:209], v3 offset:36864
    ds_read_b64_tr_b16 v[210:211], v3 offset:38912
    ds_read_b64_tr_b16 v[212:213], v4 offset:36864
    ds_read_b64_tr_b16 v[214:215], v4 offset:38912
    ds_read_b64_tr_b16 v[216:217], v3 offset:40960
    ds_read_b64_tr_b16 v[218:219], v3 offset:43008
    ds_read_b64_tr_b16 v[220:221], v4 offset:40960
    ds_read_b64_tr_b16 v[222:223], v4 offset:43008
    ds_read_b64_tr_b16 v[120:121], v3 offset:45056
    ds_read_b64_tr_b16 v[122:123], v3 offset:47104
    ds_read_b64_tr_b16 v[124:125], v4 offset:45056
    ds_read_b64_tr_b16 v[126:127], v4 offset:47104
    v_add_u32 v3, 49152, v3
    v_add_u32 v4, 49152, v4
    s_waitcnt lgkmcnt(0)
    s_barrier
    v_mov_b32 v96, 158744
    s_mov_b32 s67, 4194304
L_lw_94:
    ds_read_b32 v97, v96
    s_sub_u32 s67, s67, 1
    s_cbranch_scc1 L_lw_95
    s_waitcnt lgkmcnt(0)
    v_cmp_eq_u32 vcc, 4, v97
    s_cbranch_vccz L_lw_94
L_lw_95:
    s_add_u32 s64, s72, 0
    s_lshl_b64 exec, 0xffff, s64
    ds_read_b64 v[226:227], v248 offset:32
    ds_read_b64 v[230:231], v249 offset:32
    ds_read_b64 v[234:235], v250 offset:32
    s_add_u32 s64, s72, 16
    s_lshl_b64 exec, 0xffff, s64
    ds_read_b64 v[236:237], v248 offset:872
    ds_read_b64 v[240:241], v249 offset:872
    ds_read_b64 v[244:245], v250 offset:872
    s_mov_b64 exec, -1
    v_add_u32 v96, v248, v251
    v_add_u32 v97, v249, v251
    v_add_u32 v98, v250, v251
    ds_read_b64 v[224:225], v96 offset:0
    ds_read_b64 v[228:229], v97 offset:0
    ds_read_b64 v[232:233], v98 offset:0
    ds_read_b64 v[238:239], v96 offset:840
    ds_read_b64 v[242:243], v97 offset:840
    ds_read_b64 v[246:247], v98 offset:840
    v_lshlrev_b32 v1, 4, v0
    s_waitcnt lgkmcnt(0)
    v_mfma_f32_16x16x32_bf16 v[104:107], v[232:235], v[8:11], 0
    v_mfma_f32_16x16x32_bf16 v[96:99], v[224:227], v[8:11], 0
    v_mfma_f32_16x16x32_bf16 v[100:103], v[228:231], v[8:11], 0
    v_mfma_f32_16x16x32_bf16 v[116:119], v[244:247], v[10:13], 0
    v_mfma_f32_16x16x32_bf16 v[108:111], v[236:239], v[10:13], 0
    v_mfma_f32_16x16x32_bf16 v[112:115], v[240:243], v[10:13], 0
    v_mfma_f32_16x16x32_bf16 v[152:155], v[232:235], v[14:17], 0
    v_mfma_f32_16x16x32_bf16 v[144:147], v[224:227], v[14:17], 0
    v_mfma_f32_16x16x32_bf16 v[148:151], v[228:231], v[14:17], 0
    v_mfma_f32_16x16x32_bf16 v[164:167], v[244:247], v[16:19], 0
    v_mfma_f32_16x16x32_bf16 v[156:159], v[236:239], v[16:19], 0
    v_mfma_f32_16x16x32_bf16 v[160:163], v[240:243], v[16:19], 0
    v_add_f32 v104, 0x358637bd, v104
    v_add_f32 v116, 0x358637bd, v116
    v_rcp_f32 v104, v104
    v_rcp_f32_e64 v116, v116
    v_pk_mul_f32 v[96:97], v[96:97], v[104:105] op_sel_hi:[1,0]
    v_pk_mul_f32 v[98:99], v[98:99], v[104:105] op_sel_hi:[1,0]
    v_pk_mul_f32 v[100:101], v[100:101], v[104:105] op_sel_hi:[1,0]
    v_pk_mul_f32 v[102:103], v[102:103], v[104:105] op_sel_hi:[1,0]
    v_pk_mul_f32 v[108:109], v[108:109], v[116:117] op_sel_hi:[1,0]
    v_pk_mul_f32 v[110:111], v[110:111], v[116:117] op_sel_hi:[1,0]
    v_pk_mul_f32 v[112:113], v[112:113], v[116:117] op_sel_hi:[1,0]
    v_pk_mul_f32 v[114:115], v[114:115], v[116:117] op_sel_hi:[1,0]
    v_cvt_pk_bf16_f32 v104, v96, v97
    v_cvt_pk_bf16_f32 v116, v100, v101
    v_cvt_pk_bf16_f32 v105, v98, v99
    v_cvt_pk_bf16_f32 v117, v102, v103
    v_cvt_pk_bf16_f32 v106, v108, v109
    v_cvt_pk_bf16_f32 v118, v112, v113
    v_cvt_pk_bf16_f32 v107, v110, v111
    v_cvt_pk_bf16_f32 v119, v114, v115
    buffer_store_dwordx4 v[104:107], v1, s[24:27], s83 offen sc1
    s_add_u32 s83, s83, 69632
    s_mov_b64 exec, 0xffff
    buffer_store_dwordx4 v[116:119], v1, s[24:27], s82 offen sc1
    s_add_u32 s82, s82, 69632
    s_mov_b64 exec, -1
    v_mfma_f32_16x16x32_bf16 v[104:107], v[232:235], v[20:23], 0
    v_mfma_f32_16x16x32_bf16 v[96:99], v[224:227], v[20:23], 0
    v_mfma_f32_16x16x32_bf16 v[100:103], v[228:231], v[20:23], 0
    v_mfma_f32_16x16x32_bf16 v[116:119], v[244:247], v[22:25], 0
    v_mfma_f32_16x16x32_bf16 v[108:111], v[236:239], v[22:25], 0
    v_mfma_f32_16x16x32_bf16 v[112:115], v[240:243], v[22:25], 0
    v_add_f32 v152, 0x358637bd, v152
    v_add_f32 v164, 0x358637bd, v164
    v_rcp_f32 v152, v152
    v_rcp_f32_e64 v164, v164
    v_pk_mul_f32 v[144:145], v[144:145], v[152:153] op_sel_hi:[1,0]
    v_pk_mul_f32 v[146:147], v[146:147], v[152:153] op_sel_hi:[1,0]
    v_pk_mul_f32 v[148:149], v[148:149], v[152:153] op_sel_hi:[1,0]
    v_pk_mul_f32 v[150:151], v[150:151], v[152:153] op_sel_hi:[1,0]
    v_pk_mul_f32 v[156:157], v[156:157], v[164:165] op_sel_hi:[1,0]
    v_pk_mul_f32 v[158:159], v[158:159], v[164:165] op_sel_hi:[1,0]
    v_pk_mul_f32 v[160:161], v[160:161], v[164:165] op_sel_hi:[1,0]
    v_pk_mul_f32 v[162:163], v[162:163], v[164:165] op_sel_hi:[1,0]
    v_cvt_pk_bf16_f32 v152, v144, v145
    v_cvt_pk_bf16_f32 v164, v148, v149
    v_cvt_pk_bf16_f32 v153, v146, v147
    v_cvt_pk_bf16_f32 v165, v150, v151
    v_cvt_pk_bf16_f32 v154, v156, v157
    v_cvt_pk_bf16_f32 v166, v160, v161
    v_cvt_pk_bf16_f32 v155, v158, v159
    v_cvt_pk_bf16_f32 v167, v162, v163
    buffer_store_dwordx4 v[152:155], v1, s[24:27], s83 offen sc1
    s_add_u32 s83, s83, s81
    s_mov_b64 exec, 0xffff
    buffer_store_dwordx4 v[164:167], v1, s[24:27], s82 offen sc1
    s_add_u32 s82, s82, s81
    s_mov_b64 exec, -1
    v_mfma_f32_16x16x32_bf16 v[152:155], v[232:235], v[26:29], 0
    v_mfma_f32_16x16x32_bf16 v[144:147], v[224:227], v[26:29], 0
    v_mfma_f32_16x16x32_bf16 v[148:151], v[228:231], v[26:29], 0
    v_mfma_f32_16x16x32_bf16 v[164:167], v[244:247], v[28:31], 0
    v_mfma_f32_16x16x32_bf16 v[156:159], v[236:239], v[28:31], 0
    v_mfma_f32_16x16x32_bf16 v[160:163], v[240:243], v[28:31], 0
    v_add_f32 v104, 0x358637bd, v104
    v_add_f32 v116, 0x358637bd, v116
    v_rcp_f32 v104, v104
    v_rcp_f32_e64 v116, v116
    v_pk_mul_f32 v[96:97], v[96:97], v[104:105] op_sel_hi:[1,0]
    v_pk_mul_f32 v[98:99], v[98:99], v[104:105] op_sel_hi:[1,0]
    v_pk_mul_f32 v[100:101], v[100:101], v[104:105] op_sel_hi:[1,0]
    v_pk_mul_f32 v[102:103], v[102:103], v[104:105] op_sel_hi:[1,0]
    v_pk_mul_f32 v[108:109], v[108:109], v[116:117] op_sel_hi:[1,0]
    v_pk_mul_f32 v[110:111], v[110:111], v[116:117] op_sel_hi:[1,0]
    v_pk_mul_f32 v[112:113], v[112:113], v[116:117] op_sel_hi:[1,0]
    v_pk_mul_f32 v[114:115], v[114:115], v[116:117] op_sel_hi:[1,0]
    v_cvt_pk_bf16_f32 v104, v96, v97
    v_cvt_pk_bf16_f32 v116, v100, v101
    v_cvt_pk_bf16_f32 v105, v98, v99
    v_cvt_pk_bf16_f32 v117, v102, v103
    v_cvt_pk_bf16_f32 v106, v108, v109
    v_cvt_pk_bf16_f32 v118, v112, v113
    v_cvt_pk_bf16_f32 v107, v110, v111
    v_cvt_pk_bf16_f32 v119, v114, v115
    buffer_store_dwordx4 v[104:107], v1, s[24:27], s83 offen sc1
    s_add_u32 s83, s83, 69632
    s_mov_b64 exec, 0xffff
    buffer_store_dwordx4 v[116:119], v1, s[24:27], s82 offen sc1
    s_add_u32 s82, s82, 69632
    s_mov_b64 exec, -1
    v_add_f32 v152, 0x358637bd, v152
    v_add_f32 v164, 0x358637bd, v164
    v_rcp_f32 v152, v152
    v_rcp_f32_e64 v164, v164
    v_pk_mul_f32 v[144:145], v[144:145], v[152:153] op_sel_hi:[1,0]
    v_pk_mul_f32 v[146:147], v[146:147], v[152:153] op_sel_hi:[1,0]
    v_pk_mul_f32 v[148:149], v[148:149], v[152:153] op_sel_hi:[1,0]
    v_pk_mul_f32 v[150:151], v[150:151], v[152:153] op_sel_hi:[1,0]
    v_pk_mul_f32 v[156:157], v[156:157], v[164:165] op_sel_hi:[1,0]
    v_pk_mul_f32 v[158:159], v[158:159], v[164:165] op_sel_hi:[1,0]
    v_pk_mul_f32 v[160:161], v[160:161], v[164:165] op_sel_hi:[1,0]
    v_pk_mul_f32 v[162:163], v[162:163], v[164:165] op_sel_hi:[1,0]
    v_cvt_pk_bf16_f32 v152, v144, v145
    v_cvt_pk_bf16_f32 v164, v148, v149
    v_cvt_pk_bf16_f32 v153, v146, v147
    v_cvt_pk_bf16_f32 v165, v150, v151
    v_cvt_pk_bf16_f32 v154, v156, v157
    v_cvt_pk_bf16_f32 v166, v160, v161
    v_cvt_pk_bf16_f32 v155, v158, v159
    v_cvt_pk_bf16_f32 v167, v162, v163
    buffer_store_dwordx4 v[152:155], v1, s[24:27], s83 offen sc1
    s_add_u32 s83, s83, 69632
    s_mov_b64 exec, 0xffff
    buffer_store_dwordx4 v[164:167], v1, s[24:27], s82 offen sc1
    s_add_u32 s82, s82, 69632
    s_mov_b64 exec, -1
    s_mov_b32 s80, 0
    s_barrier
    ds_read_b128 v[32:35], v2 offset:0
    ds_read_b128 v[36:39], v2 offset:1024
    ds_read_b128 v[48:51], v2 offset:4096
    ds_read_b128 v[52:55], v2 offset:5120
    s_waitcnt lgkmcnt(2)
    v_mfma_f32_16x16x32_bf16 v[128:131], v[40:43], v[32:35], v[128:131]
    ds_read_b128 v[64:67], v2 offset:8192
    v_mfma_f32_16x16x32_bf16 v[132:135], v[44:47], v[32:35], v[132:135]
    ds_read_b128 v[68:71], v2 offset:9216
    v_mfma_f32_16x16x32_bf16 v[140:143], v[44:47], v[36:39], v[140:143]
    v_mfma_f32_16x16x32_bf16 v[136:139], v[40:43], v[36:39], v[136:139]
    s_waitcnt lgkmcnt(2)
    v_mfma_f32_16x16x32_bf16 v[128:131], v[56:59], v[48:51], v[128:131]
    ds_read_b128 v[80:83], v2 offset:12288
    v_mfma_f32_16x16x32_bf16 v[132:135], v[60:63], v[48:51], v[132:135]
    ds_read_b128 v[84:87], v2 offset:13312
    v_mfma_f32_16x16x32_bf16 v[140:143], v[60:63], v[52:55], v[140:143]
    v_mfma_f32_16x16x32_bf16 v[136:139], v[56:59], v[52:55], v[136:139]
    s_waitcnt lgkmcnt(2)
    v_mfma_f32_16x16x32_bf16 v[128:131], v[72:75], v[64:67], v[128:131]
    v_add_u32 v2, 0x4000, v2
    v_mfma_f32_16x16x32_bf16 v[132:135], v[76:79], v[64:67], v[132:135]
    v_mfma_f32_16x16x32_bf16 v[140:143], v[76:79], v[68:71], v[140:143]
    v_mfma_f32_16x16x32_bf16 v[136:139], v[72:75], v[68:71], v[136:139]
    s_waitcnt lgkmcnt(0)
    s_barrier
    v_mfma_f32_16x16x32_bf16 v[128:131], v[88:91], v[80:83], v[128:131]
    ds_read_b128 v[32:35], v2 offset:0
    ds_read_b128 v[36:39], v2 offset:1024
    ds_read_b128 v[48:51], v2 offset:4096
    v_mfma_f32_16x16x32_bf16 v[132:135], v[92:95], v[80:83], v[132:135]
    ds_read_b128 v[52:55], v2 offset:5120
    v_mfma_f32_16x16x32_bf16 v[140:143], v[92:95], v[84:87], v[140:143]
    v_mfma_f32_16x16x32_bf16 v[136:139], v[88:91], v[84:87], v[136:139]
    s_getreg_b32 s64, hwreg(HW_REG_IB_STS, 0, 4)
    s_or_b32 s64, s64, s80
    s_cbranch_scc1 L_or1
    s_mov_b32 s80, 1
    s_lshl_b32 s64, s55, 7
    s_add_u32 s64, s64, 0x918800
    v_mov_b32 v252, 158728
    v_mov_b32 v253, 1
    v_mov_b32 v255, s64
    s_mov_b64 exec, 1
    s_waitcnt vmcnt(0)
    ds_add_rtn_u32 v254, v252, v253
    s_waitcnt lgkmcnt(0)
    v_cmp_eq_u32 vcc, 3, v254
    s_cbranch_vccz L_arr_96
    buffer_atomic_add v253, v255, s[24:27], 0 offen
L_arr_96:
    s_mov_b64 exec, -1
L_or1:
    s_waitcnt lgkmcnt(2)
    v_mfma_f32_16x16x32_bf16 v[128:131], v[168:171], v[32:35], v[128:131]
    ds_read_b128 v[64:67], v2 offset:8192
    v_mfma_f32_16x16x32_bf16 v[132:135], v[172:175], v[32:35], v[132:135]
    ds_read_b128 v[68:71], v2 offset:9216
    v_mfma_f32_16x16x32_bf16 v[140:143], v[172:175], v[36:39], v[140:143]
    v_mfma_f32_16x16x32_bf16 v[136:139], v[168:171], v[36:39], v[136:139]
    s_waitcnt lgkmcnt(2)
    v_mfma_f32_16x16x32_bf16 v[128:131], v[176:179], v[48:51], v[128:131]
    ds_read_b128 v[80:83], v2 offset:12288
    v_mfma_f32_16x16x32_bf16 v[132:135], v[180:183], v[48:51], v[132:135]
    ds_read_b128 v[84:87], v2 offset:13312
    v_mfma_f32_16x16x32_bf16 v[140:143], v[180:183], v[52:55], v[140:143]
    v_mfma_f32_16x16x32_bf16 v[136:139], v[176:179], v[52:55], v[136:139]
    s_waitcnt lgkmcnt(2)
    v_mfma_f32_16x16x32_bf16 v[128:131], v[184:187], v[64:67], v[128:131]
    v_add_u32 v2, 0x4000, v2
    v_mfma_f32_16x16x32_bf16 v[132:135], v[188:191], v[64:67], v[132:135]
    v_mfma_f32_16x16x32_bf16 v[140:143], v[188:191], v[68:71], v[140:143]
    v_mfma_f32_16x16x32_bf16 v[136:139], v[184:187], v[68:71], v[136:139]
    s_waitcnt lgkmcnt(0)
    s_barrier
    v_mfma_f32_16x16x32_bf16 v[128:131], v[192:195], v[80:83], v[128:131]
    ds_read_b128 v[32:35], v2 offset:0
    ds_read_b128 v[36:39], v2 offset:1024
    ds_read_b128 v[48:51], v2 offset:4096
    v_mfma_f32_16x16x32_bf16 v[132:135], v[196:199], v[80:83], v[132:135]
    ds_read_b128 v[52:55], v2 offset:5120
    v_mfma_f32_16x16x32_bf16 v[140:143], v[196:199], v[84:87], v[140:143]
    v_mfma_f32_16x16x32_bf16 v[136:139], v[192:195], v[84:87], v[136:139]
    s_getreg_b32 s64, hwreg(HW_REG_IB_STS, 0, 4)
    s_or_b32 s64, s64, s80
    s_cbranch_scc1 L_or2
    s_mov_b32 s80, 1
    s_lshl_b32 s64, s55, 7
    s_add_u32 s64, s64, 0x918800
    v_mov_b32 v252, 158728
    v_mov_b32 v253, 1
    v_mov_b32 v255, s64
    s_mov_b64 exec, 1
    s_waitcnt vmcnt(0)
    ds_add_rtn_u32 v254, v252, v253
    s_waitcnt lgkmcnt(0)
    v_cmp_eq_u32 vcc, 3, v254
    s_cbranch_vccz L_arr_97
    buffer_atomic_add v253, v255, s[24:27], 0 offen
L_arr_97:
    s_mov_b64 exec, -1
L_or2:
    s_waitcnt lgkmcnt(2)
    v_mfma_f32_16x16x32_bf16 v[128:131], v[200:203], v[32:35], v[128:131]
    ds_read_b128 v[64:67], v2 offset:8192
    v_mfma_f32_16x16x32_bf16 v[132:135], v[204:207], v[32:35], v[132:135]
    ds_read_b128 v[68:71], v2 offset:9216
    v_mfma_f32_16x16x32_bf16 v[140:143], v[204:207], v[36:39], v[140:143]
    v_mfma_f32_16x16x32_bf16 v[136:139], v[200:203], v[36:39], v[136:139]
    s_waitcnt lgkmcnt(2)
    v_mfma_f32_16x16x32_bf16 v[128:131], v[208:211], v[48:51], v[128:131]
    ds_read_b128 v[80:83], v2 offset:12288
    v_mfma_f32_16x16x32_bf16 v[132:135], v[212:215], v[48:51], v[132:135]
    ds_read_b128 v[84:87], v2 offset:13312
    v_mfma_f32_16x16x32_bf16 v[140:143], v[212:215], v[52:55], v[140:143]
    v_mfma_f32_16x16x32_bf16 v[136:139], v[208:211], v[52:55], v[136:139]
    s_waitcnt lgkmcnt(2)
    v_mfma_f32_16x16x32_bf16 v[128:131], v[216:219], v[64:67], v[128:131]
    v_add_u32 v2, 0xffff8000, v2
    v_mfma_f32_16x16x32_bf16 v[132:135], v[220:223], v[64:67], v[132:135]
    v_mfma_f32_16x16x32_bf16 v[140:143], v[220:223], v[68:71], v[140:143]
    v_mfma_f32_16x16x32_bf16 v[136:139], v[216:219], v[68:71], v[136:139]
    s_waitcnt lgkmcnt(0)
    s_barrier
    v_mfma_f32_16x16x32_bf16 v[128:131], v[120:123], v[80:83], v[128:131]
    ds_read_b128 v[32:35], v2 offset:0
    ds_read_b128 v[36:39], v2 offset:1024
    ds_read_b64_tr_b16 v[40:41], v3 offset:0
    v_mfma_f32_16x16x32_bf16 v[132:135], v[124:127], v[80:83], v[132:135]
    ds_read_b64_tr_b16 v[42:43], v3 offset:2048
    ds_read_b64_tr_b16 v[44:45], v4 offset:0
    ds_read_b64_tr_b16 v[46:47], v4 offset:2048
    v_mfma_f32_16x16x32_bf16 v[140:143], v[124:127], v[84:87], v[140:143]
    ds_read_b128 v[48:51], v2 offset:4096
    ds_read_b128 v[52:55], v2 offset:5120
    ds_read_b64_tr_b16 v[56:57], v3 offset:4096
    v_mfma_f32_16x16x32_bf16 v[136:139], v[120:123], v[84:87], v[136:139]
    ds_read_b64_tr_b16 v[58:59], v3 offset:6144
    ds_read_b64_tr_b16 v[60:61], v4 offset:4096
    ds_read_b64_tr_b16 v[62:63], v4 offset:6144
L_p2_Q:
    s_cmp_eq_u32 s80, 0
    s_cbranch_scc1 L_oflag
L_p2b_Q:
    s_waitcnt lgkmcnt(6)
    v_mfma_f32_16x16x32_bf16 v[128:131], v[40:43], v[32:35], v[128:131]
    ds_read_b128 v[64:67], v2 offset:8192
    ds_read_b128 v[68:71], v2 offset:9216
    v_mfma_f32_16x16x32_bf16 v[132:135], v[44:47], v[32:35], v[132:135]
    ds_read_b64_tr_b16 v[72:73], v3 offset:8192
    ds_read_b64_tr_b16 v[74:75], v3 offset:10240
    v_mfma_f32_16x16x32_bf16 v[140:143], v[44:47], v[36:39], v[140:143]
    ds_read_b64_tr_b16 v[76:77], v4 offset:8192
    ds_read_b64_tr_b16 v[78:79], v4 offset:10240
    v_mfma_f32_16x16x32_bf16 v[136:139], v[40:43], v[36:39], v[136:139]
    s_waitcnt lgkmcnt(6)
    v_mfma_f32_16x16x32_bf16 v[128:131], v[56:59], v[48:51], v[128:131]
    ds_read_b128 v[80:83], v2 offset:12288
    ds_read_b128 v[84:87], v2 offset:13312
    v_mfma_f32_16x16x32_bf16 v[132:135], v[60:63], v[48:51], v[132:135]
    ds_read_b64_tr_b16 v[88:89], v3 offset:12288
    ds_read_b64_tr_b16 v[90:91], v3 offset:14336
    v_mfma_f32_16x16x32_bf16 v[140:143], v[60:63], v[52:55], v[140:143]
    ds_read_b64_tr_b16 v[92:93], v4 offset:12288
    ds_read_b64_tr_b16 v[94:95], v4 offset:14336
    v_mfma_f32_16x16x32_bf16 v[136:139], v[56:59], v[52:55], v[136:139]
    s_waitcnt lgkmcnt(6)
    v_mfma_f32_16x16x32_bf16 v[128:131], v[72:75], v[64:67], v[128:131]
    s_mov_b32 s78, 16384
    s_add_u32 s75, s75, 1
    s_cmp_eq_u32 s75, 3
    s_cselect_b32 s78, 4294934528, s78
    s_cselect_b32 s75, 0, s75
    v_mfma_f32_16x16x32_bf16 v[132:135], v[76:79], v[64:67], v[132:135]
    s_mov_b32 s79, 16384
    s_add_u32 s76, s76, 1
    s_cmp_eq_u32 s76, 6
    s_cselect_b32 s79, 4294885376, s79
    s_cselect_b32 s76, 0, s76
    v_mfma_f32_16x16x32_bf16 v[140:143], v[76:79], v[68:71], v[140:143]
    v_add_u32 v2, s78, v2
    v_add_u32 v3, s79, v3
    v_add_u32 v4, s79, v4
    s_add_u32 s77, s77, 1
    s_cmp_eq_u32 s77, 17
    v_mfma_f32_16x16x32_bf16 v[136:139], v[72:75], v[68:71], v[136:139]
    s_cbranch_scc1 L_p2l_Q
    s_waitcnt lgkmcnt(0)
    s_barrier
    v_mfma_f32_16x16x32_bf16 v[128:131], v[88:91], v[80:83], v[128:131]
    ds_read_b128 v[32:35], v2 offset:0
    ds_read_b128 v[36:39], v2 offset:1024
    ds_read_b64_tr_b16 v[40:41], v3 offset:0
    v_mfma_f32_16x16x32_bf16 v[132:135], v[92:95], v[80:83], v[132:135]
    ds_read_b64_tr_b16 v[42:43], v3 offset:2048
    ds_read_b64_tr_b16 v[44:45], v4 offset:0
    ds_read_b64_tr_b16 v[46:47], v4 offset:2048
    v_mfma_f32_16x16x32_bf16 v[140:143], v[92:95], v[84:87], v[140:143]
    ds_read_b128 v[48:51], v2 offset:4096
    ds_read_b128 v[52:55], v2 offset:5120
    ds_read_b64_tr_b16 v[56:57], v3 offset:4096
    v_mfma_f32_16x16x32_bf16 v[136:139], v[88:91], v[84:87], v[136:139]
    ds_read_b64_tr_b16 v[58:59], v3 offset:6144
    ds_read_b64_tr_b16 v[60:61], v4 offset:4096
    ds_read_b64_tr_b16 v[62:63], v4 offset:6144
    s_branch L_p2_Q
L_p2l_Q:
    ds_read_b64 v[112:113], v5 offset:0
    ds_read_b64 v[114:115], v6 offset:0
    ds_read_b64 v[116:117], v5 offset:2048
    ds_read_b64 v[118:119], v6 offset:2048
    s_waitcnt lgkmcnt(4)
    v_mfma_f32_16x16x32_bf16 v[128:131], v[88:91], v[80:83], v[128:131]
    v_mfma_f32_16x16x32_bf16 v[132:135], v[92:95], v[80:83], v[132:135]
    v_mfma_f32_16x16x32_bf16 v[140:143], v[92:95], v[84:87], v[140:143]
    v_mfma_f32_16x16x32_bf16 v[136:139], v[88:91], v[84:87], v[136:139]
    s_waitcnt lgkmcnt(0)
    v_lshlrev_b32 v32, 16, v112
    v_and_b32 v33, 0xffff0000, v112
    v_lshlrev_b32 v34, 16, v113
    v_and_b32 v35, 0xffff0000, v113
    v_lshlrev_b32 v36, 16, v114
    v_and_b32 v37, 0xffff0000, v114
    v_lshlrev_b32 v38, 16, v115
    v_and_b32 v39, 0xffff0000, v115
    v_lshlrev_b32 v40, 16, v116
    v_and_b32 v41, 0xffff0000, v116
    v_lshlrev_b32 v42, 16, v117
    v_and_b32 v43, 0xffff0000, v117
    v_lshlrev_b32 v44, 16, v118
    v_and_b32 v45, 0xffff0000, v118
    v_lshlrev_b32 v46, 16, v119
    v_and_b32 v47, 0xffff0000, v119
    v_pk_add_f32 v[128:129], v[128:129], v[32:33]
    v_pk_add_f32 v[130:131], v[130:131], v[34:35]
    v_cvt_pk_bf16_f32 v112, v128, v129
    v_cvt_pk_bf16_f32 v113, v130, v131
    ds_write_b64 v5, v[112:113] offset:0
    v_pk_add_f32 v[132:133], v[132:133], v[36:37]
    v_pk_add_f32 v[134:135], v[134:135], v[38:39]
    v_cvt_pk_bf16_f32 v114, v132, v133
    v_cvt_pk_bf16_f32 v115, v134, v135
    ds_write_b64 v6, v[114:115] offset:0
    v_pk_add_f32 v[136:137], v[136:137], v[40:41]
    v_pk_add_f32 v[138:139], v[138:139], v[42:43]
    v_cvt_pk_bf16_f32 v116, v136, v137
    v_cvt_pk_bf16_f32 v117, v138, v139
    ds_write_b64 v5, v[116:117] offset:2048
    v_pk_add_f32 v[140:141], v[140:141], v[44:45]
    v_pk_add_f32 v[142:143], v[142:143], v[46:47]
    v_cvt_pk_bf16_f32 v118, v140, v141
    v_cvt_pk_bf16_f32 v119, v142, v143
    ds_write_b64 v6, v[118:119] offset:2048
    s_waitcnt lgkmcnt(0)
L_final_Q:
    s_barrier
    s_lshl_b32 s64, s54, 10
    s_add_u32 s64, s64, 131072
    v_lshl_add_u32 v1, v0, 4, s64
    ds_read_b128 v[8:11], v1
    s_mul_i32 s66, s61, 20480
    s_lshl_b32 s65, s60, 7
    s_add_u32 s66, s66, s65
    s_mul_i32 s65, s54, 10240
    s_add_u32 s66, s66, s65
    s_waitcnt lgkmcnt(0)
    buffer_store_dwordx4 v[8:11], v7, s[28:31], s66 offen sc1
    s_endpgm
L_oflag:
    s_getreg_b32 s64, hwreg(HW_REG_IB_STS, 0, 4)
    s_cmp_ge_u32 s77, 6
    s_cselect_b32 s64, 0, s64
    s_cmp_lg_u32 s64, 0
    s_cbranch_scc1 L_p2b_Q
    s_mov_b32 s80, 1
    s_lshl_b32 s64, s55, 7
    s_add_u32 s64, s64, 0x918800
    v_mov_b32 v252, 158728
    v_mov_b32 v253, 1
    v_mov_b32 v255, s64
    s_mov_b64 exec, 1
    s_waitcnt vmcnt(0)
    ds_add_rtn_u32 v254, v252, v253
    s_waitcnt lgkmcnt(0)
    v_cmp_eq_u32 vcc, 3, v254
    s_cbranch_vccz L_arr_98
    buffer_atomic_add v253, v255, s[24:27], 0 offen
L_arr_98:
    s_mov_b64 exec, -1
    s_branch L_p2b_Q
L_end:
    s_endpgm
.section .rodata,"a"
.p2align 6
.amdhsa_kernel parallel_sum__linear_attn_block__dense_activation_silu__prompt_kernel
  .amdhsa_next_free_vgpr 256
  .amdhsa_next_free_sgpr 102
  .amdhsa_accum_offset 256
  .amdhsa_group_segment_fixed_size 0
  .amdhsa_kernarg_size 72
  .amdhsa_user_sgpr_count 2
  .amdhsa_user_sgpr_kernarg_segment_ptr 1
  .amdhsa_system_sgpr_workgroup_id_x 1
.end_amdhsa_kernel
```
